```python
import torch

def _softmax(x, axis=-1):
    return torch.softmax(x, dim=axis)
def _gelu(x):
    return torch.nn.functional.gelu(x, approximate="tanh")
def _silu(x):
    return torch.nn.functional.silu(x)
def _sigmoid(x):
    return torch.sigmoid(x)
def _layernorm(x, axis=-1, eps=1e-5):
    m = x.mean(dim=axis, keepdim=True)
    v = x.var(dim=axis, keepdim=True, unbiased=False)
    return (x - m) / torch.sqrt(v + eps)
def _scatter_add(tgt, idx, src, axis=0):
    return tgt.clone().index_add_(axis, idx, src)
def _segment_sum(src, seg, n):
    out = torch.zeros((n,) + src.shape[1:], dtype=src.dtype)
    return out.index_add_(0, seg, src)
def _pad(x, pw):
    flat = tuple(v for pair in reversed(pw) for v in pair)
    return torch.nn.functional.pad(x, flat)

kernel_name = 'sequential_preLN__sliding_block__geglu_ffn__prompt'

def setup_inputs():

    _w = (lambda a: (lambda t: t.to(torch.bfloat16) if t.is_floating_point() else t)(torch.as_tensor(a)))
    def _A_setup():
        B, S, D = 1, 2048, 448
        return {
            "x": _w((lambda *s: torch.randn(*s, dtype=torch.bfloat16) * 0.05)(B, S, D)),
            "wqkv": _w((lambda *s: torch.randn(*s, dtype=torch.bfloat16) * 0.05)(D, 3 * D)),
            "wo": _w((lambda *s: torch.randn(*s, dtype=torch.bfloat16) * 0.05)(D, D)),
        }
    _A_in = _A_setup()

    def _B_setup():
        B, S, D, F = 1, 2048, 448, 1792
        return {
            "x": _w((lambda *s: torch.randn(*s, dtype=torch.bfloat16) * 0.05)(B, S, D)),
            "w_gate": _w((lambda *s: torch.randn(*s, dtype=torch.bfloat16) * 0.05)(D, F)),
            "w_up": _w((lambda *s: torch.randn(*s, dtype=torch.bfloat16) * 0.05)(D, F)),
            "w_down": _w((lambda *s: torch.randn(*s, dtype=torch.bfloat16) * 0.05)(F, D)),
        }
    _B_in = _B_setup()

    return {
        "A_x": _A_in["x"],
        "A_wqkv": _A_in["wqkv"],
        "A_wo": _A_in["wo"],
        "B_x": _B_in["x"],
        "B_w_gate": _B_in["w_gate"],
        "B_w_up": _B_in["w_up"],
        "B_w_down": _B_in["w_down"],
    }

def reference(A_x, A_wqkv, A_wo, B_x, B_w_gate, B_w_up, B_w_down):
    def _A_ref(x, wqkv, wo):
        B, S, D = x.shape
        H = 16; Dh = D // H; W = 256
        qkv = (lambda x, *d: x.permute(*d))((x @ wqkv).reshape(B, S, 3, H, Dh), 2, 0, 3, 1, 4)
        q, k, v = qkv[0], qkv[1], qkv[2]
        scores = torch.einsum("bhqd,bhkd->bhqk", q, k) * (Dh ** -0.5)
        idx = torch.arange(S)
        mask = (idx[:, None] - idx[None, :] >= 0) & (idx[:, None] - idx[None, :] < W)
        scores = torch.where(mask[None, None], scores, -1e9)
        p = _softmax(scores, axis=-1)
        o = torch.einsum("bhqk,bhkd->bhqd", p, v)
        return (lambda x, *d: x.permute(*d))(o, 0, 2, 1, 3).reshape(B, S, D) @ wo

    def _B_ref(x, w_gate, w_up, w_down):
        return (_gelu(x @ w_gate) * (x @ w_up)) @ w_down

    x = A_x
    h = x + _A_ref(_layernorm(x, axis=-1), A_wqkv, A_wo)
    h2 = h + _B_ref(_layernorm(h, axis=-1), B_w_gate, B_w_up, B_w_down)
    return h2
```

```asm
; @launch grid=(256,1,1) block=(512,1,1) lds=163840
.amdgcn_target "amdgcn-amd-amdhsa--gfx950"
.text
.globl sequential_preLN__sliding_block__geglu_ffn__prompt_kernel
.p2align 12
.p2align 8
.type sequential_preLN__sliding_block__geglu_ffn__prompt_kernel,@function
sequential_preLN__sliding_block__geglu_ffn__prompt_kernel:
    s_cmp_ge_u32 s2, 256
    s_cbranch_scc1 L_exit
    s_load_dwordx16 s[84:99], s[0:1], 0
    s_load_dwordx4 s[4:7], s[0:1], 64
    v_lshrrev_b32 v3, 6, v0
    v_and_b32 v1, 63, v0
    v_readfirstlane_b32 s47, v3
    s_and_b32 s44, s2, 7
    s_bfe_u32 s48, s2, 0x40003
    s_and_b32 s46, s47, 3
    s_cmp_lt_u32 s47, 4
    s_cbranch_scc1 L_roleL
    v_lshrrev_b32 v28, 3, v1
    v_bfe_u32 v26, v1, 4, 1
    v_and_b32 v29, 7, v1
    v_lshlrev_b32 v26, 2, v26
    v_xor_b32 v26, v26, v29
    v_mul_u32_u24 v27, 2688, v28
    v_lshl_add_u32 v8, v26, 4, v27
    v_add_u32 v9, 20480, v8
    s_cmp_eq_u32 s44, 7
    s_cselect_b32 s69, 0, s44
    s_mov_b32 s59, s69
    s_mul_i32 s56, s46, 43008
    s_add_u32 s53, s48, 7
    s_lshl_b32 s53, s53, 7
    s_add_u32 s78, s56, s53
    s_cmp_lt_u32 s48, 14
    s_cselect_b32 s78, s78, 0x7f000000
    s_lshl_b32 s55, s46, 11
    s_waitcnt lgkmcnt(0)
    s_mov_b64 s[12:13], s[86:87]
    s_mov_b32 s14, 1204224
    s_mov_b32 s15, 0x20000
    s_add_u32 m0, s55, 106496
    s_mul_i32 s53, s69, 172032
    s_add_u32 s53, s53, s78
    buffer_load_dwordx4 v8, s[12:15], s53 offen offset:0  lds
    buffer_load_dwordx4 v9, s[12:15], s53 offen offset:1024  lds
    s_add_u32 s69, s69, 1
    s_cmp_eq_u32 s69, 7
    s_cselect_b32 s69, 0, s69
    v_mul_u32_u24 v27, 896, v28
    v_lshrrev_b32 v26, 1, v28
    v_xor_b32 v26, v26, v29
    v_lshl_add_u32 v4, v26, 4, v27
    v_xor_b32_e64 v5, 64, v4
    v_add_u32 v6, 12288, v4
    v_add_u32 v7, 18432, v5
    v_add_u32 v5, 6144, v5
    s_lshr_b32 s54, s2, 7
    s_lshl_b32 s49, s44, 1
    s_add_u32 s49, s49, s54
    s_lshl_b32 s68, s49, 2
    s_add_u32 s68, s68, s46
    s_lshl_b32 s58, s46, 12
    s_mul_i32 s57, s68, 28672
    s_mov_b64 s[8:9], s[84:85]
    s_mov_b32 s10, 1835008
    s_mov_b32 s11, 0x20000
    s_add_u32 m0, s58, 0
    s_lshl_b32 s53, s59, 7
    s_add_u32 s53, s53, s57
    buffer_load_dwordx4 v4, s[8:11], s53 offen offset:0  lds
    buffer_load_dwordx4 v5, s[8:11], s53 offen offset:1024  lds
    buffer_load_dwordx4 v6, s[8:11], s53 offen offset:2048  lds
    buffer_load_dwordx4 v7, s[8:11], s53 offen offset:3072  lds
    s_add_u32 s59, s59, 1
    s_cmp_eq_u32 s59, 7
    s_cselect_b32 s59, 0, s59
    s_add_u32 m0, s55, 114688
    s_mul_i32 s53, s69, 172032
    s_add_u32 s53, s53, s78
    buffer_load_dwordx4 v8, s[12:15], s53 offen offset:0  lds
    buffer_load_dwordx4 v9, s[12:15], s53 offen offset:1024  lds
    s_add_u32 s69, s69, 1
    s_cmp_eq_u32 s69, 7
    s_cselect_b32 s69, 0, s69
    s_lshr_b32 s54, s2, 7
    s_cmp_lt_u32 s48, 14
    s_cselect_b32 s53, 14, 2
    s_cselect_b32 s45, 0, 14
    s_mul_i32 s53, s53, s54
    s_add_u32 s45, s45, s53
    s_add_u32 s45, s45, s48
    s_lshl_b32 s77, s44, 12
    s_add_u32 s77, s77, 16908288
    v_lshlrev_b32_e64 v2, 4, v1
    s_mov_b64 s[40:41], s[6:7]
    s_mov_b32 s42, 18874368
    s_mov_b32 s43, 0x20000
    s_mov_b64 s[36:37], s[4:5]
    s_mov_b32 s38, 256
    s_mov_b32 s39, 0x20000
    s_mov_b64 s[16:17], s[88:89]
    s_mov_b32 s18, 401408
    s_mov_b32 s19, 0x20000
    s_mov_b64 s[20:21], s[92:93]
    s_mov_b32 s22, 1605632
    s_mov_b32 s23, 0x20000
    s_mov_b64 s[24:25], s[94:95]
    s_mov_b32 s26, 1605632
    s_mov_b32 s27, 0x20000
    s_mov_b64 s[28:29], s[96:97]
    s_mov_b32 s30, 1605632
    s_mov_b32 s31, 0x20000
    s_mov_b64 s[32:33], s[98:99]
    s_mov_b32 s34, 1835008
    s_mov_b32 s35, 0x20000
    s_mul_i32 s72, s45, 37
    s_lshr_b32 s72, s72, 8
    s_mul_i32 s53, s72, 7
    s_sub_u32 s73, s45, s53
    s_and_b32 s70, s45, 1
    s_and_b32 s75, s46, 1
    s_lshr_b32 s74, s46, 1
    s_lshr_b32 s76, s72, 1
    s_mov_b32 s52, 0
    s_mov_b32 s60, 0
    s_mov_b32 s61, -1
    s_getreg_b32 s50, hwreg(HW_REG_XCC_ID, 0, 4)
    s_or_b32 s50, s50, 0x100
    s_mul_i32 s53, s48, 56
    s_add_u32 s56, s56, s53
    v_lshlrev_b32 v24, 7, v1
    v_lshrrev_b32 v10, 2, v1
    v_mul_u32_u24 v10, 2688, v10
    v_and_b32 v26, 3, v1
    v_lshl_add_u32 v10, v26, 4, v10
    v_lshrrev_b32 v12, 3, v1
    v_mul_u32_u24 v12, 896, v12
    v_lshrrev_b32 v26, 2, v1
    v_lshrrev_b32 v27, 4, v1
    v_xor_b32 v26, v26, v27
    v_and_b32 v26, 1, v26
    v_mul_u32_u24 v26, 64, v26
    v_add_u32 v12, v12, v26
    v_and_b32_e64 v26, 3, v1
    v_lshl_add_u32 v12, v26, 4, v12
    v_add_u32 v13, 6144, v12
    v_add_u32 v14, 12288, v12
    v_add_u32 v15, 18432, v12
    v_lshrrev_b32 v11, 3, v1
    v_mul_u32_u24 v11, 896, v11
    v_and_b32 v27, 7, v1
    v_lshl_add_u32 v11, v27, 4, v11
    v_lshrrev_b32 v30, 3, v1
    v_mul_u32_u24 v30, 3584, v30
    v_lshrrev_b32 v26, 2, v1
    v_lshrrev_b32 v27, 4, v1
    v_xor_b32 v26, v26, v27
    v_and_b32 v26, 1, v26
    v_mul_u32_u24 v26, 64, v26
    v_add_u32 v30, v30, v26
    v_and_b32 v26, 3, v1
    v_lshl_add_u32 v30, v26, 4, v30
    v_add_u32 v31, 27648, v30
    v_and_b32 v26, 31, v1
    v_lshrrev_b32 v27, 5, v1
    v_mul_u32_u24 v16, 7168, v27
    v_lshl_add_u32 v16, v26, 4, v16
    v_add_u32 v17, 2108416, v16
    v_add_u32 v16, 2095104, v16
    v_bfe_u32 v21, v1, 1, 1
    v_xor_b32 v21, s74, v21
    v_lshlrev_b32 v21, 6, v21
    v_lshl_add_u32 v21, v26, 7, v21
    v_lshl_add_u32 v21, v27, 3, v21
    s_lshl_b32 s53, s75, 12
    s_add_u32 s53, s53, 98304
    v_add_u32 v21, s53, v21
    v_lshrrev_b32 v18, 5, v1
    v_mul_u32_u24 v18, 4, v18
    v_bfe_u32 v26, v1, 2, 2
    v_add_u32_e64 v18, v18, v26
    v_mul_u32_u24 v18, 128, v18
    v_bfe_u32 v26, v1, 4, 1
    v_mul_u32_u24 v26, 32, v26
    v_add_u32 v18, v18, v26
    v_and_b32_e64 v26, 3, v1
    v_lshl_add_u32 v18, v26, 3, v18
    v_bfe_u32 v26, v1, 3, 1
    v_xor_b32 v26, s74, v26
    v_lshlrev_b32 v26, 6, v26
    v_xor_b32 v27, 64, v26
    v_add_u32 v19, v18, v27
    v_add_u32_e64 v18, v18, v26
    s_mul_i32 s53, s74, 28672
    s_add_u32 s53, s53, 49152
    v_add_u32 v18, s53, v18
    v_add_u32 v19, s53, v19
    s_mov_b32 s64, 1329540880
    s_mov_b32 s65, 4294440693
    s_lshl_b32 s53, s48, 2
    s_lshr_b64 s[64:65], s[64:65], s53
    s_and_b32 s53, s64, 15
    s_and_b32 s64, s49, 1
    s_lshl_b32 s64, s64, 3
    s_add_u32 s64, s64, s53
    s_lshl_b32 s64, s64, 2
    s_add_u32 s64, s64, s46
    s_mul_i32 s64, s64, 3584
    s_cmp_lt_u32 s53, 8
    s_cselect_b32 s64, s64, 0x7f000000
    s_add_u32 m0, s58, 16384
    s_lshl_b32 s53, s59, 7
    s_add_u32 s53, s53, s57
    buffer_load_dwordx4 v4, s[8:11], s53 offen offset:0  lds
    buffer_load_dwordx4 v5, s[8:11], s53 offen offset:1024  lds
    buffer_load_dwordx4 v6, s[8:11], s53 offen offset:2048  lds
    buffer_load_dwordx4 v7, s[8:11], s53 offen offset:3072  lds
    s_add_u32 s59, s59, 1
    s_cmp_eq_u32 s59, 7
    s_cselect_b32 s59, 0, s59
    s_waitcnt vmcnt(6)
    s_barrier
    s_add_u32 m0, s55, 122880
    s_mul_i32 s53, s69, 172032
    s_add_u32 s53, s53, s78
    buffer_load_dwordx4 v8, s[12:15], s53 offen offset:0  lds
    buffer_load_dwordx4 v9, s[12:15], s53 offen offset:1024  lds
    s_add_u32 s69, s69, 1
    s_cmp_eq_u32 s69, 7
    s_cselect_b32 s69, 0, s69
    s_add_u32 m0, s55, 131072
    s_mul_i32 s53, s69, 172032
    s_add_u32 s53, s53, s78
    buffer_load_dwordx4 v8, s[12:15], s53 offen offset:0  lds
    buffer_load_dwordx4 v9, s[12:15], s53 offen offset:1024  lds
    s_add_u32 s69, s69, 1
    s_cmp_eq_u32 s69, 7
    s_cselect_b32 s69, 0, s69
    s_add_u32 m0, s58, 32768
    s_lshl_b32 s53, s59, 7
    s_add_u32 s53, s53, s57
    buffer_load_dwordx4 v4, s[8:11], s53 offen offset:0  lds
    buffer_load_dwordx4 v5, s[8:11], s53 offen offset:1024  lds
    buffer_load_dwordx4 v6, s[8:11], s53 offen offset:2048  lds
    buffer_load_dwordx4 v7, s[8:11], s53 offen offset:3072  lds
    s_add_u32 s59, s59, 1
    s_cmp_eq_u32 s59, 7
    s_cselect_b32 s59, 0, s59
    s_waitcnt vmcnt(8)
    s_barrier
    s_add_u32 m0, s55, 139264
    s_mul_i32 s53, s69, 172032
    s_add_u32 s53, s53, s78
    buffer_load_dwordx4 v8, s[12:15], s53 offen offset:0  lds
    buffer_load_dwordx4 v9, s[12:15], s53 offen offset:1024  lds
    s_add_u32 s69, s69, 1
    s_cmp_eq_u32 s69, 7
    s_cselect_b32 s69, 0, s69
    s_add_u32 m0, s58, 49152
    s_lshl_b32 s53, s59, 7
    s_add_u32 s53, s53, s57
    buffer_load_dwordx4 v4, s[8:11], s53 offen offset:0  lds
    buffer_load_dwordx4 v5, s[8:11], s53 offen offset:1024  lds
    buffer_load_dwordx4 v6, s[8:11], s53 offen offset:2048  lds
    buffer_load_dwordx4 v7, s[8:11], s53 offen offset:3072  lds
    s_add_u32 s59, s59, 1
    s_cmp_eq_u32 s59, 7
    s_cselect_b32 s59, 0, s59
    s_lshr_b32 s54, s55, 1
    s_add_u32 m0, s54, 65536
    s_cmp_eq_u32 s44, 7
    s_cselect_b32 s79, 0, s44
    s_mul_i32 s53, s79, 172032
    s_add_u32 s53, s53, s56
    buffer_load_dwordx4 v10, s[12:15], s53 offen offset:0  lds
    s_add_u32 s79, s79, 1
    s_cmp_eq_u32 s79, 7
    s_cselect_b32 s79, 0, s79
    s_waitcnt vmcnt(7)
    s_barrier
    s_add_u32 m0, s55, 147456
    s_mul_i32 s53, s69, 172032
    s_add_u32 s53, s53, s78
    buffer_load_dwordx4 v8, s[12:15], s53 offen offset:0  lds
    buffer_load_dwordx4 v9, s[12:15], s53 offen offset:1024  lds
    s_add_u32 s69, s69, 1
    s_cmp_eq_u32 s69, 7
    s_cselect_b32 s69, 0, s69
    s_add_u32 m0, s58, 0
    s_lshl_b32 s53, s59, 7
    s_add_u32 s53, s53, s57
    buffer_load_dwordx4 v4, s[8:11], s53 offen offset:0  lds
    buffer_load_dwordx4 v5, s[8:11], s53 offen offset:1024  lds
    buffer_load_dwordx4 v6, s[8:11], s53 offen offset:2048  lds
    buffer_load_dwordx4 v7, s[8:11], s53 offen offset:3072  lds
    s_add_u32 s59, s59, 1
    s_cmp_eq_u32 s59, 7
    s_cselect_b32 s59, 0, s59
    s_lshr_b32 s54, s55, 1
    s_add_u32 m0, s54, 69632
    s_mul_i32 s53, s79, 172032
    s_add_u32 s53, s53, s56
    buffer_load_dwordx4 v10, s[12:15], s53 offen offset:0  lds
    s_add_u32 s79, s79, 1
    s_cmp_eq_u32 s79, 7
    s_cselect_b32 s79, 0, s79
    s_waitcnt vmcnt(8)
    s_barrier
    s_add_u32 m0, s55, 155648
    s_mul_i32 s53, s69, 172032
    s_add_u32 s53, s53, s78
    buffer_load_dwordx4 v8, s[12:15], s53 offen offset:0  lds
    buffer_load_dwordx4 v9, s[12:15], s53 offen offset:1024  lds
    s_add_u32 s69, s69, 1
    s_cmp_eq_u32 s69, 7
    s_cselect_b32 s69, 0, s69
    s_add_u32 m0, s58, 16384
    s_lshl_b32 s53, s59, 7
    s_add_u32 s53, s53, s57
    buffer_load_dwordx4 v4, s[8:11], s53 offen offset:0  lds
    buffer_load_dwordx4 v5, s[8:11], s53 offen offset:1024  lds
    buffer_load_dwordx4 v6, s[8:11], s53 offen offset:2048  lds
    buffer_load_dwordx4 v7, s[8:11], s53 offen offset:3072  lds
    s_add_u32 s59, s59, 1
    s_cmp_eq_u32 s59, 7
    s_cselect_b32 s59, 0, s59
    s_lshr_b32 s54, s55, 1
    s_add_u32 m0, s54, 73728
    s_mul_i32 s53, s79, 172032
    s_add_u32 s53, s53, s56
    buffer_load_dwordx4 v10, s[12:15], s53 offen offset:0  lds
    s_add_u32 s79, s79, 1
    s_cmp_eq_u32 s79, 7
    s_cselect_b32 s79, 0, s79
    s_waitcnt vmcnt(8)
    s_barrier
    s_add_u32 m0, s58, 32768
    s_lshl_b32 s53, s59, 7
    s_add_u32 s53, s53, s57
    buffer_load_dwordx4 v4, s[8:11], s53 offen offset:0  lds
    buffer_load_dwordx4 v5, s[8:11], s53 offen offset:1024  lds
    buffer_load_dwordx4 v6, s[8:11], s53 offen offset:2048  lds
    buffer_load_dwordx4 v7, s[8:11], s53 offen offset:3072  lds
    s_add_u32 s59, s59, 1
    s_cmp_eq_u32 s59, 7
    s_cselect_b32 s59, 0, s59
    s_lshr_b32 s54, s55, 1
    s_add_u32 m0, s54, 77824
    s_mul_i32 s53, s79, 172032
    s_add_u32 s53, s53, s56
    buffer_load_dwordx4 v10, s[12:15], s53 offen offset:0  lds
    s_add_u32 s79, s79, 1
    s_cmp_eq_u32 s79, 7
    s_cselect_b32 s79, 0, s79
    s_waitcnt vmcnt(6)
    s_barrier
    s_lshr_b32 s54, s55, 1
    s_add_u32 m0, s54, 81920
    s_mul_i32 s53, s79, 172032
    s_add_u32 s53, s53, s56
    buffer_load_dwordx4 v10, s[12:15], s53 offen offset:0  lds
    s_add_u32 s79, s79, 1
    s_cmp_eq_u32 s79, 7
    s_cselect_b32 s79, 0, s79
    s_lshr_b32 s54, s55, 1
    s_add_u32 m0, s54, 86016
    s_mul_i32 s53, s79, 172032
    s_add_u32 s53, s53, s56
    buffer_load_dwordx4 v10, s[12:15], s53 offen offset:0  lds
    s_add_u32 s79, s79, 1
    s_cmp_eq_u32 s79, 7
    s_cselect_b32 s79, 0, s79
    s_waitcnt vmcnt(3)
    s_barrier
    s_lshr_b32 s54, s55, 1
    s_add_u32 m0, s54, 90112
    s_mul_i32 s53, s79, 172032
    s_add_u32 s53, s53, s56
    buffer_load_dwordx4 v10, s[12:15], s53 offen offset:0  lds
    s_add_u32 s79, s79, 1
    s_cmp_eq_u32 s79, 7
    s_cselect_b32 s79, 0, s79
    s_branch L_pgS_skip
L_roleL:
    s_waitcnt lgkmcnt(0)
    s_lshl_b32 s53, s44, 5
    s_lshr_b32 s54, s2, 3
    s_add_u32 s53, s53, s54
    s_lshl_b32 s55, s46, 3
    s_lshr_b32 s55, 218959160, s55
    s_and_b32 s55, s55, 63
    s_cmp_eq_u32 s46, 3
    s_cselect_b32 s53, s54, s53
    s_mul_i32 s53, s53, s55
    v_add_u32 v3, s53, v1
    v_mul_u32_u24 v15, 9363, v3
    v_lshrrev_b32 v15, 16, v15
    s_cmp_eq_u32 s46, 1
    s_cselect_b32 s53, 14, 0
    v_mad_u32_u24 v3, v15, s53, v3
    v_lshlrev_b32 v3, 7, v3
    s_bfm_b64 exec, s55, 0
    s_getpc_b64 s[100:101]
L_pc:
    s_mov_b32 s56, L_tail-L_pc
    s_cmp_eq_u32 s46, 0
    s_cselect_b64 s[100:101], s[84:85], s[100:101]
    s_cselect_b32 s56, 1835004, s56
    s_cmp_eq_u32 s46, 1
    s_cselect_b64 s[100:101], s[86:87], s[100:101]
    s_cselect_b32 s56, 1204220, s56
    s_cmp_eq_u32 s46, 2
    s_cselect_b64 s[100:101], s[88:89], s[100:101]
    s_cselect_b32 s56, 401404, s56
    v_min_u32 v3, s56, v3
    global_load_dword v15, v3, s[100:101]
    s_mov_b64 exec, -1
    s_lshr_b32 s54, s2, 7
    s_cmp_lt_u32 s48, 14
    s_cselect_b32 s53, 14, 2
    s_cselect_b32 s45, 0, 14
    s_mul_i32 s53, s53, s54
    s_add_u32 s45, s45, s53
    s_add_u32 s45, s45, s48
    s_lshl_b32 s77, s44, 12
    s_add_u32 s77, s77, 16908288
    v_lshlrev_b32 v2, 4, v1
    s_mov_b64 s[40:41], s[6:7]
    s_mov_b32 s42, 18874368
    s_mov_b32 s43, 0x20000
    s_mov_b64 s[36:37], s[4:5]
    s_mov_b32 s38, 256
    s_mov_b32 s39, 0x20000
    v_mov_b32 v32, 0
    v_mov_b32 v33, 0
    v_mov_b32 v34, 0
    v_mov_b32 v35, 0
    s_lshl_b32 s53, s45, 2
    s_add_u32 s53, s53, s46
    s_cmp_lg_u32 s53, 112
    s_cbranch_scc1 L_nolead_36
    v_lshlrev_b32 v26, 7, v1
    s_lshl_b32 s53, s44, 14
    s_add_u32 s53, s53, 16777216
    s_add_u32 s54, s53, 8192
    buffer_store_dword v32, v26, s[40:43], s53 offen sc1
    buffer_store_dword v32, v26, s[40:43], s54 offen sc1
    buffer_store_dwordx4 v[32:35], v2, s[40:43], s77 offen offset:0 sc1
    buffer_store_dwordx4 v[32:35], v2, s[40:43], s77 offen offset:1024 sc1
    buffer_store_dwordx4 v[32:35], v2, s[40:43], s77 offen offset:2048 sc1
    buffer_store_dwordx4 v[32:35], v2, s[40:43], s77 offen offset:3072 sc1
    s_lshl_b32 s53, s44, 2
    v_mov_b32 v36, 1
    s_waitcnt vmcnt(0)
    s_mov_b64 exec, 1
    buffer_store_dword v36, v32, s[36:39], s53 offen sc1
    s_mov_b64 exec, -1
L_nolead_36:
    s_lshr_b32 s54, s2, 7
    s_lshl_b32 s49, s44, 1
    s_add_u32 s49, s49, s54
    s_lshl_b32 s68, s49, 2
    s_add_u32 s68, s68, s46
    s_lshl_b32 s58, s46, 12
    s_mov_b64 s[16:17], s[88:89]
    s_mov_b32 s18, 401408
    s_mov_b32 s19, 0x20000
    s_mov_b64 s[20:21], s[92:93]
    s_mov_b32 s22, 1605632
    s_mov_b32 s23, 0x20000
    s_mov_b64 s[24:25], s[94:95]
    s_mov_b32 s26, 1605632
    s_mov_b32 s27, 0x20000
    s_mov_b64 s[28:29], s[96:97]
    s_mov_b32 s30, 1605632
    s_mov_b32 s31, 0x20000
    s_mov_b64 s[32:33], s[98:99]
    s_mov_b32 s34, 1835008
    s_mov_b32 s35, 0x20000
    s_mul_i32 s72, s45, 37
    s_lshr_b32 s72, s72, 8
    s_mul_i32 s53, s72, 7
    s_sub_u32 s73, s45, s53
    s_and_b32 s70, s45, 1
    s_and_b32 s75, s46, 1
    s_lshr_b32 s74, s46, 1
    s_lshr_b32 s76, s72, 1
    s_mov_b32 s52, 0
    s_mov_b32 s60, 0
    s_mov_b32 s61, -1
    s_getreg_b32 s50, hwreg(HW_REG_XCC_ID, 0, 4)
    s_or_b32 s50, s50, 0x100
    v_and_b32 v26, 31, v1
    v_lshlrev_b32 v30, 4, v26
    v_lshlrev_b32 v27, 7, v26
    v_add_u32 v27, s58, v27
    v_bfe_u32 v26, v1, 1, 3
    v_lshrrev_b32 v28, 5, v1
    v_mul_u32_u24 v29, 7168, v28
    v_add_u32 v30, v30, v29
    v_xor_b32 v26, v26, v28
    v_xor_b32 v28, 0, v26
    v_lshl_add_u32 v8, v28, 4, v27
    v_xor_b32 v28, 2, v26
    v_lshl_add_u32 v9, v28, 4, v27
    v_xor_b32 v28, 4, v26
    v_lshl_add_u32 v10, v28, 4, v27
    v_xor_b32 v28, 6, v26
    v_lshl_add_u32 v11, v28, 4, v27
    v_lshrrev_b32 v12, 5, v1
    v_mul_u32_u24 v12, 8, v12
    v_bfe_u32 v26, v1, 2, 2
    v_add_u32 v12, v12, v26
    v_mul_u32_u24 v12, 128, v12
    v_bfe_u32 v26, v1, 4, 1
    v_mul_u32_u24 v26, 32, v26
    v_add_u32 v12, v12, v26
    v_and_b32_e64 v26, 3, v1
    v_lshl_add_u32 v12, v26, 3, v12
    v_bfe_u32 v26, v1, 3, 1
    v_lshlrev_b32 v26, 6, v26
    v_add_u32 v12, 106496, v12
    v_xor_b32 v27, 64, v26
    v_add_u32 v13, v12, v27
    v_add_u32 v12, v12, v26
    s_lshl_b32 s53, s46, 11
    v_add_u32 v5, s53, v12
    v_add_u32 v6, s53, v13
    v_add_u32 v7, 95232, v2
    s_lshl_b32 s53, s46, 2
    v_add_u32 v3, s53, v7
    v_lshrrev_b32 v14, 5, v1
    v_mul_u32_u24 v14, 8, v14
    v_bfe_u32 v26, v1, 2, 2
    v_add_u32 v14, v14, v26
    v_mul_u32_u24 v14, 64, v14
    v_bfe_u32 v26, v1, 4, 1
    v_mul_u32_u24 v26, 32, v26
    v_add_u32 v14, v14, v26
    v_and_b32 v26, 3, v1
    v_lshl_add_u32 v14, v26, 3, v14
    v_add_u32 v14, 65536, v14
    v_mov_b32 v16, 1065369472
    v_mov_b32 v17, 1065369472
    v_cndmask_b32 v18, v16, 0, s[60:61]
    v_mov_b32_e64 v19, 0
    s_mov_b32 s62, 572662306
    s_mov_b32 s63, 572662306
    s_mov_b32 s64, 1145324612
    s_mov_b32 s65, 1145324612
    s_mov_b32 s66, 2290649224
    s_mov_b32 s67, 2290649224
    v_and_b32 v4, 1, v1
    v_min_u32 v4, s44, v4
    v_sub_u32 v4, s44, v4
    v_lshlrev_b32 v4, 2, v4
L_visit0_back:
    s_cmp_ge_u32 s48, 14
    s_cbranch_scc1 L_formN_38
    s_cmp_ge_u32 s48, 7
    s_cbranch_scc1 L_formV_37
    s_branch L_formK
    .p2align 12
L_page0:
L_nogate_1:
    s_waitcnt vmcnt(0)
    s_branch L_gated_2
L_pgS_skip:
    s_mul_i32 s57, s68, 28672
    s_mul_i32 s53, s48, 448
    s_add_u32 s57, s57, s53
    s_lshl_b32 s71, s72, 1
    s_add_u32 s71, s71, s75
    s_lshl_b32 s68, s44, 3
    s_add_u32 s68, s68, s71
    s_cmp_eq_u32 s46, 0
    s_cbranch_scc1 L_pg0
    s_cmp_eq_u32 s46, 1
    s_cbranch_scc1 L_pg1
    s_cmp_eq_u32 s46, 2
    s_cbranch_scc1 L_pg2
    s_cmp_eq_u32 s46, 3
    s_cbranch_scc1 L_pg3
L_visit1_back:
    s_waitcnt vmcnt(0)
    s_barrier
    s_lshl_b32 s53, s48, 2
    s_add_u32 s53, s53, s46
    s_mul_i32 s53, s53, 6272
    buffer_load_dwordx4 v[160:163], v11, s[16:19], s53 offen offset:0
    buffer_load_dwordx4 v[164:167], v11, s[16:19], s53 offen offset:128
    buffer_load_dwordx4 v[168:171], v11, s[16:19], s53 offen offset:256
    buffer_load_dwordx4 v[172:175], v11, s[16:19], s53 offen offset:384
    buffer_load_dwordx4 v[176:179], v11, s[16:19], s53 offen offset:512
    buffer_load_dwordx4 v[180:183], v11, s[16:19], s53 offen offset:640
    buffer_load_dwordx4 v[184:187], v11, s[16:19], s53 offen offset:768
    s_lshl_b32 s53, s44, 2
    s_add_u32 s53, s53, s72
    s_lshl_b32 s53, s53, 2
    s_add_u32 s53, s53, s46
    s_mul_i32 s53, s53, 14336
    s_lshl_b32 s54, s73, 7
    s_add_u32 s53, s53, s54
    s_cmp_lt_u32 s45, 28
    s_cselect_b32 s53, s53, 0x7f000000
    s_add_u32 m0, s55, 98304
    s_nop 0
    buffer_load_dwordx4 v12, s[8:11], s53 offen offset:0  lds
    buffer_load_dwordx4 v13, s[8:11], s53 offen offset:1024  lds
    s_cmp_ge_u32 s45, 28
    s_cbranch_scc1 L_nogate_1
    s_add_u32 s55, s44, 0
    s_cmp_ge_u32 s55, 7
    s_cselect_b32 s56, 7, 0
    s_sub_u32 s55, s55, s56
    s_lshl_b32 s55, s55, 2
    s_add_u32 s55, s55, s46
    s_lshl_b32 s56, s55, 11
    s_add_u32 m0, s56, 106496
    s_mul_i32 s55, s55, 57344
    s_lshl_b32 s56, s45, 7
    s_add_u32 s55, s55, s56
    buffer_load_dwordx4 v30, s[20:23], s55 offen offset:0  lds
    buffer_load_dwordx4 v31, s[20:23], s55 offen offset:1024  lds
    s_add_u32 s55, s44, 1
    s_cmp_ge_u32 s55, 7
    s_cselect_b32 s56, 7, 0
    s_sub_u32 s55, s55, s56
    s_lshl_b32 s55, s55, 2
    s_add_u32 s55, s55, s46
    s_lshl_b32 s56, s55, 11
    s_add_u32 m0, s56, 106496
    s_mul_i32 s55, s55, 57344
    s_lshl_b32 s56, s45, 7
    s_add_u32 s55, s55, s56
    buffer_load_dwordx4 v30, s[20:23], s55 offen offset:0  lds
    buffer_load_dwordx4 v31, s[20:23], s55 offen offset:1024  lds
L_gated_2:
    s_waitcnt vmcnt(4)
    v_lshlrev_b32 v28, 16, v160
    v_and_b32 v29, 0xffff0000, v160
    v_add_f32 v26, v28, v29
    v_lshlrev_b32 v28, 16, v161
    v_and_b32 v29, 0xffff0000, v161
    v_add_f32 v27, v28, v29
    v_lshlrev_b32 v28, 16, v162
    v_and_b32 v29, 0xffff0000, v162
    v_add_f32 v26, v26, v28
    v_add_f32 v26, v26, v29
    v_lshlrev_b32 v28, 16, v163
    v_and_b32 v29, 0xffff0000, v163
    v_add_f32 v27, v27, v28
    v_add_f32 v27, v27, v29
    v_lshlrev_b32 v28, 16, v164
    v_and_b32 v29, 0xffff0000, v164
    v_add_f32 v26, v26, v28
    v_add_f32 v26, v26, v29
    v_lshlrev_b32 v28, 16, v165
    v_and_b32 v29, 0xffff0000, v165
    v_add_f32 v27, v27, v28
    v_add_f32 v27, v27, v29
    v_lshlrev_b32 v28, 16, v166
    v_and_b32 v29, 0xffff0000, v166
    v_add_f32 v26, v26, v28
    v_add_f32 v26, v26, v29
    v_lshlrev_b32 v28, 16, v167
    v_and_b32 v29, 0xffff0000, v167
    v_add_f32 v27, v27, v28
    v_add_f32 v27, v27, v29
    v_lshlrev_b32 v28, 16, v168
    v_and_b32 v29, 0xffff0000, v168
    v_add_f32 v26, v26, v28
    v_add_f32 v26, v26, v29
    v_lshlrev_b32 v28, 16, v169
    v_and_b32 v29, 0xffff0000, v169
    v_add_f32 v27, v27, v28
    v_add_f32 v27, v27, v29
    v_lshlrev_b32 v28, 16, v170
    v_and_b32 v29, 0xffff0000, v170
    v_add_f32 v26, v26, v28
    v_add_f32 v26, v26, v29
    v_lshlrev_b32 v28, 16, v171
    v_and_b32 v29, 0xffff0000, v171
    v_add_f32 v27, v27, v28
    v_add_f32 v27, v27, v29
    v_lshlrev_b32 v28, 16, v172
    v_and_b32 v29, 0xffff0000, v172
    v_add_f32 v26, v26, v28
    v_add_f32 v26, v26, v29
    v_lshlrev_b32 v28, 16, v173
    v_and_b32 v29, 0xffff0000, v173
    v_add_f32 v27, v27, v28
    v_add_f32 v27, v27, v29
    v_lshlrev_b32 v28, 16, v174
    v_and_b32 v29, 0xffff0000, v174
    v_add_f32 v26, v26, v28
    v_add_f32 v26, v26, v29
    v_lshlrev_b32 v28, 16, v175
    v_and_b32 v29, 0xffff0000, v175
    v_add_f32 v27, v27, v28
    v_add_f32 v27, v27, v29
    v_lshlrev_b32 v28, 16, v176
    v_and_b32 v29, 0xffff0000, v176
    v_add_f32 v26, v26, v28
    v_add_f32 v26, v26, v29
    v_lshlrev_b32 v28, 16, v177
    v_and_b32 v29, 0xffff0000, v177
    v_add_f32 v27, v27, v28
    v_add_f32 v27, v27, v29
    v_lshlrev_b32 v28, 16, v178
    v_and_b32 v29, 0xffff0000, v178
    v_add_f32 v26, v26, v28
    v_add_f32 v26, v26, v29
    v_lshlrev_b32 v28, 16, v179
    v_and_b32 v29, 0xffff0000, v179
    v_add_f32 v27, v27, v28
    v_add_f32 v27, v27, v29
    v_lshlrev_b32 v28, 16, v180
    v_and_b32 v29, 0xffff0000, v180
    v_add_f32 v26, v26, v28
    v_add_f32 v26, v26, v29
    v_lshlrev_b32 v28, 16, v181
    v_and_b32 v29, 0xffff0000, v181
    v_add_f32 v27, v27, v28
    v_add_f32 v27, v27, v29
    v_lshlrev_b32 v28, 16, v182
    v_and_b32 v29, 0xffff0000, v182
    v_add_f32 v26, v26, v28
    v_add_f32 v26, v26, v29
    v_lshlrev_b32 v28, 16, v183
    v_and_b32 v29, 0xffff0000, v183
    v_add_f32 v27, v27, v28
    v_add_f32 v27, v27, v29
    v_lshlrev_b32 v28, 16, v184
    v_and_b32 v29, 0xffff0000, v184
    v_add_f32 v26, v26, v28
    v_add_f32 v26, v26, v29
    v_lshlrev_b32 v28, 16, v185
    v_and_b32 v29, 0xffff0000, v185
    v_add_f32 v27, v27, v28
    v_add_f32 v27, v27, v29
    v_lshlrev_b32 v28, 16, v186
    v_and_b32 v29, 0xffff0000, v186
    v_add_f32 v26, v26, v28
    v_add_f32 v26, v26, v29
    v_lshlrev_b32 v28, 16, v187
    v_and_b32 v29, 0xffff0000, v187
    v_add_f32 v27, v27, v28
    v_add_f32 v27, v27, v29
    v_add_f32 v26, v26, v27
    s_nop 1
    v_add_f32_dpp v26, v26, v26 quad_perm:[1,0,3,2] row_mask:0xf bank_mask:0xf
    s_nop 1
    v_add_f32_dpp v26, v26, v26 quad_perm:[2,3,0,1] row_mask:0xf bank_mask:0xf
    s_nop 1
    v_add_f32_dpp v26, v26, v26 row_half_mirror row_mask:0xf bank_mask:0xf
    v_mul_f32 v26, 991054117, v26
    s_mov_b32 s62, 0
    s_mov_b32 s63, 0xff000000
    v_cndmask_b32 v26, v26, 0, s[62:63]
    s_mul_i32 s53, s46, 7
    s_add_u32 s54, s46, 28
    v_lshrrev_b32 v27, 3, v1
    v_add_u32 v27, s53, v27
    v_mov_b32 v28, s54
    v_cndmask_b32 v27, v27, v28, s[62:63]
    v_lshlrev_b32_e64 v27, 2, v27
    v_add_u32 v27, 94208, v27
    ds_write_b32 v27, v26
    s_cmp_ge_u32 s45, 28
    s_cbranch_scc1 L_nogate_3
    s_waitcnt vmcnt(3)
    s_add_u32 s55, s44, 2
    s_cmp_ge_u32 s55, 7
    s_cselect_b32 s56, 7, 0
    s_sub_u32 s55, s55, s56
    s_lshl_b32 s55, s55, 2
    s_add_u32 s55, s55, s46
    s_lshl_b32 s56, s55, 11
    s_add_u32 m0, s56, 106496
    s_mul_i32 s55, s55, 57344
    s_lshl_b32 s56, s45, 7
    s_add_u32 s55, s55, s56
    buffer_load_dwordx4 v30, s[20:23], s55 offen offset:0  lds
    s_waitcnt vmcnt(3)
    buffer_load_dwordx4 v31, s[20:23], s55 offen offset:1024  lds
    s_waitcnt vmcnt(3)
    s_add_u32 s55, s44, 3
    s_cmp_ge_u32 s55, 7
    s_cselect_b32 s56, 7, 0
    s_sub_u32 s55, s55, s56
    s_lshl_b32 s55, s55, 2
    s_add_u32 s55, s55, s46
    s_lshl_b32 s56, s55, 11
    s_add_u32 m0, s56, 106496
    s_mul_i32 s55, s55, 57344
    s_lshl_b32 s56, s45, 7
    s_add_u32 s55, s55, s56
    buffer_load_dwordx4 v30, s[20:23], s55 offen offset:0  lds
    s_waitcnt vmcnt(3)
    buffer_load_dwordx4 v31, s[20:23], s55 offen offset:1024  lds
L_nogate_3:
    s_waitcnt lgkmcnt(0)
    s_barrier
    s_mov_b32 exec_lo, 0x0fffffff
    s_mov_b32 exec_hi, 0x0fffffff
    s_sub_u32 s54, s57, 229376
    s_cmp_ge_u32 s49, 2
    s_cselect_b32 s54, s54, 0x7f000000
    s_add_u32 m0, s58, 0
    s_nop 0
    buffer_load_dwordx4 v16, s[40:43], s54 offen offset:2048 sc1 lds
    buffer_load_dwordx4 v17, s[40:43], s54 offen offset:3072 sc1 lds
    s_sub_u32 s54, s57, 114688
    s_cmp_ge_u32 s49, 1
    s_cselect_b32 s54, s54, 0x7f000000
    s_add_u32 m0, s58, 16384
    s_nop 0
    buffer_load_dwordx4 v16, s[40:43], s54 offen offset:2048 sc1 lds
    buffer_load_dwordx4 v17, s[40:43], s54 offen offset:3072 sc1 lds
    s_sub_u32 s54, s57, 0
    s_add_u32 m0, s58, 32768
    s_nop 0
    buffer_load_dwordx4 v16, s[40:43], s54 offen offset:2048 sc1 lds
    buffer_load_dwordx4 v17, s[40:43], s54 offen offset:3072 sc1 lds
    s_mov_b64 exec, -1
    s_cmp_ge_u32 s45, 28
    s_cbranch_scc1 L_helper
    ds_read_b64 v[224:225], v21 offset:0
    ds_read_b64 v[226:227], v21 offset:16
    ds_read_b64 v[228:229], v21 offset:32
    ds_read_b64 v[230:231], v21 offset:48
    s_mul_i32 s53, s46, 4096
    s_add_u32 m0, s53, 49152
    s_mul_i32 s53, s46, 28672
    s_lshl_b32 s54, s73, 7
    s_add_u32 s53, s53, s54
    s_add_u32 s53, s53, 0
    buffer_load_dwordx4 v12, s[16:19], s53 offen offset:0  lds
    buffer_load_dwordx4 v13, s[16:19], s53 offen offset:1024  lds
    buffer_load_dwordx4 v14, s[16:19], s53 offen offset:2048  lds
    buffer_load_dwordx4 v15, s[16:19], s53 offen offset:3072  lds
    s_waitcnt lgkmcnt(0)
    v_lshlrev_b32 v240, 16, v224
    v_and_b32 v241, 0xffff0000, v224
    v_lshlrev_b32 v242, 16, v225
    v_and_b32 v243, 0xffff0000, v225
    v_lshlrev_b32 v244, 16, v226
    v_and_b32 v245, 0xffff0000, v226
    v_lshlrev_b32 v246, 16, v227
    v_and_b32 v247, 0xffff0000, v227
    v_lshlrev_b32 v248, 16, v228
    v_and_b32 v249, 0xffff0000, v228
    v_lshlrev_b32 v250, 16, v229
    v_and_b32 v251, 0xffff0000, v229
    v_lshlrev_b32 v252, 16, v230
    v_and_b32 v253, 0xffff0000, v230
    v_lshlrev_b32 v254, 16, v231
    v_and_b32 v255, 0xffff0000, v231
    v_mov_b32 v26, 0xbf80bf80
    s_barrier
    s_mul_i32 s53, s46, 4096
    s_add_u32 m0, s53, 65536
    s_mul_i32 s53, s46, 28672
    s_lshl_b32 s54, s73, 7
    s_add_u32 s53, s53, s54
    s_add_u32 s53, s53, 114688
    buffer_load_dwordx4 v12, s[16:19], s53 offen offset:0  lds
    buffer_load_dwordx4 v13, s[16:19], s53 offen offset:1024  lds
    buffer_load_dwordx4 v14, s[16:19], s53 offen offset:2048  lds
    buffer_load_dwordx4 v15, s[16:19], s53 offen offset:3072  lds
    s_mul_i32 s53, s46, 4096
    s_add_u32 m0, s53, 81920
    s_mul_i32 s53, s46, 28672
    s_lshl_b32 s54, s73, 7
    s_add_u32 s53, s53, s54
    s_add_u32 s53, s53, 229376
    buffer_load_dwordx4 v12, s[16:19], s53 offen offset:0  lds
    buffer_load_dwordx4 v13, s[16:19], s53 offen offset:1024  lds
    buffer_load_dwordx4 v14, s[16:19], s53 offen offset:2048  lds
    buffer_load_dwordx4 v15, s[16:19], s53 offen offset:3072  lds
    s_mul_i32 s53, s46, 2048
    s_add_u32 m0, s53, 98304
    s_mul_i32 s53, s46, 14336
    s_lshl_b32 s54, s73, 7
    s_add_u32 s53, s53, s54
    s_add_u32 s53, s53, 344064
    buffer_load_dwordx4 v12, s[16:19], s53 offen offset:0  lds
    buffer_load_dwordx4 v13, s[16:19], s53 offen offset:1024  lds
    s_add_u32 s55, s44, 4
    s_cmp_ge_u32 s55, 7
    s_cselect_b32 s56, 7, 0
    s_sub_u32 s55, s55, s56
    s_lshl_b32 s55, s55, 2
    s_add_u32 s55, s55, s46
    s_lshl_b32 s56, s55, 11
    s_add_u32 m0, s56, 106496
    s_mul_i32 s55, s55, 57344
    s_lshl_b32 s56, s45, 7
    s_add_u32 s55, s55, s56
    buffer_load_dwordx4 v30, s[20:23], s55 offen offset:0  lds
    buffer_load_dwordx4 v31, s[20:23], s55 offen offset:1024  lds
    s_add_u32 s55, s44, 5
    s_cmp_ge_u32 s55, 7
    s_cselect_b32 s56, 7, 0
    s_sub_u32 s55, s55, s56
    s_lshl_b32 s55, s55, 2
    s_add_u32 s55, s55, s46
    s_lshl_b32 s56, s55, 11
    s_add_u32 m0, s56, 106496
    s_mul_i32 s55, s55, 57344
    s_lshl_b32 s56, s45, 7
    s_add_u32 s55, s55, s56
    buffer_load_dwordx4 v30, s[20:23], s55 offen offset:0  lds
    buffer_load_dwordx4 v31, s[20:23], s55 offen offset:1024  lds
    s_waitcnt vmcnt(18)
    s_barrier
    s_lshl_b32 s53, s44, 5
    s_add_u32 s53, s53, s45
    s_lshl_b32 s53, s53, 2
    s_add_u32 s53, s53, s46
    s_lshl_b32 s53, s53, 11
    s_add_u32 s53, s53, 4194304
    s_mov_b32 exec_lo, 65535
    s_mov_b32 exec_hi, 0
    buffer_load_dword v25, v24, s[40:43], s53 offen sc1
    s_mov_b64 exec, -1
    s_add_u32 s55, s44, 6
    s_cmp_ge_u32 s55, 7
    s_cselect_b32 s56, 7, 0
    s_sub_u32 s55, s55, s56
    s_lshl_b32 s55, s55, 2
    s_add_u32 s55, s55, s46
    s_lshl_b32 s56, s55, 11
    s_add_u32 m0, s56, 106496
    s_mul_i32 s55, s55, 57344
    s_lshl_b32 s56, s45, 7
    s_add_u32 s55, s55, s56
    buffer_load_dwordx4 v30, s[20:23], s55 offen offset:0  lds
    buffer_load_dwordx4 v31, s[20:23], s55 offen offset:1024  lds
    s_waitcnt vmcnt(7)
    s_barrier
    ds_read_b64_tr_b16 v[32:33], v18 offset:0
    ds_read_b64_tr_b16 v[34:35], v18 offset:1024
    ds_read_b64_tr_b16 v[36:37], v19 offset:0
    ds_read_b64_tr_b16 v[38:39], v19 offset:1024
    ds_read_b64_tr_b16 v[40:41], v18 offset:2048
    ds_read_b64_tr_b16 v[42:43], v18 offset:3072
    ds_read_b64_tr_b16 v[44:45], v19 offset:2048
    ds_read_b64_tr_b16 v[46:47], v19 offset:3072
    ds_read_b64_tr_b16 v[48:49], v18 offset:3584
    ds_read_b64_tr_b16 v[50:51], v18 offset:4608
    ds_read_b64_tr_b16 v[52:53], v19 offset:3584
    ds_read_b64_tr_b16 v[54:55], v19 offset:4608
    ds_read_b64_tr_b16 v[56:57], v18 offset:5632
    ds_read_b64_tr_b16 v[58:59], v18 offset:6656
    ds_read_b64_tr_b16 v[60:61], v19 offset:5632
    ds_read_b64_tr_b16 v[62:63], v19 offset:6656
    ds_read_b64_tr_b16 v[64:65], v18 offset:7168
    ds_read_b64_tr_b16 v[66:67], v18 offset:8192
    ds_read_b64_tr_b16 v[68:69], v19 offset:7168
    ds_read_b64_tr_b16 v[70:71], v19 offset:8192
    ds_read_b64_tr_b16 v[72:73], v18 offset:9216
    ds_read_b64_tr_b16 v[74:75], v18 offset:10240
    ds_read_b64_tr_b16 v[76:77], v19 offset:9216
    ds_read_b64_tr_b16 v[78:79], v19 offset:10240
    ds_read_b64_tr_b16 v[80:81], v18 offset:10752
    ds_read_b64_tr_b16 v[82:83], v18 offset:11776
    ds_read_b64_tr_b16 v[84:85], v19 offset:10752
    ds_read_b64_tr_b16 v[86:87], v19 offset:11776
    ds_read_b64_tr_b16 v[88:89], v18 offset:12800
    ds_read_b64_tr_b16 v[90:91], v18 offset:13824
    ds_read_b64_tr_b16 v[92:93], v19 offset:12800
    ds_read_b64_tr_b16 v[94:95], v19 offset:13824
    ds_read_b64_tr_b16 v[96:97], v18 offset:14336
    ds_read_b64_tr_b16 v[98:99], v18 offset:15360
    ds_read_b64_tr_b16 v[100:101], v19 offset:14336
    ds_read_b64_tr_b16 v[102:103], v19 offset:15360
    ds_read_b64_tr_b16 v[104:105], v18 offset:16384
    ds_read_b64_tr_b16 v[106:107], v18 offset:17408
    ds_read_b64_tr_b16 v[108:109], v19 offset:16384
    ds_read_b64_tr_b16 v[110:111], v19 offset:17408
    ds_read_b64_tr_b16 v[112:113], v18 offset:17920
    ds_read_b64_tr_b16 v[114:115], v18 offset:18944
    ds_read_b64_tr_b16 v[116:117], v19 offset:17920
    ds_read_b64_tr_b16 v[118:119], v19 offset:18944
    ds_read_b64_tr_b16 v[120:121], v18 offset:19968
    ds_read_b64_tr_b16 v[122:123], v18 offset:20992
    ds_read_b64_tr_b16 v[124:125], v19 offset:19968
    ds_read_b64_tr_b16 v[126:127], v19 offset:20992
    ds_read_b64_tr_b16 v[128:129], v18 offset:21504
    ds_read_b64_tr_b16 v[130:131], v18 offset:22528
    ds_read_b64_tr_b16 v[132:133], v19 offset:21504
    ds_read_b64_tr_b16 v[134:135], v19 offset:22528
    ds_read_b64_tr_b16 v[136:137], v18 offset:23552
    ds_read_b64_tr_b16 v[138:139], v18 offset:24576
    ds_read_b64_tr_b16 v[140:141], v19 offset:23552
    ds_read_b64_tr_b16 v[142:143], v19 offset:24576
    ds_read_b64_tr_b16 v[144:145], v18 offset:25088
    ds_read_b64_tr_b16 v[146:147], v18 offset:26112
    ds_read_b64_tr_b16 v[148:149], v19 offset:25088
    ds_read_b64_tr_b16 v[150:151], v19 offset:26112
    ds_read_b64_tr_b16 v[152:153], v18 offset:27136
    ds_read_b64_tr_b16 v[154:155], v18 offset:28160
    ds_read_b64_tr_b16 v[156:157], v19 offset:27136
    ds_read_b64_tr_b16 v[158:159], v19 offset:28160
    s_setprio 1
    v_lshlrev_b32 v3, 2, v1
    v_add_u32 v3, 3584, v3
    s_mov_b32 exec_hi, 0
    buffer_load_dword v22, v3, s[40:43], s77 offen sc1
    s_mov_b64 exec, -1
    s_waitcnt lgkmcnt(0)
    v_cndmask_b32 v42, v42, v26, s[60:61]
    v_cndmask_b32 v43, v43, 0, s[60:61]
    v_cndmask_b32 v46, v46, v26, s[60:61]
    v_cndmask_b32 v47, v47, 0, s[60:61]
    v_cndmask_b32 v58, v58, v26, s[60:61]
    v_cndmask_b32 v59, v59, 0, s[60:61]
    v_cndmask_b32 v62, v62, v26, s[60:61]
    v_cndmask_b32 v63, v63, 0, s[60:61]
    v_cndmask_b32 v74, v74, v26, s[60:61]
    v_cndmask_b32 v75, v75, 0, s[60:61]
    v_cndmask_b32 v78, v78, v26, s[60:61]
    v_cndmask_b32 v79, v79, 0, s[60:61]
    v_cndmask_b32 v90, v90, v26, s[60:61]
    v_cndmask_b32 v91, v91, 0, s[60:61]
    v_cndmask_b32 v94, v94, v26, s[60:61]
    v_cndmask_b32 v95, v95, 0, s[60:61]
    v_cndmask_b32 v106, v106, v26, s[60:61]
    v_cndmask_b32 v107, v107, 0, s[60:61]
    v_cndmask_b32 v110, v110, v26, s[60:61]
    v_cndmask_b32 v111, v111, 0, s[60:61]
    v_cndmask_b32 v122, v122, v26, s[60:61]
    v_cndmask_b32 v123, v123, 0, s[60:61]
    v_cndmask_b32 v126, v126, v26, s[60:61]
    v_cndmask_b32 v127, v127, 0, s[60:61]
    v_cndmask_b32 v138, v138, v26, s[60:61]
    v_cndmask_b32 v139, v139, 0, s[60:61]
    v_cndmask_b32 v142, v142, v26, s[60:61]
    v_cndmask_b32 v143, v143, 0, s[60:61]
    v_cndmask_b32 v154, v154, v26, s[60:61]
    v_cndmask_b32 v155, v155, 0, s[60:61]
    v_cndmask_b32 v158, v158, v26, s[60:61]
    v_cndmask_b32 v159, v159, 0, s[60:61]
    s_waitcnt vmcnt(0)
    s_mov_b32 exec_hi, 0
    v_cmp_eq_u32 vcc, 0, v22
    s_cbranch_vccz L_ok_5
L_poll_6:
    buffer_load_dword v22, v3, s[40:43], s77 offen sc1
    s_add_u32 s52, s52, 1
    s_waitcnt vmcnt(0)
    v_cmp_eq_u32 vcc, 0, v22
    s_cmp_gt_u32 s52, 4194304
    s_cbranch_scc1 L_polled_7
    s_cbranch_vccnz L_poll_6
L_polled_7:
L_ok_5:
    v_cmp_ne_u32 vcc, s50, v22
    s_mov_b64 exec, -1
    s_cmp_eq_u64 vcc, 0
    s_cselect_b32 s51, 1, 0
    v_lshlrev_b32 v26, 2, v1
    s_lshl_b32 s53, s71, 2
    s_add_u32 s53, s53, s74
    s_lshl_b32 s53, s53, 5
    s_add_u32 s53, s53, s77
    s_lshl_b32 s55, s68, 1
    s_add_u32 s55, s55, s74
    s_lshl_b32 s55, s55, 14
    s_add_u32 s55, s55, 4194304
    s_lshl_b32 s54, s73, 1
    s_add_u32 s54, s54, s74
    s_mul_i32 s57, s68, 14
    s_add_u32 s57, s57, s54
    s_lshl_b32 s57, s57, 11
    s_add_u32 s57, s57, 6291456
    s_lshl_b32 s58, s68, 4
    s_add_u32 s58, s58, s54
    s_lshl_b32 s58, s58, 7
    s_add_u32 s58, s58, 8126464
    s_lshl_b32 s56, s71, 5
    s_add_u32 s56, s56, s54
    s_lshl_b32 s56, s56, 2
    s_add_u32 s56, s56, s77
    s_mov_b64 exec, 0xff
L_poll_8:
    buffer_load_dword v27, v26, s[40:43], s53 offen sc1
    s_add_u32 s52, s52, 1
    s_waitcnt vmcnt(0)
    v_cmp_ne_u32 vcc, 1, v27
    s_cmp_gt_u32 s52, 4194304
    s_cbranch_scc1 L_polled_9
    s_cbranch_vccnz L_poll_8
L_polled_9:
    s_mov_b64 exec, -1
    buffer_load_dwordx4 v[160:163], v2, s[40:43], s55 offen offset:0 sc1
    buffer_load_dwordx4 v[164:167], v2, s[40:43], s55 offen offset:1024 sc1
    buffer_load_dwordx4 v[168:171], v2, s[40:43], s55 offen offset:2048 sc1
    buffer_load_dwordx4 v[172:175], v2, s[40:43], s55 offen offset:3072 sc1
    s_add_u32 s55, s55, 4096
    buffer_load_dwordx4 v[176:179], v2, s[40:43], s55 offen offset:0 sc1
    s_lshl_b32 s53, s46, 12
    v_add_u32 v26, s53, v2
    v_xor_b32 v27, 8192, v26
    s_waitcnt vmcnt(4)
    v_mfma_f32_32x32x16_bf16 v[224:239], v[36:39], v[160:163], 0
    buffer_load_dwordx4 v[180:183], v2, s[40:43], s55 offen offset:1024 sc1
    s_waitcnt vmcnt(4)
    v_mfma_f32_32x32x16_bf16 v[224:239], v[44:47], v[164:167], v[224:239]
    buffer_load_dwordx4 v[184:187], v2, s[40:43], s55 offen offset:2048 sc1
    s_waitcnt vmcnt(4)
    v_mfma_f32_32x32x16_bf16 v[224:239], v[52:55], v[168:171], v[224:239]
    buffer_load_dwordx4 v[188:191], v2, s[40:43], s55 offen offset:3072 sc1
    s_add_u32 s55, s55, 4096
    s_waitcnt vmcnt(4)
    v_mfma_f32_32x32x16_bf16 v[224:239], v[60:63], v[172:175], v[224:239]
    buffer_load_dwordx4 v[192:195], v2, s[40:43], s55 offen offset:0 sc1
    v_mfma_f32_32x32x16_bf16 v[240:255], v[32:35], v[160:163], v[240:255]
    s_waitcnt vmcnt(4)
    v_mfma_f32_32x32x16_bf16 v[224:239], v[68:71], v[176:179], v[224:239]
    buffer_load_dwordx4 v[196:199], v2, s[40:43], s55 offen offset:1024 sc1
    v_mfma_f32_32x32x16_bf16 v[240:255], v[40:43], v[164:167], v[240:255]
    s_waitcnt vmcnt(4)
    v_mfma_f32_32x32x16_bf16 v[224:239], v[76:79], v[180:183], v[224:239]
    buffer_load_dwordx4 v[200:203], v2, s[40:43], s55 offen offset:2048 sc1
    v_mfma_f32_32x32x16_bf16 v[240:255], v[48:51], v[168:171], v[240:255]
    s_waitcnt vmcnt(4)
    v_mfma_f32_32x32x16_bf16 v[224:239], v[84:87], v[184:187], v[224:239]
    buffer_load_dwordx4 v[204:207], v2, s[40:43], s55 offen offset:3072 sc1
    s_add_u32 s55, s55, 4096
    v_mfma_f32_32x32x16_bf16 v[240:255], v[56:59], v[172:175], v[240:255]
    s_waitcnt vmcnt(4)
    v_mfma_f32_32x32x16_bf16 v[224:239], v[92:95], v[188:191], v[224:239]
    buffer_load_dwordx4 v[208:211], v2, s[40:43], s55 offen offset:0 sc1
    v_mfma_f32_32x32x16_bf16 v[240:255], v[64:67], v[176:179], v[240:255]
    s_waitcnt vmcnt(4)
    v_mfma_f32_32x32x16_bf16 v[224:239], v[100:103], v[192:195], v[224:239]
    buffer_load_dwordx4 v[212:215], v2, s[40:43], s55 offen offset:1024 sc1
    v_mfma_f32_32x32x16_bf16 v[240:255], v[72:75], v[180:183], v[240:255]
    s_waitcnt vmcnt(4)
    v_mfma_f32_32x32x16_bf16 v[224:239], v[108:111], v[196:199], v[224:239]
    buffer_load_dwordx4 v[216:219], v2, s[40:43], s55 offen offset:2048 sc1
    v_mfma_f32_32x32x16_bf16 v[240:255], v[80:83], v[184:187], v[240:255]
    s_waitcnt vmcnt(4)
    v_mfma_f32_32x32x16_bf16 v[224:239], v[116:119], v[200:203], v[224:239]
    buffer_load_dwordx4 v[220:223], v2, s[40:43], s55 offen offset:3072 sc1
    s_add_u32 s55, s55, 4096
    s_barrier
    v_mfma_f32_32x32x16_bf16 v[240:255], v[88:91], v[188:191], v[240:255]
    s_waitcnt vmcnt(4)
    v_mfma_f32_32x32x16_bf16 v[224:239], v[124:127], v[204:207], v[224:239]
    v_mfma_f32_32x32x16_bf16 v[240:255], v[96:99], v[192:195], v[240:255]
    s_waitcnt vmcnt(3)
    v_mfma_f32_32x32x16_bf16 v[224:239], v[132:135], v[208:211], v[224:239]
    v_mfma_f32_32x32x16_bf16 v[240:255], v[104:107], v[196:199], v[240:255]
    s_waitcnt vmcnt(2)
    v_mfma_f32_32x32x16_bf16 v[224:239], v[140:143], v[212:215], v[224:239]
    v_mfma_f32_32x32x16_bf16 v[240:255], v[112:115], v[200:203], v[240:255]
    s_waitcnt vmcnt(1)
    v_mfma_f32_32x32x16_bf16 v[224:239], v[148:151], v[216:219], v[224:239]
    v_mfma_f32_32x32x16_bf16 v[240:255], v[120:123], v[204:207], v[240:255]
    s_waitcnt vmcnt(0)
    v_mfma_f32_32x32x16_bf16 v[224:239], v[156:159], v[220:223], v[224:239]
    v_mfma_f32_32x32x16_bf16 v[240:255], v[128:131], v[208:211], v[240:255]
    v_mfma_f32_32x32x16_bf16 v[240:255], v[136:139], v[212:215], v[240:255]
    v_mfma_f32_32x32x16_bf16 v[240:255], v[144:147], v[216:219], v[240:255]
    s_nop 8
    ds_write_b128 v26, v[224:227] offset:0
    ds_write_b128 v26, v[228:231] offset:1024
    ds_write_b128 v26, v[232:235] offset:2048
    ds_write_b128 v26, v[236:239] offset:3072
    v_mfma_f32_32x32x16_bf16 v[240:255], v[152:155], v[220:223], v[240:255]
    s_waitcnt lgkmcnt(0)
    s_barrier
    ds_read_b128 v[224:227], v27 offset:0
    ds_read_b128 v[228:231], v27 offset:1024
    ds_read_b128 v[232:235], v27 offset:2048
    ds_read_b128 v[236:239], v27 offset:3072
    s_waitcnt lgkmcnt(3)
    s_nop 4
    v_pk_add_f32 v[240:241], v[240:241], v[224:225]
    v_pk_add_f32 v[242:243], v[242:243], v[226:227]
    v_cvt_pk_bf16_f32 v32, v240, v241
    v_cvt_pk_bf16_f32 v33, v242, v243
    v_pk_mul_f32 v[28:29], v[240:241], v[240:241]
    v_pk_fma_f32 v[28:29], v[242:243], v[242:243], v[28:29]
    s_waitcnt lgkmcnt(2)
    v_pk_add_f32 v[244:245], v[244:245], v[228:229]
    v_pk_add_f32 v[246:247], v[246:247], v[230:231]
    v_cvt_pk_bf16_f32 v34, v244, v245
    v_cvt_pk_bf16_f32 v35, v246, v247
    s_cmp_eq_u32 s51, 0
    s_cbranch_scc1 L_slow_10
    buffer_store_dwordx4 v[32:35], v2, s[40:43], s57 offen offset:0
L_pubd_11:
    v_pk_fma_f32 v[28:29], v[244:245], v[244:245], v[28:29]
    v_pk_fma_f32 v[28:29], v[246:247], v[246:247], v[28:29]
    s_waitcnt lgkmcnt(1)
    v_pk_add_f32 v[248:249], v[248:249], v[232:233]
    v_pk_add_f32 v[250:251], v[250:251], v[234:235]
    v_cvt_pk_bf16_f32 v36, v248, v249
    v_cvt_pk_bf16_f32 v37, v250, v251
    v_pk_fma_f32 v[28:29], v[248:249], v[248:249], v[28:29]
    v_pk_fma_f32 v[28:29], v[250:251], v[250:251], v[28:29]
    s_waitcnt lgkmcnt(0)
    v_pk_add_f32 v[252:253], v[252:253], v[236:237]
    v_pk_add_f32 v[254:255], v[254:255], v[238:239]
    v_cvt_pk_bf16_f32 v38, v252, v253
    v_cvt_pk_bf16_f32 v39, v254, v255
    s_cmp_eq_u32 s51, 0
    s_cbranch_scc1 L_slow_12
    buffer_store_dwordx4 v[36:39], v2, s[40:43], s57 offen offset:1024
L_pubd_13:
    v_pk_fma_f32 v[28:29], v[252:253], v[252:253], v[28:29]
    v_pk_fma_f32 v[28:29], v[254:255], v[254:255], v[28:29]
    v_add_f32 v28, v28, v29
    v_mov_b32 v29, v28
    v_lshlrev_b32 v26, 2, v1
    s_nop 0
    v_permlane32_swap_b32 v28, v29
    v_add_f32 v28, v28, v29
    s_mov_b32 exec_hi, 0
    s_cmp_eq_u32 s51, 0
    s_cbranch_scc1 L_slow_14
    buffer_store_dword v28, v26, s[40:43], s58 offen
L_pubd_15:
    s_mov_b64 exec, -1
    v_mov_b32 v27, 1
    v_mov_b32 v29, 1065369472
    v_mov_b32 v17, 0
    v_dot2c_f32_bf16 v17, v166, v29
    v_dot2c_f32_bf16 v17, v174, v29
    v_dot2c_f32_bf16 v17, v182, v29
    v_dot2c_f32_bf16 v17, v190, v29
    v_dot2c_f32_bf16 v17, v198, v29
    v_dot2c_f32_bf16 v17, v206, v29
    v_dot2c_f32_bf16 v17, v214, v29
    v_dot2c_f32_bf16 v17, v222, v29
    s_waitcnt vmcnt(0)
    s_mov_b64 exec, 1
    s_cmp_eq_u32 s51, 0
    s_cbranch_scc1 L_slow_16
    buffer_store_dword v27, v26, s[40:43], s56 offen offset:1024
L_pubd_17:
    s_mov_b64 exec, -1
    v_mov_b32 v29, v17
    s_nop 1
    v_permlane32_swap_b32 v29, v17
    v_add_f32 v240, v17, v240
    v_add_f32 v241, v17, v241
    v_add_f32 v242, v17, v242
    v_add_f32 v243, v17, v243
    v_add_f32 v244, v17, v244
    v_add_f32 v245, v17, v245
    v_add_f32 v246, v17, v246
    v_add_f32 v247, v17, v247
    v_add_f32 v248, v17, v248
    v_add_f32 v249, v17, v249
    v_add_f32 v250, v17, v250
    v_add_f32 v251, v17, v251
    v_add_f32 v252, v17, v252
    v_add_f32 v253, v17, v253
    s_branch L_pg0_skip
    .p2align 12
L_pg0:
    s_branch L_pg4
    s_nop 0
L_pg0_skip:
    v_add_f32 v254, v17, v254
    v_add_f32 v255, v17, v255
    s_xor_b32 s53, s46, 2
    s_lshl_b32 s53, s53, 12
    v_add_u32 v27, s53, v2
    s_lshl_b32 s53, s46, 8
    v_add_u32_e64 v26, s53, v26
    ds_write_b128 v27, v[240:243] offset:0
    ds_write_b128 v27, v[244:247] offset:1024
    ds_write_b128 v27, v[248:251] offset:2048
    ds_write_b128 v27, v[252:255] offset:3072
    ds_write_b32 v26, v17 offset:16384
    v_lshrrev_b32 v4, 3, v1
    v_mul_u32_u24 v4, 896, v4
    v_lshrrev_b32 v26, 2, v1
    v_lshrrev_b32 v27, 4, v1
    v_xor_b32 v26, v26, v27
    v_and_b32 v26, 1, v26
    v_mul_u32_u24 v26, 64, v26
    v_add_u32 v4, v4, v26
    v_and_b32 v26, 3, v1
    v_lshl_add_u32 v4, v26, 4, v4
    v_add_u32 v5, 113664, v4
    v_add_u32 v6, 227328, v4
    v_add_u32 v7, 340992, v4
    v_lshrrev_b32 v8, 5, v1
    v_mul_u32_u24 v8, 4, v8
    v_bfe_u32 v26, v1, 2, 2
    v_add_u32_e64 v8, v8, v26
    v_mul_u32_u24 v8, 128, v8
    v_bfe_u32 v26, v1, 4, 1
    v_mul_u32_u24 v26, 32, v26
    v_add_u32 v8, v8, v26
    v_and_b32_e64 v26, 3, v1
    v_lshl_add_u32 v8, v26, 3, v8
    v_bfe_u32 v26, v1, 3, 1
    v_lshlrev_b32 v26, 6, v26
    v_xor_b32 v27, 64, v26
    s_mov_b32 s53, 106496
    s_mov_b32 s54, 49152
    v_add3_u32 v9, v8, v27, s53
    v_add3_u32 v10, v8, v26, s54
    v_add3_u32 v11, v8, v27, s54
    v_add3_u32 v8, v8, v26, s53
    v_lshrrev_b32 v26, 3, v1
    v_mul_u32_u24 v26, 13312, v26
    v_add_u32 v24, v24, v26
    v_lshrrev_b32 v12, 5, v1
    v_mul_u32_u24 v12, 4, v12
    v_bfe_u32 v26, v1, 2, 2
    v_add_u32_e64 v12, v12, v26
    v_mul_u32_u24 v12, 128, v12
    v_bfe_u32 v26, v1, 4, 1
    v_mul_u32_u24 v26, 32, v26
    v_add_u32 v12, v12, v26
    v_and_b32_e64 v26, 3, v1
    v_lshl_add_u32 v12, v26, 3, v12
    v_bfe_u32 v26, v1, 3, 1
    v_xor_b32 v26, s74, v26
    v_lshlrev_b32 v26, 6, v26
    v_xor_b32 v27, 64, v26
    v_add_u32 v13, v12, v27
    v_add_u32 v12, v12, v26
    s_mul_i32 s53, s74, 14336
    v_add_u32 v12, s53, v12
    v_add_u32_e64 v13, s53, v13
    s_xor_b32 s54, s72, 0
    s_lshl_b32 s54, s54, 1
    s_add_u32 s54, s54, s75
    s_lshl_b32 s59, s44, 3
    s_add_u32 s59, s59, s54
    s_lshl_b32 s54, s54, 5
    s_mul_i32 s53, s74, 14
    s_add_u32 s54, s54, s53
    s_sub_u32 s54, s54, s76
    s_add_u32 s54, s54, 1
    s_lshl_b32 s54, s54, 2
    s_add_u32 s54, s54, s77
    s_add_u32 s49, s54, 2048
    s_mul_i32 s79, s74, 802816
    s_mul_i32 s53, s75, 7168
    s_add_u32 s79, s79, s53
    s_lshl_b32 s53, s73, 7
    s_add_u32 s79, s79, s53
    s_xor_b32 s53, s76, 1
    s_mul_i32 s53, s53, 57344
    s_add_u32 s79, s79, s53
    s_mul_i32 s62, s46, 7168
    s_xor_b32 s71, s70, 1
    s_lshl_b32 s71, s71, 2
    s_add_u32 s71, s71, s46
    s_lshl_b32 s68, s44, 3
    s_add_u32 s68, s68, s71
    s_lshr_b32 s54, s45, 1
    s_lshl_b32 s54, s54, 10
    s_mul_i32 s53, s68, 57344
    s_add_u32 s53, s53, s54
    s_add_u32 s78, s53, 8388608
    s_mul_i32 s53, s68, 57344
    s_add_u32 s53, s53, s54
    s_add_u32 s69, s53, 8417280
    s_lshl_b32 s53, s71, 5
    s_add_u32 s53, s53, s45
    s_lshl_b32 s53, s53, 2
    s_add_u32 s53, s53, s77
    s_add_u32 s48, s53, 2048
    v_lshlrev_b32 v21, 2, v1
    v_lshlrev_b32 v22, 3, v1
    v_and_b32 v20, 31, v1
    v_mul_u32_u24 v20, 896, v20
    v_lshrrev_b32 v27, 5, v1
    v_lshl_add_u32 v20, v27, 4, v20
    s_lshl_b32 s53, s44, 2
    s_add_u32 s53, s53, s72
    s_lshl_b32 s53, s53, 1
    s_add_u32 s53, s53, s75
    s_mul_i32 s3, s53, 28672
    s_lshl_b32 s54, s73, 1
    s_add_u32 s54, s54, s74
    s_lshl_b32 s54, s54, 6
    s_add_u32 s3, s3, s54
    ds_read_b64_tr_b16 v[192:193], v8 offset:0
    ds_read_b64_tr_b16 v[194:195], v8 offset:1024
    ds_read_b64_tr_b16 v[196:197], v9 offset:0
    ds_read_b64_tr_b16 v[198:199], v9 offset:1024
    ds_read_b64_tr_b16 v[200:201], v8 offset:2048
    ds_read_b64_tr_b16 v[202:203], v8 offset:3072
    ds_read_b64_tr_b16 v[204:205], v9 offset:2048
    ds_read_b64_tr_b16 v[206:207], v9 offset:3072
    ds_read_b64_tr_b16 v[208:209], v8 offset:4096
    ds_read_b64_tr_b16 v[210:211], v8 offset:5120
    ds_read_b64_tr_b16 v[212:213], v9 offset:4096
    ds_read_b64_tr_b16 v[214:215], v9 offset:5120
    s_lshl_b32 s53, s71, 7
    s_add_u32 s53, s53, s77
    s_add_u32 s53, s53, 1024
    s_mul_i32 s57, s68, 28672
    s_add_u32 s57, s57, 6291456
    s_lshl_b32 s58, s68, 11
    s_add_u32 s58, s58, 8126464
    s_mov_b64 exec, 0x3fff
L_poll_18:
    buffer_load_dword v23, v21, s[40:43], s53 offen sc1
    s_add_u32 s52, s52, 1
    s_waitcnt vmcnt(0)
    v_cmp_ne_u32 vcc, 1, v23
    s_cmp_gt_u32 s52, 4194304
    s_cbranch_scc1 L_polled_19
    s_cbranch_vccnz L_poll_18
L_polled_19:
    s_mov_b64 exec, -1
    s_add_u32 s55, s44, 2
    s_cmp_ge_u32 s55, 7
    s_cselect_b32 s56, 7, 0
    s_sub_u32 s55, s55, s56
    s_lshl_b32 s55, s55, 2
    s_add_u32 s55, s55, s46
    s_lshl_b32 s56, s55, 11
    s_add_u32 m0, s56, 49152
    s_mul_i32 s55, s55, 57344
    s_lshl_b32 s56, s45, 7
    s_add_u32 s55, s55, s56
    buffer_load_dwordx4 v30, s[24:27], s55 offen offset:0  lds
    buffer_load_dwordx4 v31, s[24:27], s55 offen offset:1024  lds
    s_add_u32 s55, s44, 3
    s_cmp_ge_u32 s55, 7
    s_cselect_b32 s56, 7, 0
    s_sub_u32 s55, s55, s56
    s_lshl_b32 s55, s55, 2
    s_add_u32 s55, s55, s46
    s_lshl_b32 s56, s55, 11
    s_add_u32 m0, s56, 49152
    s_mul_i32 s55, s55, 57344
    s_lshl_b32 s56, s45, 7
    s_add_u32 s55, s55, s56
    buffer_load_dwordx4 v30, s[24:27], s55 offen offset:0  lds
    buffer_load_dwordx4 v31, s[24:27], s55 offen offset:1024  lds
    s_barrier
    s_setprio 1
    buffer_load_dwordx4 v[32:35], v2, s[40:43], s57 offen offset:0 sc1
    buffer_load_dwordx4 v[36:39], v2, s[40:43], s57 offen offset:1024 sc1
    buffer_load_dwordx4 v[40:43], v2, s[40:43], s57 offen offset:2048 sc1
    buffer_load_dwordx4 v[44:47], v2, s[40:43], s57 offen offset:3072 sc1
    s_add_u32 s57, s57, 4096
    buffer_load_dwordx4 v[48:51], v2, s[40:43], s57 offen offset:0 sc1
    buffer_load_dwordx4 v[52:55], v2, s[40:43], s57 offen offset:1024 sc1
    buffer_load_dwordx4 v[56:59], v2, s[40:43], s57 offen offset:2048 sc1
    buffer_load_dwordx4 v[60:63], v2, s[40:43], s57 offen offset:3072 sc1
    s_add_u32 s57, s57, 4096
    buffer_load_dwordx4 v[64:67], v2, s[40:43], s57 offen offset:0 sc1
    buffer_load_dwordx4 v[68:71], v2, s[40:43], s57 offen offset:1024 sc1
    buffer_load_dwordx4 v[72:75], v2, s[40:43], s57 offen offset:2048 sc1
    buffer_load_dwordx4 v[76:79], v2, s[40:43], s57 offen offset:3072 sc1
    s_add_u32 s57, s57, 4096
    buffer_load_dwordx4 v[80:83], v2, s[40:43], s57 offen offset:0 sc1
    buffer_load_dwordx4 v[84:87], v2, s[40:43], s57 offen offset:1024 sc1
    s_waitcnt vmcnt(13) lgkmcnt(10)
    v_mfma_f32_32x32x16_bf16 v[144:159], v[192:195], v[32:35], 0
    ds_read_b64_tr_b16 v[216:217], v8 offset:6144
    ds_read_b64_tr_b16 v[218:219], v8 offset:7168
    buffer_load_dwordx4 v[88:91], v2, s[40:43], s57 offen offset:2048 sc1
    s_waitcnt lgkmcnt(10)
    v_mfma_f32_32x32x16_bf16 v[160:175], v[196:199], v[32:35], 0
    ds_read_b64_tr_b16 v[192:193], v9 offset:6144
    ds_read_b64_tr_b16 v[194:195], v9 offset:7168
    s_waitcnt vmcnt(13) lgkmcnt(10)
    v_mfma_f32_32x32x16_bf16 v[144:159], v[200:203], v[36:39], v[144:159]
    ds_read_b64_tr_b16 v[196:197], v8 offset:8192
    ds_read_b64_tr_b16 v[198:199], v8 offset:9216
    buffer_load_dwordx4 v[92:95], v2, s[40:43], s57 offen offset:3072 sc1
    s_add_u32 s57, s57, 4096
    s_waitcnt lgkmcnt(10)
    v_mfma_f32_32x32x16_bf16 v[160:175], v[204:207], v[36:39], v[160:175]
    ds_read_b64_tr_b16 v[200:201], v9 offset:8192
    ds_read_b64_tr_b16 v[202:203], v9 offset:9216
    s_waitcnt vmcnt(13) lgkmcnt(10)
    v_mfma_f32_32x32x16_bf16 v[144:159], v[208:211], v[40:43], v[144:159]
    ds_read_b64_tr_b16 v[204:205], v8 offset:10240
    ds_read_b64_tr_b16 v[206:207], v8 offset:11264
    buffer_load_dwordx4 v[96:99], v2, s[40:43], s57 offen offset:0 sc1
    s_waitcnt lgkmcnt(10)
    v_mfma_f32_32x32x16_bf16 v[160:175], v[212:215], v[40:43], v[160:175]
    ds_read_b64_tr_b16 v[208:209], v9 offset:10240
    ds_read_b64_tr_b16 v[210:211], v9 offset:11264
    s_waitcnt vmcnt(13) lgkmcnt(10)
    v_mfma_f32_32x32x16_bf16 v[144:159], v[216:219], v[44:47], v[144:159]
    ds_read_b64_tr_b16 v[212:213], v8 offset:12288
    ds_read_b64_tr_b16 v[214:215], v8 offset:13312
    buffer_load_dwordx4 v[100:103], v2, s[40:43], s57 offen offset:1024 sc1
    s_waitcnt lgkmcnt(10)
    v_mfma_f32_32x32x16_bf16 v[160:175], v[192:195], v[44:47], v[160:175]
    ds_read_b64_tr_b16 v[216:217], v9 offset:12288
    ds_read_b64_tr_b16 v[218:219], v9 offset:13312
    s_waitcnt vmcnt(13) lgkmcnt(10)
    v_mfma_f32_32x32x16_bf16 v[144:159], v[196:199], v[48:51], v[144:159]
    ds_read_b64_tr_b16 v[192:193], v8 offset:14336
    ds_read_b64_tr_b16 v[194:195], v8 offset:15360
    buffer_load_dwordx4 v[104:107], v2, s[40:43], s57 offen offset:2048 sc1
    s_waitcnt lgkmcnt(10)
    v_mfma_f32_32x32x16_bf16 v[160:175], v[200:203], v[48:51], v[160:175]
    ds_read_b64_tr_b16 v[196:197], v9 offset:14336
    ds_read_b64_tr_b16 v[198:199], v9 offset:15360
    s_waitcnt vmcnt(13) lgkmcnt(10)
    v_mfma_f32_32x32x16_bf16 v[144:159], v[204:207], v[52:55], v[144:159]
    ds_read_b64_tr_b16 v[200:201], v8 offset:16384
    ds_read_b64_tr_b16 v[202:203], v8 offset:17408
    buffer_load_dwordx4 v[108:111], v2, s[40:43], s57 offen offset:3072 sc1
    s_add_u32 s57, s57, 4096
    s_waitcnt lgkmcnt(10)
    v_mfma_f32_32x32x16_bf16 v[160:175], v[208:211], v[52:55], v[160:175]
    ds_read_b64_tr_b16 v[204:205], v9 offset:16384
    ds_read_b64_tr_b16 v[206:207], v9 offset:17408
    s_waitcnt vmcnt(13) lgkmcnt(10)
    v_mfma_f32_32x32x16_bf16 v[144:159], v[212:215], v[56:59], v[144:159]
    ds_read_b64_tr_b16 v[208:209], v8 offset:18432
    ds_read_b64_tr_b16 v[210:211], v8 offset:19456
    buffer_load_dwordx4 v[112:115], v2, s[40:43], s57 offen offset:0 sc1
    s_waitcnt lgkmcnt(10)
    v_mfma_f32_32x32x16_bf16 v[160:175], v[216:219], v[56:59], v[160:175]
    ds_read_b64_tr_b16 v[212:213], v9 offset:18432
    ds_read_b64_tr_b16 v[214:215], v9 offset:19456
    s_waitcnt vmcnt(13) lgkmcnt(10)
    v_mfma_f32_32x32x16_bf16 v[144:159], v[192:195], v[60:63], v[144:159]
    ds_read_b64_tr_b16 v[216:217], v8 offset:20480
    ds_read_b64_tr_b16 v[218:219], v8 offset:21504
    buffer_load_dwordx4 v[116:119], v2, s[40:43], s57 offen offset:1024 sc1
    s_waitcnt lgkmcnt(10)
    v_mfma_f32_32x32x16_bf16 v[160:175], v[196:199], v[60:63], v[160:175]
    ds_read_b64_tr_b16 v[192:193], v9 offset:20480
    ds_read_b64_tr_b16 v[194:195], v9 offset:21504
    s_waitcnt vmcnt(13) lgkmcnt(10)
    v_mfma_f32_32x32x16_bf16 v[144:159], v[200:203], v[64:67], v[144:159]
    ds_read_b64_tr_b16 v[196:197], v8 offset:22528
    ds_read_b64_tr_b16 v[198:199], v8 offset:23552
    buffer_load_dwordx4 v[120:123], v2, s[40:43], s57 offen offset:2048 sc1
    s_waitcnt lgkmcnt(10)
    v_mfma_f32_32x32x16_bf16 v[160:175], v[204:207], v[64:67], v[160:175]
    ds_read_b64_tr_b16 v[200:201], v9 offset:22528
    ds_read_b64_tr_b16 v[202:203], v9 offset:23552
    s_waitcnt vmcnt(13) lgkmcnt(10)
    v_mfma_f32_32x32x16_bf16 v[144:159], v[208:211], v[68:71], v[144:159]
    ds_read_b64_tr_b16 v[204:205], v8 offset:24576
    ds_read_b64_tr_b16 v[206:207], v8 offset:25600
    buffer_load_dwordx4 v[124:127], v2, s[40:43], s57 offen offset:3072 sc1
    s_add_u32 s57, s57, 4096
    s_waitcnt lgkmcnt(10)
    v_mfma_f32_32x32x16_bf16 v[160:175], v[212:215], v[68:71], v[160:175]
    ds_read_b64_tr_b16 v[208:209], v9 offset:24576
    ds_read_b64_tr_b16 v[210:211], v9 offset:25600
    s_waitcnt vmcnt(13) lgkmcnt(10)
    v_mfma_f32_32x32x16_bf16 v[144:159], v[216:219], v[72:75], v[144:159]
    ds_read_b64_tr_b16 v[212:213], v8 offset:26624
    ds_read_b64_tr_b16 v[214:215], v8 offset:27648
    buffer_load_dwordx4 v[128:131], v2, s[40:43], s57 offen offset:0 sc1
    s_waitcnt lgkmcnt(10)
    v_mfma_f32_32x32x16_bf16 v[160:175], v[192:195], v[72:75], v[160:175]
    ds_read_b64_tr_b16 v[216:217], v9 offset:26624
    ds_read_b64_tr_b16 v[218:219], v9 offset:27648
    s_waitcnt vmcnt(13) lgkmcnt(10)
    v_mfma_f32_32x32x16_bf16 v[144:159], v[196:199], v[76:79], v[144:159]
    ds_read_b64_tr_b16 v[192:193], v8 offset:28672
    ds_read_b64_tr_b16 v[194:195], v8 offset:29696
    buffer_load_dwordx4 v[132:135], v2, s[40:43], s57 offen offset:1024 sc1
    s_waitcnt lgkmcnt(10)
    v_mfma_f32_32x32x16_bf16 v[160:175], v[200:203], v[76:79], v[160:175]
    ds_read_b64_tr_b16 v[196:197], v9 offset:28672
    ds_read_b64_tr_b16 v[198:199], v9 offset:29696
    s_waitcnt vmcnt(13) lgkmcnt(10)
    v_mfma_f32_32x32x16_bf16 v[144:159], v[204:207], v[80:83], v[144:159]
    ds_read_b64_tr_b16 v[200:201], v8 offset:30720
    ds_read_b64_tr_b16 v[202:203], v8 offset:31744
    buffer_load_dwordx4 v[136:139], v2, s[40:43], s57 offen offset:2048 sc1
    s_waitcnt lgkmcnt(10)
    v_mfma_f32_32x32x16_bf16 v[160:175], v[208:211], v[80:83], v[160:175]
    ds_read_b64_tr_b16 v[204:205], v9 offset:30720
    ds_read_b64_tr_b16 v[206:207], v9 offset:31744
    s_waitcnt vmcnt(13) lgkmcnt(10)
    v_mfma_f32_32x32x16_bf16 v[144:159], v[212:215], v[84:87], v[144:159]
    ds_read_b64_tr_b16 v[208:209], v8 offset:32768
    ds_read_b64_tr_b16 v[210:211], v8 offset:33792
    buffer_load_dwordx4 v[140:143], v2, s[40:43], s57 offen offset:3072 sc1
    s_add_u32 s57, s57, 4096
    s_waitcnt lgkmcnt(10)
    v_mfma_f32_32x32x16_bf16 v[160:175], v[216:219], v[84:87], v[160:175]
    ds_read_b64_tr_b16 v[212:213], v9 offset:32768
    ds_read_b64_tr_b16 v[214:215], v9 offset:33792
    s_waitcnt vmcnt(13) lgkmcnt(10)
    v_mfma_f32_32x32x16_bf16 v[144:159], v[192:195], v[88:91], v[144:159]
    ds_read_b64_tr_b16 v[216:217], v8 offset:34816
    ds_read_b64_tr_b16 v[218:219], v8 offset:35840
    s_lshl_b32 s53, s46, 11
    s_add_u32 m0, s53, 28672
    v_add_u32 v235, s53, v21
    buffer_load_dwordx4 v2, s[40:43], s58 offen offset:0 sc1 lds
    buffer_load_dwordx4 v2, s[40:43], s58 offen offset:1024 sc1 lds
    s_waitcnt lgkmcnt(10)
    v_mfma_f32_32x32x16_bf16 v[160:175], v[196:199], v[88:91], v[160:175]
    ds_read_b64_tr_b16 v[192:193], v9 offset:34816
    ds_read_b64_tr_b16 v[194:195], v9 offset:35840
    s_waitcnt vmcnt(14) lgkmcnt(10)
    v_mfma_f32_32x32x16_bf16 v[144:159], v[200:203], v[92:95], v[144:159]
    ds_read_b64_tr_b16 v[196:197], v8 offset:36864
    ds_read_b64_tr_b16 v[198:199], v8 offset:37888
    s_waitcnt lgkmcnt(10)
    v_mfma_f32_32x32x16_bf16 v[160:175], v[204:207], v[92:95], v[160:175]
    ds_read_b64_tr_b16 v[200:201], v9 offset:36864
    ds_read_b64_tr_b16 v[202:203], v9 offset:37888
    s_waitcnt vmcnt(13) lgkmcnt(10)
    v_mfma_f32_32x32x16_bf16 v[144:159], v[208:211], v[96:99], v[144:159]
    ds_read_b64_tr_b16 v[204:205], v8 offset:38912
    ds_read_b64_tr_b16 v[206:207], v8 offset:39936
    s_waitcnt lgkmcnt(10)
    v_mfma_f32_32x32x16_bf16 v[160:175], v[212:215], v[96:99], v[160:175]
    ds_read_b64_tr_b16 v[208:209], v9 offset:38912
    ds_read_b64_tr_b16 v[210:211], v9 offset:39936
    s_waitcnt vmcnt(12) lgkmcnt(10)
    v_mfma_f32_32x32x16_bf16 v[144:159], v[216:219], v[100:103], v[144:159]
    ds_read_b64_tr_b16 v[212:213], v8 offset:40960
    ds_read_b64_tr_b16 v[214:215], v8 offset:41984
    s_waitcnt lgkmcnt(10)
    v_mfma_f32_32x32x16_bf16 v[160:175], v[192:195], v[100:103], v[160:175]
    ds_read_b64_tr_b16 v[216:217], v9 offset:40960
    ds_read_b64_tr_b16 v[218:219], v9 offset:41984
    s_waitcnt vmcnt(11) lgkmcnt(10)
    v_mfma_f32_32x32x16_bf16 v[144:159], v[196:199], v[104:107], v[144:159]
    ds_read_b64_tr_b16 v[192:193], v8 offset:43008
    ds_read_b64_tr_b16 v[194:195], v8 offset:44032
    s_waitcnt lgkmcnt(10)
    v_mfma_f32_32x32x16_bf16 v[160:175], v[200:203], v[104:107], v[160:175]
    ds_read_b64_tr_b16 v[196:197], v9 offset:43008
    ds_read_b64_tr_b16 v[198:199], v9 offset:44032
    s_waitcnt vmcnt(10) lgkmcnt(10)
    v_mfma_f32_32x32x16_bf16 v[144:159], v[204:207], v[108:111], v[144:159]
    ds_read_b64_tr_b16 v[200:201], v8 offset:45056
    ds_read_b64_tr_b16 v[202:203], v8 offset:46080
    s_waitcnt lgkmcnt(10)
    v_mfma_f32_32x32x16_bf16 v[160:175], v[208:211], v[108:111], v[160:175]
    ds_read_b64_tr_b16 v[204:205], v9 offset:45056
    ds_read_b64_tr_b16 v[206:207], v9 offset:46080
    s_waitcnt vmcnt(9) lgkmcnt(10)
    v_mfma_f32_32x32x16_bf16 v[144:159], v[212:215], v[112:115], v[144:159]
    ds_read_b64_tr_b16 v[208:209], v8 offset:47104
    ds_read_b64_tr_b16 v[210:211], v8 offset:48128
    s_waitcnt lgkmcnt(10)
    v_mfma_f32_32x32x16_bf16 v[160:175], v[216:219], v[112:115], v[160:175]
    ds_read_b64_tr_b16 v[212:213], v9 offset:47104
    ds_read_b64_tr_b16 v[214:215], v9 offset:48128
    s_waitcnt vmcnt(8) lgkmcnt(10)
    v_mfma_f32_32x32x16_bf16 v[144:159], v[192:195], v[116:119], v[144:159]
    ds_read_b64_tr_b16 v[216:217], v8 offset:49152
    ds_read_b64_tr_b16 v[218:219], v8 offset:50176
    s_waitcnt lgkmcnt(10)
    v_mfma_f32_32x32x16_bf16 v[160:175], v[196:199], v[116:119], v[160:175]
    ds_read_b64_tr_b16 v[192:193], v9 offset:49152
    ds_read_b64_tr_b16 v[194:195], v9 offset:50176
    s_waitcnt vmcnt(7) lgkmcnt(10)
    v_mfma_f32_32x32x16_bf16 v[144:159], v[200:203], v[120:123], v[144:159]
    ds_read_b64_tr_b16 v[196:197], v8 offset:51200
    ds_read_b64_tr_b16 v[198:199], v8 offset:52224
    s_waitcnt lgkmcnt(10)
    v_mfma_f32_32x32x16_bf16 v[160:175], v[204:207], v[120:123], v[160:175]
    ds_read_b64_tr_b16 v[200:201], v9 offset:51200
    ds_read_b64_tr_b16 v[202:203], v9 offset:52224
    s_waitcnt vmcnt(6) lgkmcnt(10)
    v_mfma_f32_32x32x16_bf16 v[144:159], v[208:211], v[124:127], v[144:159]
    ds_read_b64_tr_b16 v[204:205], v8 offset:53248
    ds_read_b64_tr_b16 v[206:207], v8 offset:54272
    s_waitcnt vmcnt(0)
    ds_read_b32 v228, v235 offset:28672
    ds_read_b32 v229, v235 offset:28928
    ds_read_b32 v230, v235 offset:29184
    ds_read_b32 v231, v235 offset:29440
    ds_read_b32 v232, v235 offset:29696
    ds_read_b32 v233, v235 offset:29952
    ds_read_b32 v234, v235 offset:30208
    s_waitcnt lgkmcnt(15)
    v_mfma_f32_32x32x16_bf16 v[160:175], v[212:215], v[124:127], v[160:175]
    ds_read_b64_tr_b16 v[208:209], v9 offset:53248
    ds_read_b64_tr_b16 v[210:211], v9 offset:54272
    v_mfma_f32_32x32x16_bf16 v[144:159], v[216:219], v[128:131], v[144:159]
    ds_read_b64_tr_b16 v[212:213], v8 offset:55296
    ds_read_b64_tr_b16 v[214:215], v8 offset:56320
    v_mov_b32 v3, 1
    s_mov_b64 exec, 1
    s_cmp_eq_u32 s51, 0
    s_cbranch_scc1 L_slow_20
    buffer_store_dword v3, v21, s[40:43], s48 offen
L_pubd_21:
    s_mov_b64 exec, -1
    s_waitcnt lgkmcnt(15)
    v_mfma_f32_32x32x16_bf16 v[160:175], v[192:195], v[128:131], v[160:175]
    ds_read_b64_tr_b16 v[216:217], v9 offset:55296
    ds_read_b64_tr_b16 v[218:219], v9 offset:56320
    v_mfma_f32_32x32x16_bf16 v[144:159], v[196:199], v[132:135], v[144:159]
    s_waitcnt lgkmcnt(6)
    v_add_f32 v228, v228, v231
    v_add_f32 v229, v229, v232
    v_add_f32 v230, v230, v233
    v_add_f32 v228, v228, v234
    v_add_f32 v229, v229, v230
    v_add_f32_e64 v228, v228, v229
    v_mfma_f32_32x32x16_bf16 v[160:175], v[200:203], v[132:135], v[160:175]
    v_mfma_f32_32x32x16_bf16 v[144:159], v[204:207], v[136:139], v[144:159]
    s_waitcnt lgkmcnt(0)
    s_barrier
    v_mov_b32 v229, v228
    s_nop 1
    v_permlane32_swap_b32 v228, v229
    v_add_f32 v228, v228, v229
    v_mul_f32 v228, 991054117, v228
    v_add_f32 v16, 925353388, v228
    v_mfma_f32_32x32x16_bf16 v[160:175], v[208:211], v[136:139], v[160:175]
    v_mfma_f32_32x32x16_bf16 v[144:159], v[212:215], v[140:143], v[144:159]
    v_rsq_f32 v228, v16
    s_nop 0
    v_mul_f32 v14, 3222493025, v228
    v_mul_f32 v228, v228, v228
    v_mul_f32 v228, 1027024659, v228
    v_mul_f32 v15, v228, v14
    v_mfma_f32_32x32x16_bf16 v[160:175], v[216:219], v[140:143], v[160:175]
    s_nop 4
    v_mul_f32 v220, v144, v144
    v_mul_f32 v221, v145, v145
    v_mul_f32 v222, v146, v146
    v_mul_f32 v223, v147, v147
    v_mul_f32 v224, v148, v148
    v_mul_f32 v225, v149, v149
    v_mul_f32 v226, v150, v150
    v_mul_f32_e64 v227, v151, v151
    v_fma_f32 v220, v220, v15, v14
    v_fma_f32 v221, v221, v15, v14
    v_fma_f32 v222, v222, v15, v14
    v_fma_f32 v223, v223, v15, v14
    v_fma_f32 v224, v224, v15, v14
    v_fma_f32 v225, v225, v15, v14
    v_fma_f32 v226, v226, v15, v14
    v_fma_f32 v227, v227, v15, v14
    v_mul_f32 v220, v220, v144
    v_mul_f32 v221, v221, v145
    v_mul_f32 v222, v222, v146
    v_mul_f32 v223, v223, v147
    v_mul_f32 v224, v224, v148
    v_mul_f32 v225, v225, v149
    v_mul_f32 v226, v226, v150
    v_mul_f32 v227, v227, v151
    v_exp_f32 v220, v220
    v_exp_f32 v221, v221
    v_exp_f32 v222, v222
    v_exp_f32 v223, v223
    v_exp_f32 v224, v224
    v_exp_f32 v225, v225
    v_exp_f32 v226, v226
    v_exp_f32 v227, v227
    v_fma_f32 v220, v220, v16, v16
    v_fma_f32 v221, v221, v16, v16
    v_fma_f32 v222, v222, v16, v16
    v_fma_f32 v223, v223, v16, v16
    v_fma_f32 v224, v224, v16, v16
    v_fma_f32 v225, v225, v16, v16
    v_fma_f32 v226, v226, v16, v16
    v_fma_f32 v227, v227, v16, v16
    v_rcp_f32 v220, v220
    v_rcp_f32 v221, v221
    v_rcp_f32 v222, v222
    v_rcp_f32 v223, v223
    v_rcp_f32 v224, v224
    v_rcp_f32 v225, v225
    v_rcp_f32 v226, v226
    v_rcp_f32 v227, v227
    v_mul_f32 v144, v220, v144
    v_mul_f32 v145, v221, v145
    v_mul_f32 v146, v222, v146
    v_mul_f32 v147, v223, v147
    v_mul_f32 v148, v224, v148
    v_mul_f32 v149, v225, v149
    v_mul_f32 v150, v226, v150
    v_mul_f32 v151, v227, v151
    v_mul_f32 v220, v152, v152
    v_mul_f32 v221, v153, v153
    v_mul_f32 v222, v154, v154
    v_mul_f32 v223, v155, v155
    v_mul_f32 v224, v156, v156
    v_mul_f32 v225, v157, v157
    v_mul_f32 v226, v158, v158
    v_mul_f32 v227, v159, v159
    v_fma_f32 v220, v220, v15, v14
    v_fma_f32 v221, v221, v15, v14
    v_fma_f32 v222, v222, v15, v14
    v_fma_f32 v223, v223, v15, v14
    v_fma_f32 v224, v224, v15, v14
    v_fma_f32 v225, v225, v15, v14
    v_fma_f32 v226, v226, v15, v14
    v_fma_f32 v227, v227, v15, v14
    v_mul_f32 v220, v220, v152
    v_mul_f32 v221, v221, v153
    v_mul_f32 v222, v222, v154
    v_mul_f32 v223, v223, v155
    v_mul_f32 v224, v224, v156
    v_mul_f32 v225, v225, v157
    v_mul_f32 v226, v226, v158
    v_mul_f32 v227, v227, v159
    v_exp_f32 v220, v220
    v_exp_f32 v221, v221
    v_exp_f32 v222, v222
    v_exp_f32 v223, v223
    v_exp_f32 v224, v224
    v_exp_f32 v225, v225
    v_exp_f32 v226, v226
    v_exp_f32 v227, v227
    v_fma_f32 v220, v220, v16, v16
    v_fma_f32 v221, v221, v16, v16
    v_fma_f32 v222, v222, v16, v16
    v_fma_f32 v223, v223, v16, v16
    v_fma_f32 v224, v224, v16, v16
    v_fma_f32 v225, v225, v16, v16
    v_fma_f32 v226, v226, v16, v16
    v_fma_f32 v227, v227, v16, v16
    v_rcp_f32 v220, v220
    v_rcp_f32 v221, v221
    v_rcp_f32 v222, v222
    v_rcp_f32 v223, v223
    v_rcp_f32 v224, v224
    v_rcp_f32 v225, v225
    v_rcp_f32 v226, v226
    v_rcp_f32 v227, v227
    v_mul_f32 v152, v220, v152
    v_mul_f32 v153, v221, v153
    v_mul_f32 v154, v222, v154
    v_mul_f32 v155, v223, v155
    v_mul_f32 v156, v224, v156
    v_mul_f32 v157, v225, v157
    v_mul_f32 v158, v226, v158
    v_mul_f32 v159, v227, v159
    v_mul_f32 v220, v160, v160
    v_mul_f32 v221, v161, v161
    v_mul_f32 v222, v162, v162
    v_mul_f32 v223, v163, v163
    v_mul_f32 v224, v164, v164
    v_mul_f32 v225, v165, v165
    v_mul_f32 v226, v166, v166
    v_mul_f32 v227, v167, v167
    v_fma_f32 v220, v220, v15, v14
    v_fma_f32 v221, v221, v15, v14
    v_fma_f32 v222, v222, v15, v14
    v_fma_f32 v223, v223, v15, v14
    v_fma_f32 v224, v224, v15, v14
    v_fma_f32 v225, v225, v15, v14
    v_fma_f32 v226, v226, v15, v14
    v_fma_f32 v227, v227, v15, v14
    v_mul_f32 v220, v220, v160
    v_mul_f32 v221, v221, v161
    v_mul_f32 v222, v222, v162
    v_mul_f32 v223, v223, v163
    v_mul_f32 v224, v224, v164
    v_mul_f32 v225, v225, v165
    v_mul_f32 v226, v226, v166
    v_mul_f32 v227, v227, v167
    v_exp_f32 v220, v220
    v_exp_f32 v221, v221
    v_exp_f32 v222, v222
    v_exp_f32 v223, v223
    v_exp_f32 v224, v224
    v_exp_f32 v225, v225
    v_exp_f32 v226, v226
    v_exp_f32 v227, v227
    v_fma_f32 v220, v220, v16, v16
    v_fma_f32 v221, v221, v16, v16
    v_fma_f32 v222, v222, v16, v16
    v_fma_f32 v223, v223, v16, v16
    v_fma_f32 v224, v224, v16, v16
    v_fma_f32 v225, v225, v16, v16
    v_fma_f32 v226, v226, v16, v16
    v_fma_f32 v227, v227, v16, v16
    v_rcp_f32 v220, v220
    v_rcp_f32 v221, v221
    v_rcp_f32 v222, v222
    v_rcp_f32 v223, v223
    v_rcp_f32 v224, v224
    v_rcp_f32 v225, v225
    v_rcp_f32 v226, v226
    v_rcp_f32 v227, v227
    v_mul_f32 v160, v220, v160
    v_mul_f32 v161, v221, v161
    v_mul_f32 v162, v222, v162
    v_mul_f32 v163, v223, v163
    v_mul_f32 v164, v224, v164
    v_mul_f32 v165, v225, v165
    v_mul_f32 v166, v226, v166
    v_mul_f32 v167, v227, v167
    v_mul_f32 v220, v168, v168
    v_mul_f32 v221, v169, v169
    v_mul_f32 v222, v170, v170
    v_mul_f32 v223, v171, v171
    v_mul_f32 v224, v172, v172
    v_mul_f32 v225, v173, v173
    v_mul_f32 v226, v174, v174
    v_mul_f32 v227, v175, v175
    v_fma_f32 v220, v220, v15, v14
    v_fma_f32 v221, v221, v15, v14
    v_fma_f32 v222, v222, v15, v14
    v_fma_f32 v223, v223, v15, v14
    v_fma_f32 v224, v224, v15, v14
    v_fma_f32 v225, v225, v15, v14
    v_fma_f32 v226, v226, v15, v14
    v_fma_f32 v227, v227, v15, v14
    v_mul_f32 v220, v220, v168
    v_mul_f32 v221, v221, v169
    v_mul_f32 v222, v222, v170
    v_mul_f32 v223, v223, v171
    v_mul_f32 v224, v224, v172
    v_mul_f32 v225, v225, v173
    v_mul_f32 v226, v226, v174
    v_mul_f32 v227, v227, v175
    v_exp_f32 v220, v220
    v_exp_f32 v221, v221
    v_exp_f32 v222, v222
    v_exp_f32 v223, v223
    v_exp_f32 v224, v224
    v_exp_f32 v225, v225
    v_exp_f32 v226, v226
    v_exp_f32 v227, v227
    v_fma_f32 v220, v220, v16, v16
    v_fma_f32 v221, v221, v16, v16
    v_fma_f32 v222, v222, v16, v16
    v_fma_f32 v223, v223, v16, v16
    v_fma_f32 v224, v224, v16, v16
    v_fma_f32 v225, v225, v16, v16
    v_fma_f32 v226, v226, v16, v16
    v_fma_f32 v227, v227, v16, v16
    v_rcp_f32 v220, v220
    v_rcp_f32 v221, v221
    v_rcp_f32 v222, v222
    v_rcp_f32 v223, v223
    v_rcp_f32 v224, v224
    v_rcp_f32 v225, v225
    v_rcp_f32 v226, v226
    v_rcp_f32 v227, v227
    s_branch L_pg1_skip
    .p2align 12
L_pg1:
    s_branch L_pg5
    s_nop 0
L_pg1_skip:
    v_mul_f32 v168, v220, v168
    v_mul_f32 v169, v221, v169
    v_mul_f32 v170, v222, v170
    v_mul_f32 v171, v223, v171
    v_mul_f32 v172, v224, v172
    v_mul_f32 v173, v225, v173
    v_mul_f32 v174, v226, v174
    v_mul_f32 v175, v227, v175
    ds_read_b64_tr_b16 v[192:193], v10 offset:0
    ds_read_b64_tr_b16 v[194:195], v10 offset:1024
    ds_read_b64_tr_b16 v[196:197], v10 offset:2048
    ds_read_b64_tr_b16 v[198:199], v10 offset:3072
    ds_read_b64_tr_b16 v[200:201], v10 offset:4096
    ds_read_b64_tr_b16 v[202:203], v10 offset:5120
    ds_read_b64_tr_b16 v[204:205], v10 offset:6144
    ds_read_b64_tr_b16 v[206:207], v10 offset:7168
    ds_read_b64_tr_b16 v[208:209], v10 offset:8192
    ds_read_b64_tr_b16 v[210:211], v10 offset:9216
    ds_read_b64_tr_b16 v[212:213], v10 offset:10240
    ds_read_b64_tr_b16 v[214:215], v10 offset:11264
    s_waitcnt lgkmcnt(10)
    v_mfma_f32_32x32x16_bf16 v[176:191], v[192:195], v[32:35], 0
    ds_read_b64_tr_b16 v[216:217], v10 offset:12288
    ds_read_b64_tr_b16 v[218:219], v10 offset:13312
    s_waitcnt lgkmcnt(10)
    v_mfma_f32_32x32x16_bf16 v[176:191], v[196:199], v[36:39], v[176:191]
    ds_read_b64_tr_b16 v[192:193], v10 offset:14336
    ds_read_b64_tr_b16 v[194:195], v10 offset:15360
    s_waitcnt lgkmcnt(10)
    v_mfma_f32_32x32x16_bf16 v[176:191], v[200:203], v[40:43], v[176:191]
    ds_read_b64_tr_b16 v[196:197], v10 offset:16384
    ds_read_b64_tr_b16 v[198:199], v10 offset:17408
    s_waitcnt lgkmcnt(10)
    v_mfma_f32_32x32x16_bf16 v[176:191], v[204:207], v[44:47], v[176:191]
    ds_read_b64_tr_b16 v[200:201], v10 offset:18432
    ds_read_b64_tr_b16 v[202:203], v10 offset:19456
    s_waitcnt lgkmcnt(10)
    v_mfma_f32_32x32x16_bf16 v[176:191], v[208:211], v[48:51], v[176:191]
    ds_read_b64_tr_b16 v[204:205], v10 offset:20480
    ds_read_b64_tr_b16 v[206:207], v10 offset:21504
    s_waitcnt lgkmcnt(10)
    v_mfma_f32_32x32x16_bf16 v[176:191], v[212:215], v[52:55], v[176:191]
    ds_read_b64_tr_b16 v[208:209], v10 offset:22528
    ds_read_b64_tr_b16 v[210:211], v10 offset:23552
    s_waitcnt lgkmcnt(10)
    v_mfma_f32_32x32x16_bf16 v[176:191], v[216:219], v[56:59], v[176:191]
    ds_read_b64_tr_b16 v[212:213], v10 offset:24576
    ds_read_b64_tr_b16 v[214:215], v10 offset:25600
    s_waitcnt lgkmcnt(10)
    v_mfma_f32_32x32x16_bf16 v[176:191], v[192:195], v[60:63], v[176:191]
    ds_read_b64_tr_b16 v[216:217], v10 offset:26624
    ds_read_b64_tr_b16 v[218:219], v10 offset:27648
    s_waitcnt lgkmcnt(10)
    v_mfma_f32_32x32x16_bf16 v[176:191], v[196:199], v[64:67], v[176:191]
    ds_read_b64_tr_b16 v[192:193], v10 offset:28672
    ds_read_b64_tr_b16 v[194:195], v10 offset:29696
    s_add_u32 m0, s62, 135168
    s_add_u32 s55, s79, 28672
    buffer_load_dwordx4 v4, s[28:31], s55 offen offset:0  lds
    s_waitcnt lgkmcnt(10)
    v_mfma_f32_32x32x16_bf16 v[176:191], v[200:203], v[68:71], v[176:191]
    ds_read_b64_tr_b16 v[196:197], v10 offset:30720
    ds_read_b64_tr_b16 v[198:199], v10 offset:31744
    s_waitcnt lgkmcnt(10)
    v_mfma_f32_32x32x16_bf16 v[176:191], v[204:207], v[72:75], v[176:191]
    ds_read_b64_tr_b16 v[200:201], v10 offset:32768
    ds_read_b64_tr_b16 v[202:203], v10 offset:33792
    buffer_load_dwordx4 v5, s[28:31], s55 offen offset:1024  lds
    s_waitcnt lgkmcnt(10)
    v_mfma_f32_32x32x16_bf16 v[176:191], v[208:211], v[76:79], v[176:191]
    ds_read_b64_tr_b16 v[204:205], v10 offset:34816
    ds_read_b64_tr_b16 v[206:207], v10 offset:35840
    s_waitcnt lgkmcnt(10)
    v_mfma_f32_32x32x16_bf16 v[176:191], v[212:215], v[80:83], v[176:191]
    ds_read_b64_tr_b16 v[208:209], v10 offset:36864
    ds_read_b64_tr_b16 v[210:211], v10 offset:37888
    buffer_load_dwordx4 v6, s[28:31], s55 offen offset:2048  lds
    s_waitcnt lgkmcnt(10)
    v_mfma_f32_32x32x16_bf16 v[176:191], v[216:219], v[84:87], v[176:191]
    ds_read_b64_tr_b16 v[212:213], v10 offset:38912
    ds_read_b64_tr_b16 v[214:215], v10 offset:39936
    s_waitcnt lgkmcnt(10)
    v_mfma_f32_32x32x16_bf16 v[176:191], v[192:195], v[88:91], v[176:191]
    ds_read_b64_tr_b16 v[216:217], v10 offset:40960
    ds_read_b64_tr_b16 v[218:219], v10 offset:41984
    buffer_load_dwordx4 v7, s[28:31], s55 offen offset:3072  lds
    s_waitcnt lgkmcnt(10)
    v_mfma_f32_32x32x16_bf16 v[176:191], v[196:199], v[92:95], v[176:191]
    ds_read_b64_tr_b16 v[192:193], v10 offset:43008
    ds_read_b64_tr_b16 v[194:195], v10 offset:44032
    s_waitcnt lgkmcnt(10)
    v_mfma_f32_32x32x16_bf16 v[176:191], v[200:203], v[96:99], v[176:191]
    ds_read_b64_tr_b16 v[196:197], v10 offset:45056
    ds_read_b64_tr_b16 v[198:199], v10 offset:46080
    s_add_u32 m0, s62, 139264
    s_add_u32 s55, s79, 487424
    buffer_load_dwordx4 v4, s[28:31], s55 offen offset:0  lds
    s_waitcnt lgkmcnt(10)
    v_mfma_f32_32x32x16_bf16 v[176:191], v[204:207], v[100:103], v[176:191]
    ds_read_b64_tr_b16 v[200:201], v10 offset:47104
    ds_read_b64_tr_b16 v[202:203], v10 offset:48128
    s_waitcnt lgkmcnt(10)
    v_mfma_f32_32x32x16_bf16 v[176:191], v[208:211], v[104:107], v[176:191]
    ds_read_b64_tr_b16 v[204:205], v10 offset:49152
    ds_read_b64_tr_b16 v[206:207], v10 offset:50176
    buffer_load_dwordx4 v5, s[28:31], s55 offen offset:1024  lds
    s_waitcnt lgkmcnt(10)
    v_mfma_f32_32x32x16_bf16 v[176:191], v[212:215], v[108:111], v[176:191]
    ds_read_b64_tr_b16 v[208:209], v10 offset:51200
    ds_read_b64_tr_b16 v[210:211], v10 offset:52224
    s_waitcnt lgkmcnt(10)
    v_mfma_f32_32x32x16_bf16 v[176:191], v[216:219], v[112:115], v[176:191]
    ds_read_b64_tr_b16 v[212:213], v10 offset:53248
    ds_read_b64_tr_b16 v[214:215], v10 offset:54272
    buffer_load_dwordx4 v6, s[28:31], s55 offen offset:2048  lds
    s_waitcnt lgkmcnt(10)
    v_mfma_f32_32x32x16_bf16 v[176:191], v[192:195], v[116:119], v[176:191]
    ds_read_b64_tr_b16 v[216:217], v10 offset:55296
    ds_read_b64_tr_b16 v[218:219], v10 offset:56320
    s_waitcnt lgkmcnt(10)
    v_mfma_f32_32x32x16_bf16 v[176:191], v[196:199], v[120:123], v[176:191]
    ds_read_b64_tr_b16 v[192:193], v11 offset:0
    ds_read_b64_tr_b16 v[194:195], v11 offset:1024
    s_waitcnt lgkmcnt(10)
    v_mfma_f32_32x32x16_bf16 v[176:191], v[200:203], v[124:127], v[176:191]
    ds_read_b64_tr_b16 v[196:197], v11 offset:2048
    ds_read_b64_tr_b16 v[198:199], v11 offset:3072
    s_waitcnt lgkmcnt(10)
    v_mfma_f32_32x32x16_bf16 v[176:191], v[204:207], v[128:131], v[176:191]
    ds_read_b64_tr_b16 v[200:201], v11 offset:4096
    ds_read_b64_tr_b16 v[202:203], v11 offset:5120
    s_waitcnt lgkmcnt(10)
    v_mfma_f32_32x32x16_bf16 v[176:191], v[208:211], v[132:135], v[176:191]
    ds_read_b64_tr_b16 v[204:205], v11 offset:6144
    ds_read_b64_tr_b16 v[206:207], v11 offset:7168
    s_waitcnt lgkmcnt(10)
    v_mfma_f32_32x32x16_bf16 v[176:191], v[212:215], v[136:139], v[176:191]
    ds_read_b64_tr_b16 v[208:209], v11 offset:8192
    ds_read_b64_tr_b16 v[210:211], v11 offset:9216
    s_waitcnt lgkmcnt(10)
    v_mfma_f32_32x32x16_bf16 v[176:191], v[216:219], v[140:143], v[176:191]
    ds_read_b64_tr_b16 v[212:213], v11 offset:10240
    ds_read_b64_tr_b16 v[214:215], v11 offset:11264
    s_waitcnt lgkmcnt(10)
    v_mfma_f32_32x32x16_bf16 v[240:255], v[192:195], v[32:35], 0
    ds_read_b64_tr_b16 v[216:217], v11 offset:12288
    ds_read_b64_tr_b16 v[218:219], v11 offset:13312
    s_waitcnt lgkmcnt(10)
    v_mfma_f32_32x32x16_bf16 v[240:255], v[196:199], v[36:39], v[240:255]
    ds_read_b64_tr_b16 v[192:193], v11 offset:14336
    ds_read_b64_tr_b16 v[194:195], v11 offset:15360
    s_waitcnt lgkmcnt(10)
    v_mfma_f32_32x32x16_bf16 v[240:255], v[200:203], v[40:43], v[240:255]
    ds_read_b64_tr_b16 v[196:197], v11 offset:16384
    ds_read_b64_tr_b16 v[198:199], v11 offset:17408
    v_mul_f32 v176, v144, v176
    v_mul_f32 v177, v145, v177
    s_waitcnt lgkmcnt(10)
    v_mfma_f32_32x32x16_bf16 v[240:255], v[204:207], v[44:47], v[240:255]
    ds_read_b64_tr_b16 v[200:201], v11 offset:18432
    ds_read_b64_tr_b16 v[202:203], v11 offset:19456
    v_mul_f32 v178, v146, v178
    v_mul_f32_e64 v179, v147, v179
    s_waitcnt lgkmcnt(10)
    v_mfma_f32_32x32x16_bf16 v[240:255], v[208:211], v[48:51], v[240:255]
    ds_read_b64_tr_b16 v[204:205], v11 offset:20480
    ds_read_b64_tr_b16 v[206:207], v11 offset:21504
    v_mul_f32 v180, v148, v180
    v_mul_f32_e64 v181, v149, v181
    s_waitcnt lgkmcnt(10)
    v_mfma_f32_32x32x16_bf16 v[240:255], v[212:215], v[52:55], v[240:255]
    ds_read_b64_tr_b16 v[208:209], v11 offset:22528
    ds_read_b64_tr_b16 v[210:211], v11 offset:23552
    v_mul_f32 v182, v150, v182
    v_mul_f32_e64 v183, v151, v183
    s_waitcnt lgkmcnt(10)
    v_mfma_f32_32x32x16_bf16 v[240:255], v[216:219], v[56:59], v[240:255]
    ds_read_b64_tr_b16 v[212:213], v11 offset:24576
    ds_read_b64_tr_b16 v[214:215], v11 offset:25600
    v_cvt_pk_bf16_f32 v176, v176, v177
    v_cvt_pk_bf16_f32 v177, v178, v179
    s_waitcnt lgkmcnt(10)
    v_mfma_f32_32x32x16_bf16 v[240:255], v[192:195], v[60:63], v[240:255]
    ds_read_b64_tr_b16 v[216:217], v11 offset:26624
    ds_read_b64_tr_b16 v[218:219], v11 offset:27648
    v_cvt_pk_bf16_f32 v178, v180, v181
    v_cvt_pk_bf16_f32 v179, v182, v183
    s_waitcnt lgkmcnt(10)
    v_mfma_f32_32x32x16_bf16 v[240:255], v[196:199], v[64:67], v[240:255]
    ds_read_b64_tr_b16 v[192:193], v11 offset:28672
    ds_read_b64_tr_b16 v[194:195], v11 offset:29696
    s_add_u32 s53, s78, 0
    buffer_store_dwordx4 v[176:179], v2, s[40:43], s53 offen sc1
    s_waitcnt lgkmcnt(10)
    v_mfma_f32_32x32x16_bf16 v[240:255], v[200:203], v[68:71], v[240:255]
    ds_read_b64_tr_b16 v[196:197], v11 offset:30720
    ds_read_b64_tr_b16 v[198:199], v11 offset:31744
    v_mul_f32 v184, v152, v184
    v_mul_f32_e64 v185, v153, v185
    s_waitcnt lgkmcnt(10)
    v_mfma_f32_32x32x16_bf16 v[240:255], v[204:207], v[72:75], v[240:255]
    ds_read_b64_tr_b16 v[200:201], v11 offset:32768
    ds_read_b64_tr_b16 v[202:203], v11 offset:33792
    v_mul_f32 v186, v154, v186
    v_mul_f32_e64 v187, v155, v187
    s_waitcnt lgkmcnt(10)
    v_mfma_f32_32x32x16_bf16 v[240:255], v[208:211], v[76:79], v[240:255]
    ds_read_b64_tr_b16 v[204:205], v11 offset:34816
    ds_read_b64_tr_b16 v[206:207], v11 offset:35840
    v_mul_f32 v188, v156, v188
    v_mul_f32_e64 v189, v157, v189
    s_waitcnt lgkmcnt(10)
    v_mfma_f32_32x32x16_bf16 v[240:255], v[212:215], v[80:83], v[240:255]
    ds_read_b64_tr_b16 v[208:209], v11 offset:36864
    ds_read_b64_tr_b16 v[210:211], v11 offset:37888
    v_mul_f32 v190, v158, v190
    v_mul_f32_e64 v191, v159, v191
    s_waitcnt lgkmcnt(10)
    v_mfma_f32_32x32x16_bf16 v[240:255], v[216:219], v[84:87], v[240:255]
    ds_read_b64_tr_b16 v[212:213], v11 offset:38912
    ds_read_b64_tr_b16 v[214:215], v11 offset:39936
    v_cvt_pk_bf16_f32 v184, v184, v185
    v_cvt_pk_bf16_f32 v185, v186, v187
    s_waitcnt lgkmcnt(10)
    v_mfma_f32_32x32x16_bf16 v[240:255], v[192:195], v[88:91], v[240:255]
    ds_read_b64_tr_b16 v[216:217], v11 offset:40960
    ds_read_b64_tr_b16 v[218:219], v11 offset:41984
    v_cvt_pk_bf16_f32 v186, v188, v189
    v_cvt_pk_bf16_f32 v187, v190, v191
    s_waitcnt lgkmcnt(10)
    v_mfma_f32_32x32x16_bf16 v[240:255], v[196:199], v[92:95], v[240:255]
    ds_read_b64_tr_b16 v[192:193], v11 offset:43008
    ds_read_b64_tr_b16 v[194:195], v11 offset:44032
    s_add_u32 s53, s78, 14336
    buffer_store_dwordx4 v[184:187], v2, s[40:43], s53 offen sc1
    s_waitcnt lgkmcnt(10)
    v_mfma_f32_32x32x16_bf16 v[240:255], v[200:203], v[96:99], v[240:255]
    ds_read_b64_tr_b16 v[196:197], v11 offset:45056
    ds_read_b64_tr_b16 v[198:199], v11 offset:46080
    s_waitcnt lgkmcnt(10)
    v_mfma_f32_32x32x16_bf16 v[240:255], v[204:207], v[100:103], v[240:255]
    ds_read_b64_tr_b16 v[200:201], v11 offset:47104
    ds_read_b64_tr_b16 v[202:203], v11 offset:48128
    s_waitcnt lgkmcnt(10)
    v_mfma_f32_32x32x16_bf16 v[240:255], v[208:211], v[104:107], v[240:255]
    ds_read_b64_tr_b16 v[204:205], v11 offset:49152
    ds_read_b64_tr_b16 v[206:207], v11 offset:50176
    s_waitcnt lgkmcnt(10)
    v_mfma_f32_32x32x16_bf16 v[240:255], v[212:215], v[108:111], v[240:255]
    ds_read_b64_tr_b16 v[208:209], v11 offset:51200
    ds_read_b64_tr_b16 v[210:211], v11 offset:52224
    s_waitcnt lgkmcnt(10)
    v_mfma_f32_32x32x16_bf16 v[240:255], v[216:219], v[112:115], v[240:255]
    ds_read_b64_tr_b16 v[212:213], v11 offset:53248
    ds_read_b64_tr_b16 v[214:215], v11 offset:54272
    s_waitcnt lgkmcnt(10)
    v_mfma_f32_32x32x16_bf16 v[240:255], v[192:195], v[116:119], v[240:255]
    ds_read_b64_tr_b16 v[216:217], v11 offset:55296
    ds_read_b64_tr_b16 v[218:219], v11 offset:56320
    s_waitcnt lgkmcnt(10)
    v_mfma_f32_32x32x16_bf16 v[240:255], v[196:199], v[120:123], v[240:255]
    s_waitcnt lgkmcnt(8)
    v_mfma_f32_32x32x16_bf16 v[240:255], v[200:203], v[124:127], v[240:255]
    s_waitcnt lgkmcnt(6)
    v_mfma_f32_32x32x16_bf16 v[240:255], v[204:207], v[128:131], v[240:255]
    s_waitcnt vmcnt(2) lgkmcnt(0)
    s_barrier
    v_mfma_f32_32x32x16_bf16 v[240:255], v[208:211], v[132:135], v[240:255]
    v_mfma_f32_32x32x16_bf16 v[240:255], v[212:215], v[136:139], v[240:255]
    v_mfma_f32_32x32x16_bf16 v[240:255], v[216:219], v[140:143], v[240:255]
    s_nop 11
    v_mul_f32 v240, v160, v240
    v_mul_f32 v241, v161, v241
    v_mul_f32 v242, v162, v242
    v_mul_f32 v243, v163, v243
    v_mul_f32 v244, v164, v244
    v_mul_f32 v245, v165, v245
    v_mul_f32 v246, v166, v246
    v_mul_f32 v247, v167, v247
    v_cvt_pk_bf16_f32 v240, v240, v241
    v_cvt_pk_bf16_f32 v241, v242, v243
    v_cvt_pk_bf16_f32 v242, v244, v245
    v_cvt_pk_bf16_f32 v243, v246, v247
    v_mov_b32 v3, 2
    s_waitcnt vmcnt(0)
    s_mov_b64 exec, 1
    s_cmp_eq_u32 s51, 0
    s_cbranch_scc1 L_slow_22
    buffer_store_dword v3, v21, s[40:43], s48 offen
L_pubd_23:
    s_mov_b64 exec, -1
    s_add_u32 s53, s69, 0
    buffer_store_dwordx4 v[240:243], v2, s[40:43], s53 offen sc1
    v_mul_f32 v248, v168, v248
    v_mul_f32 v249, v169, v249
    v_mul_f32 v250, v170, v250
    v_mul_f32 v251, v171, v251
    v_mul_f32 v252, v172, v252
    v_mul_f32 v253, v173, v253
    v_mul_f32 v254, v174, v254
    v_mul_f32_e64 v255, v175, v255
    v_cvt_pk_bf16_f32 v248, v248, v249
    v_cvt_pk_bf16_f32 v249, v250, v251
    v_cvt_pk_bf16_f32 v250, v252, v253
    v_cvt_pk_bf16_f32 v251, v254, v255
    s_add_u32 s53, s69, 14336
    buffer_store_dwordx4 v[248:251], v2, s[40:43], s53 offen sc1
    s_lshl_b32 s53, s46, 12
    v_add_u32 v26, s53, v2
    v_xor_b32 v27, 8192, v26
    s_xor_b32 s53, s46, 2
    s_lshl_b32 s53, s53, 8
    v_add_u32_e64 v29, s53, v21
    ds_read_b128 v[144:147], v27 offset:0
    ds_read_b128 v[148:151], v27 offset:1024
    ds_read_b128 v[152:155], v27 offset:2048
    ds_read_b128 v[156:159], v27 offset:3072
    ds_read_b32 v17, v29 offset:16384
    s_lshl_b32 s53, s46, 11
    s_add_u32 s53, s53, 94208
    v_add_u32 v28, s53, v2
    s_mov_b64 exec, 0x7f
    buffer_load_dword v23, v22, s[40:43], s49 offen sc1
    s_mov_b64 exec, -1
    s_waitcnt lgkmcnt(0)
    v_add_f32 v144, v17, v144
    v_add_f32 v145, v17, v145
    v_add_f32 v146, v17, v146
    v_add_f32 v147, v17, v147
    v_add_f32 v148, v17, v148
    v_add_f32 v149, v17, v149
    v_add_f32 v150, v17, v150
    v_add_f32 v151, v17, v151
    v_add_f32 v152, v17, v152
    v_add_f32 v153, v17, v153
    v_add_f32 v154, v17, v154
    v_add_f32 v155, v17, v155
    v_add_f32 v156, v17, v156
    v_add_f32 v157, v17, v157
    v_add_f32 v158, v17, v158
    v_add_f32 v159, v17, v159
    v_mov_b32 v3, 3
    s_waitcnt vmcnt(1)
    s_mov_b64 exec, 1
    s_cmp_eq_u32 s51, 0
    s_cbranch_scc1 L_slow_24
    buffer_store_dword v3, v21, s[40:43], s48 offen
L_pubd_25:
    s_mov_b64 exec, -1
    s_waitcnt vmcnt(1)
    s_mov_b64 exec, 0x7f
    v_cmp_gt_u32 vcc, 2, v23
    s_cbranch_vccz L_ok_27
L_poll_28:
    buffer_load_dword v23, v22, s[40:43], s49 offen sc1
    s_add_u32 s52, s52, 1
    s_waitcnt vmcnt(0)
    v_cmp_gt_u32 vcc, 2, v23
    s_cmp_gt_u32 s52, 4194304
    s_cbranch_scc1 L_polled_29
    s_cbranch_vccnz L_poll_28
L_polled_29:
L_ok_27:
    s_mov_b64 exec, -1
    s_mul_i32 s54, s59, 57344
    s_mul_i32 s53, s74, 7168
    s_add_u32 s54, s54, s53
    s_add_u32 s54, s54, 8388608
    buffer_load_dwordx4 v[32:35], v2, s[40:43], s54 offen offset:0 sc1
    buffer_load_dwordx4 v[36:39], v2, s[40:43], s54 offen offset:1024 sc1
    buffer_load_dwordx4 v[40:43], v2, s[40:43], s54 offen offset:2048 sc1
    buffer_load_dwordx4 v[44:47], v2, s[40:43], s54 offen offset:3072 sc1
    s_add_u32 s54, s54, 4096
    buffer_load_dwordx4 v[48:51], v2, s[40:43], s54 offen offset:0 sc1
    buffer_load_dwordx4 v[52:55], v2, s[40:43], s54 offen offset:1024 sc1
    buffer_load_dwordx4 v[56:59], v2, s[40:43], s54 offen offset:2048 sc1
    s_mov_b64 exec, 0x7f
    buffer_load_dword v23, v22, s[40:43], s49 offen sc1
    s_mov_b64 exec, -1
    s_mul_i32 s54, s59, 57344
    s_mul_i32 s53, s74, 7168
    s_add_u32 s54, s54, s53
    s_add_u32 s54, s54, 8402944
    buffer_load_dwordx4 v[60:63], v2, s[40:43], s54 offen offset:0 sc1
    buffer_load_dwordx4 v[64:67], v2, s[40:43], s54 offen offset:1024 sc1
    buffer_load_dwordx4 v[68:71], v2, s[40:43], s54 offen offset:2048 sc1
    buffer_load_dwordx4 v[72:75], v2, s[40:43], s54 offen offset:3072 sc1
    s_add_u32 s54, s54, 4096
    buffer_load_dwordx4 v[76:79], v2, s[40:43], s54 offen offset:0 sc1
    buffer_load_dwordx4 v[80:83], v2, s[40:43], s54 offen offset:1024 sc1
    buffer_load_dwordx4 v[84:87], v2, s[40:43], s54 offen offset:2048 sc1
    s_lshl_b32 s53, s74, 3
    s_add_u32 s53, s53, 17424
    v_mov_b32 v222, s53
    v_add_u32 v18, 20480, v12
    v_add_u32 v19, 20480, v13
    ds_read_b64_tr_b16 v[192:193], v18 offset:0
    ds_read_b64_tr_b16 v[194:195], v18 offset:7168
    ds_read_b64_tr_b16 v[196:197], v19 offset:0
    ds_read_b64_tr_b16 v[198:199], v19 offset:7168
    ds_read_b64_tr_b16 v[200:201], v18 offset:1024
    ds_read_b64_tr_b16 v[202:203], v18 offset:8192
    ds_read_b64_tr_b16 v[204:205], v19 offset:1024
    ds_read_b64_tr_b16 v[206:207], v19 offset:8192
    ds_read_b64_tr_b16 v[208:209], v18 offset:2048
    ds_read_b64_tr_b16 v[210:211], v18 offset:9216
    ds_read_b64_tr_b16 v[212:213], v19 offset:2048
    ds_read_b64_tr_b16 v[214:215], v19 offset:9216
    s_waitcnt vmcnt(14) lgkmcnt(10)
    v_mfma_f32_32x32x16_bf16 v[144:159], v[192:195], v[32:35], v[144:159]
    ds_read_b64_tr_b16 v[216:217], v18 offset:3072
    ds_read_b64_tr_b16 v[218:219], v18 offset:10240
    s_waitcnt vmcnt(7)
    s_mov_b64 exec, 0x7f
    v_cmp_gt_u32 vcc, 3, v23
    s_cbranch_vccz L_ok_31
L_poll_32:
    buffer_load_dword v23, v22, s[40:43], s49 offen sc1
    s_add_u32 s52, s52, 1
    s_waitcnt vmcnt(0)
    v_cmp_gt_u32 vcc, 3, v23
    s_cmp_gt_u32 s52, 4194304
    s_cbranch_scc1 L_polled_33
    s_cbranch_vccnz L_poll_32
L_polled_33:
L_ok_31:
    s_mov_b64 exec, -1
    s_mul_i32 s54, s59, 57344
    s_mul_i32 s53, s74, 7168
    s_add_u32 s54, s54, s53
    s_add_u32 s54, s54, 8417280
    buffer_load_dwordx4 v[88:91], v2, s[40:43], s54 offen offset:0 sc1
    s_waitcnt lgkmcnt(10)
    v_mfma_f32_32x32x16_bf16 v[160:175], v[196:199], v[32:35], 0
    ds_read_b64_tr_b16 v[192:193], v19 offset:3072
    ds_read_b64_tr_b16 v[194:195], v19 offset:10240
    s_waitcnt lgkmcnt(10)
    v_mfma_f32_32x32x16_bf16 v[144:159], v[200:203], v[36:39], v[144:159]
    ds_read_b64_tr_b16 v[196:197], v18 offset:4096
    ds_read_b64_tr_b16 v[198:199], v18 offset:11264
    buffer_load_dwordx4 v[92:95], v2, s[40:43], s54 offen offset:1024 sc1
    s_waitcnt lgkmcnt(10)
    v_mfma_f32_32x32x16_bf16 v[160:175], v[204:207], v[36:39], v[160:175]
    ds_read_b64_tr_b16 v[200:201], v19 offset:4096
    ds_read_b64_tr_b16 v[202:203], v19 offset:11264
    s_waitcnt lgkmcnt(10)
    v_mfma_f32_32x32x16_bf16 v[144:159], v[208:211], v[40:43], v[144:159]
    ds_read_b64_tr_b16 v[204:205], v18 offset:5120
    ds_read_b64_tr_b16 v[206:207], v18 offset:12288
    buffer_load_dwordx4 v[96:99], v2, s[40:43], s54 offen offset:2048 sc1
    s_waitcnt lgkmcnt(10)
    v_mfma_f32_32x32x16_bf16 v[160:175], v[212:215], v[40:43], v[160:175]
    ds_read_b64_tr_b16 v[208:209], v19 offset:5120
    ds_read_b64_tr_b16 v[210:211], v19 offset:12288
    s_waitcnt lgkmcnt(10)
    v_mfma_f32_32x32x16_bf16 v[144:159], v[216:219], v[44:47], v[144:159]
    ds_read_b64_tr_b16 v[212:213], v18 offset:6144
    ds_read_b64_tr_b16 v[214:215], v18 offset:13312
    buffer_load_dwordx4 v[100:103], v2, s[40:43], s54 offen offset:3072 sc1
    s_add_u32 s54, s54, 4096
    s_waitcnt lgkmcnt(10)
    v_mfma_f32_32x32x16_bf16 v[160:175], v[192:195], v[44:47], v[160:175]
    ds_read_b64_tr_b16 v[216:217], v19 offset:6144
    ds_read_b64_tr_b16 v[218:219], v19 offset:13312
    s_waitcnt lgkmcnt(10)
    v_mfma_f32_32x32x16_bf16 v[144:159], v[196:199], v[48:51], v[144:159]
    v_add_u32 v18, 106496, v12
    v_add_u32 v19, 106496, v13
    ds_read_b64_tr_b16 v[192:193], v18 offset:0
    ds_read_b64_tr_b16 v[194:195], v18 offset:7168
    buffer_load_dwordx4 v[104:107], v2, s[40:43], s54 offen offset:0 sc1
    s_waitcnt lgkmcnt(10)
    v_mfma_f32_32x32x16_bf16 v[160:175], v[200:203], v[48:51], v[160:175]
    ds_read_b64_tr_b16 v[196:197], v19 offset:0
    ds_read_b64_tr_b16 v[198:199], v19 offset:7168
    s_waitcnt lgkmcnt(10)
    v_mfma_f32_32x32x16_bf16 v[144:159], v[204:207], v[52:55], v[144:159]
    ds_read_b64_tr_b16 v[200:201], v18 offset:1024
    ds_read_b64_tr_b16 v[202:203], v18 offset:8192
    buffer_load_dwordx4 v[108:111], v2, s[40:43], s54 offen offset:1024 sc1
    s_waitcnt lgkmcnt(10)
    v_mfma_f32_32x32x16_bf16 v[160:175], v[208:211], v[52:55], v[160:175]
    ds_read_b64_tr_b16 v[204:205], v19 offset:1024
    ds_read_b64_tr_b16 v[206:207], v19 offset:8192
    s_waitcnt lgkmcnt(10)
    v_mfma_f32_32x32x16_bf16 v[144:159], v[212:215], v[56:59], v[144:159]
    ds_read_b64_tr_b16 v[208:209], v18 offset:2048
    ds_read_b64_tr_b16 v[210:211], v18 offset:9216
    buffer_load_dwordx4 v[112:115], v2, s[40:43], s54 offen offset:2048 sc1
    s_waitcnt lgkmcnt(10)
    v_mfma_f32_32x32x16_bf16 v[160:175], v[216:219], v[56:59], v[160:175]
    ds_read_b64_tr_b16 v[212:213], v19 offset:2048
    ds_read_b64_tr_b16 v[214:215], v19 offset:9216
    s_waitcnt vmcnt(13) lgkmcnt(10)
    v_mfma_f32_32x32x16_bf16 v[144:159], v[192:195], v[60:63], v[144:159]
    ds_read_b64_tr_b16 v[216:217], v18 offset:3072
    ds_read_b64_tr_b16 v[218:219], v18 offset:10240
    s_mul_i32 s54, s59, 57344
    s_mul_i32 s53, s74, 7168
    s_add_u32 s54, s54, s53
    s_add_u32 s54, s54, 8431616
    buffer_load_dwordx4 v[116:119], v2, s[40:43], s54 offen offset:0 sc1
    s_waitcnt lgkmcnt(10)
    v_mfma_f32_32x32x16_bf16 v[160:175], v[196:199], v[60:63], v[160:175]
    ds_read_b64_tr_b16 v[192:193], v19 offset:3072
    ds_read_b64_tr_b16 v[194:195], v19 offset:10240
    s_waitcnt vmcnt(13) lgkmcnt(10)
    v_mfma_f32_32x32x16_bf16 v[144:159], v[200:203], v[64:67], v[144:159]
    ds_read_b64_tr_b16 v[196:197], v18 offset:4096
    ds_read_b64_tr_b16 v[198:199], v18 offset:11264
    buffer_load_dwordx4 v[120:123], v2, s[40:43], s54 offen offset:1024 sc1
    s_waitcnt lgkmcnt(10)
    v_mfma_f32_32x32x16_bf16 v[160:175], v[204:207], v[64:67], v[160:175]
    ds_read_b64_tr_b16 v[200:201], v19 offset:4096
    ds_read_b64_tr_b16 v[202:203], v19 offset:11264
    s_waitcnt vmcnt(13) lgkmcnt(10)
    v_mfma_f32_32x32x16_bf16 v[144:159], v[208:211], v[68:71], v[144:159]
    ds_read_b64_tr_b16 v[204:205], v18 offset:5120
    ds_read_b64_tr_b16 v[206:207], v18 offset:12288
    buffer_load_dwordx4 v[124:127], v2, s[40:43], s54 offen offset:2048 sc1
    s_waitcnt lgkmcnt(10)
    v_mfma_f32_32x32x16_bf16 v[160:175], v[212:215], v[68:71], v[160:175]
    ds_read_b64_tr_b16 v[208:209], v19 offset:5120
    ds_read_b64_tr_b16 v[210:211], v19 offset:12288
    s_waitcnt vmcnt(13) lgkmcnt(10)
    v_mfma_f32_32x32x16_bf16 v[144:159], v[216:219], v[72:75], v[144:159]
    ds_read_b64_tr_b16 v[212:213], v18 offset:6144
    ds_read_b64_tr_b16 v[214:215], v18 offset:13312
    buffer_load_dwordx4 v[128:131], v2, s[40:43], s54 offen offset:3072 sc1
    s_add_u32 s54, s54, 4096
    s_waitcnt lgkmcnt(10)
    v_mfma_f32_32x32x16_bf16 v[160:175], v[192:195], v[72:75], v[160:175]
    ds_read_b64_tr_b16 v[216:217], v19 offset:6144
    ds_read_b64_tr_b16 v[218:219], v19 offset:13312
    s_waitcnt vmcnt(13) lgkmcnt(10)
    v_mfma_f32_32x32x16_bf16 v[144:159], v[196:199], v[76:79], v[144:159]
    v_add_u32 v18, 135168, v12
    v_add_u32 v19, 135168, v13
    ds_read_b64_tr_b16 v[192:193], v18 offset:0
    ds_read_b64_tr_b16 v[194:195], v18 offset:7168
    buffer_load_dwordx4 v[132:135], v2, s[40:43], s54 offen offset:0 sc1
    s_waitcnt lgkmcnt(10)
    v_mfma_f32_32x32x16_bf16 v[160:175], v[200:203], v[76:79], v[160:175]
    ds_read_b64_tr_b16 v[196:197], v19 offset:0
    ds_read_b64_tr_b16 v[198:199], v19 offset:7168
    s_waitcnt vmcnt(13) lgkmcnt(10)
    v_mfma_f32_32x32x16_bf16 v[144:159], v[204:207], v[80:83], v[144:159]
    ds_read_b64_tr_b16 v[200:201], v18 offset:1024
    ds_read_b64_tr_b16 v[202:203], v18 offset:8192
    buffer_load_dwordx4 v[136:139], v2, s[40:43], s54 offen offset:1024 sc1
    s_waitcnt lgkmcnt(10)
    v_mfma_f32_32x32x16_bf16 v[160:175], v[208:211], v[80:83], v[160:175]
    ds_read_b64_tr_b16 v[204:205], v19 offset:1024
    ds_read_b64_tr_b16 v[206:207], v19 offset:8192
    s_waitcnt vmcnt(13) lgkmcnt(10)
    v_mfma_f32_32x32x16_bf16 v[144:159], v[212:215], v[84:87], v[144:159]
    ds_read_b64_tr_b16 v[208:209], v18 offset:2048
    ds_read_b64_tr_b16 v[210:211], v18 offset:9216
    buffer_load_dwordx4 v[140:143], v2, s[40:43], s54 offen offset:2048 sc1
    s_waitcnt lgkmcnt(10)
    v_mfma_f32_32x32x16_bf16 v[160:175], v[216:219], v[84:87], v[160:175]
    ds_read_b64_tr_b16 v[212:213], v19 offset:2048
    ds_read_b64_tr_b16 v[214:215], v19 offset:9216
    s_waitcnt vmcnt(13) lgkmcnt(10)
    v_mfma_f32_32x32x16_bf16 v[144:159], v[192:195], v[88:91], v[144:159]
    ds_read_b64_tr_b16 v[216:217], v18 offset:3072
    ds_read_b64_tr_b16 v[218:219], v18 offset:10240
    s_waitcnt lgkmcnt(10)
    v_mfma_f32_32x32x16_bf16 v[160:175], v[196:199], v[88:91], v[160:175]
    ds_read_b64_tr_b16 v[192:193], v19 offset:3072
    ds_read_b64_tr_b16 v[194:195], v19 offset:10240
    s_waitcnt vmcnt(12) lgkmcnt(10)
    v_mfma_f32_32x32x16_bf16 v[144:159], v[200:203], v[92:95], v[144:159]
    ds_read_b64_tr_b16 v[196:197], v18 offset:4096
    ds_read_b64_tr_b16 v[198:199], v18 offset:11264
    s_waitcnt lgkmcnt(10)
    v_mfma_f32_32x32x16_bf16 v[160:175], v[204:207], v[92:95], v[160:175]
    ds_read_b64_tr_b16 v[200:201], v19 offset:4096
    ds_read_b64_tr_b16 v[202:203], v19 offset:11264
    s_waitcnt vmcnt(11) lgkmcnt(10)
    v_mfma_f32_32x32x16_bf16 v[144:159], v[208:211], v[96:99], v[144:159]
    ds_read_b64_tr_b16 v[204:205], v18 offset:5120
    ds_read_b64_tr_b16 v[206:207], v18 offset:12288
    s_waitcnt lgkmcnt(10)
    v_mfma_f32_32x32x16_bf16 v[160:175], v[212:215], v[96:99], v[160:175]
    ds_read_b64 v[220:221], v222
    ds_read_b64_tr_b16 v[208:209], v19 offset:5120
    ds_read_b64_tr_b16 v[210:211], v19 offset:12288
    s_waitcnt vmcnt(10) lgkmcnt(11)
    v_mfma_f32_32x32x16_bf16 v[144:159], v[216:219], v[100:103], v[144:159]
    ds_read_b64_tr_b16 v[212:213], v18 offset:6144
    ds_read_b64_tr_b16 v[214:215], v18 offset:13312
    s_waitcnt lgkmcnt(11)
    v_mfma_f32_32x32x16_bf16 v[160:175], v[192:195], v[100:103], v[160:175]
    ds_read_b64_tr_b16 v[216:217], v19 offset:6144
    ds_read_b64_tr_b16 v[218:219], v19 offset:13312
    s_waitcnt vmcnt(9) lgkmcnt(11)
    v_mfma_f32_32x32x16_bf16 v[144:159], v[196:199], v[104:107], v[144:159]
    s_waitcnt lgkmcnt(6)
    v_and_b32 v220, v220, v221
    v_cmp_ne_u32 vcc, 1, v220
    s_cbranch_vccz L_qok_34
L_qspin_35:
    ds_read_b64 v[220:221], v222
    s_add_u32 s52, s52, 1
    s_waitcnt lgkmcnt(0)
    v_and_b32 v220, v220, v221
    v_cmp_ne_u32 vcc, 1, v220
    s_cmp_gt_u32 s52, 4194304
    s_cbranch_scc1 L_qok_34
    s_cbranch_vccnz L_qspin_35
L_qok_34:
    v_add_u32 v18, 49152, v12
    v_add_u32 v19, 49152, v13
    ds_read_b64_tr_b16 v[192:193], v19 offset:0
    ds_read_b64_tr_b16 v[194:195], v19 offset:7168
    v_mfma_f32_32x32x16_bf16 v[160:175], v[200:203], v[104:107], v[160:175]
    ds_read_b64_tr_b16 v[196:197], v19 offset:1024
    ds_read_b64_tr_b16 v[198:199], v19 offset:8192
    s_branch L_pg2_skip
    .p2align 12
L_pg2:
    s_branch L_visit1_back
    s_nop 0
L_pg2_skip:
    s_waitcnt vmcnt(8)
    v_mfma_f32_32x32x16_bf16 v[144:159], v[204:207], v[108:111], v[144:159]
    ds_read_b64_tr_b16 v[200:201], v19 offset:2048
    ds_read_b64_tr_b16 v[202:203], v19 offset:9216
    s_waitcnt lgkmcnt(10)
    v_mfma_f32_32x32x16_bf16 v[160:175], v[208:211], v[108:111], v[160:175]
    ds_read_b64_tr_b16 v[204:205], v19 offset:3072
    ds_read_b64_tr_b16 v[206:207], v19 offset:10240
    s_waitcnt vmcnt(7) lgkmcnt(10)
    v_mfma_f32_32x32x16_bf16 v[144:159], v[212:215], v[112:115], v[144:159]
    ds_read_b64_tr_b16 v[208:209], v19 offset:4096
    ds_read_b64_tr_b16 v[210:211], v19 offset:11264
    s_waitcnt lgkmcnt(10)
    v_mfma_f32_32x32x16_bf16 v[160:175], v[216:219], v[112:115], v[160:175]
    ds_read_b64_tr_b16 v[212:213], v19 offset:5120
    ds_read_b64_tr_b16 v[214:215], v19 offset:12288
    s_waitcnt vmcnt(6) lgkmcnt(10)
    v_mfma_f32_32x32x16_bf16 v[160:175], v[192:195], v[116:119], v[160:175]
    ds_read_b64_tr_b16 v[216:217], v19 offset:6144
    ds_read_b64_tr_b16 v[218:219], v19 offset:13312
    s_waitcnt vmcnt(5) lgkmcnt(10)
    v_mfma_f32_32x32x16_bf16 v[160:175], v[196:199], v[120:123], v[160:175]
    ds_read_b64_tr_b16 v[192:193], v18 offset:0
    ds_read_b64_tr_b16 v[194:195], v18 offset:7168
    s_waitcnt vmcnt(4) lgkmcnt(10)
    v_mfma_f32_32x32x16_bf16 v[160:175], v[200:203], v[124:127], v[160:175]
    ds_read_b64_tr_b16 v[196:197], v18 offset:1024
    ds_read_b64_tr_b16 v[198:199], v18 offset:8192
    s_waitcnt vmcnt(3) lgkmcnt(10)
    v_mfma_f32_32x32x16_bf16 v[160:175], v[204:207], v[128:131], v[160:175]
    ds_read_b64_tr_b16 v[200:201], v18 offset:2048
    ds_read_b64_tr_b16 v[202:203], v18 offset:9216
    s_waitcnt vmcnt(2) lgkmcnt(10)
    v_mfma_f32_32x32x16_bf16 v[160:175], v[208:211], v[132:135], v[160:175]
    ds_read_b64_tr_b16 v[204:205], v18 offset:3072
    ds_read_b64_tr_b16 v[206:207], v18 offset:10240
    s_waitcnt vmcnt(1) lgkmcnt(10)
    v_mfma_f32_32x32x16_bf16 v[160:175], v[212:215], v[136:139], v[160:175]
    ds_read_b64_tr_b16 v[208:209], v18 offset:4096
    ds_read_b64_tr_b16 v[210:211], v18 offset:11264
    s_waitcnt vmcnt(0) lgkmcnt(10)
    v_mfma_f32_32x32x16_bf16 v[160:175], v[216:219], v[140:143], v[160:175]
    ds_read_b64_tr_b16 v[212:213], v18 offset:5120
    ds_read_b64_tr_b16 v[214:215], v18 offset:12288
    s_waitcnt lgkmcnt(10)
    v_mfma_f32_32x32x16_bf16 v[144:159], v[192:195], v[116:119], v[144:159]
    ds_read_b64_tr_b16 v[216:217], v18 offset:6144
    ds_read_b64_tr_b16 v[218:219], v18 offset:13312
    s_waitcnt lgkmcnt(10)
    v_mfma_f32_32x32x16_bf16 v[144:159], v[196:199], v[120:123], v[144:159]
    s_waitcnt lgkmcnt(8)
    v_mfma_f32_32x32x16_bf16 v[144:159], v[200:203], v[124:127], v[144:159]
    s_waitcnt lgkmcnt(6)
    v_mfma_f32_32x32x16_bf16 v[144:159], v[204:207], v[128:131], v[144:159]
    ds_write_b128 v27, v[160:163] offset:0
    s_waitcnt lgkmcnt(5)
    v_mfma_f32_32x32x16_bf16 v[144:159], v[208:211], v[132:135], v[144:159]
    ds_write_b128 v27, v[164:167] offset:1024
    s_waitcnt lgkmcnt(4)
    v_mfma_f32_32x32x16_bf16 v[144:159], v[212:215], v[136:139], v[144:159]
    ds_write_b128 v27, v[168:171] offset:2048
    s_waitcnt lgkmcnt(3)
    v_mfma_f32_32x32x16_bf16 v[144:159], v[216:219], v[140:143], v[144:159]
    ds_write_b128 v27, v[172:175] offset:3072
    s_waitcnt lgkmcnt(0)
    s_barrier
    ds_read_b128 v[240:243], v28 offset:0
    ds_read_b128 v[160:163], v26 offset:0
    ds_read_b128 v[164:167], v26 offset:1024
    ds_read_b128 v[244:247], v28 offset:1024
    ds_read_b128 v[168:171], v26 offset:2048
    ds_read_b128 v[172:175], v26 offset:3072
    s_waitcnt lgkmcnt(5)
    v_lshlrev_b32 v176, 16, v240
    v_and_b32 v177, 0xffff0000, v240
    v_lshlrev_b32 v178, 16, v241
    v_and_b32 v179, 0xffff0000, v241
    s_waitcnt lgkmcnt(4)
    v_pk_add_f32 v[144:145], v[144:145], v[160:161]
    v_pk_add_f32 v[146:147], v[146:147], v[162:163]
    v_pk_add_f32 v[144:145], v[144:145], v[176:177]
    v_pk_add_f32 v[146:147], v[146:147], v[178:179]
    v_cvt_pk_bf16_f32 v32, v144, v145
    v_cvt_pk_bf16_f32 v33, v146, v147
    v_lshlrev_b32 v180, 16, v242
    v_and_b32 v181, 0xffff0000, v242
    v_lshlrev_b32 v182, 16, v243
    v_and_b32 v183, 0xffff0000, v243
    s_waitcnt lgkmcnt(3)
    v_pk_add_f32 v[148:149], v[148:149], v[164:165]
    v_pk_add_f32 v[150:151], v[150:151], v[166:167]
    v_pk_add_f32 v[148:149], v[148:149], v[180:181]
    v_pk_add_f32 v[150:151], v[150:151], v[182:183]
    v_cvt_pk_bf16_f32 v34, v148, v149
    v_cvt_pk_bf16_f32 v35, v150, v151
    s_nop 0
    v_permlane32_swap_b32 v32, v34
    v_permlane32_swap_b32 v33, v35
    buffer_store_dwordx4 v[32:35], v20, s[32:35], s3 offen offset:0
    s_waitcnt lgkmcnt(2)
    v_lshlrev_b32 v184, 16, v244
    v_and_b32 v185, 0xffff0000, v244
    v_lshlrev_b32 v186, 16, v245
    v_and_b32 v187, 0xffff0000, v245
    s_waitcnt lgkmcnt(1)
    v_pk_add_f32 v[152:153], v[152:153], v[168:169]
    v_pk_add_f32 v[154:155], v[154:155], v[170:171]
    v_pk_add_f32 v[152:153], v[152:153], v[184:185]
    v_pk_add_f32 v[154:155], v[154:155], v[186:187]
    v_cvt_pk_bf16_f32 v36, v152, v153
    v_cvt_pk_bf16_f32 v37, v154, v155
    v_lshlrev_b32 v188, 16, v246
    v_and_b32 v189, 0xffff0000, v246
    v_lshlrev_b32 v190, 16, v247
    v_and_b32 v191, 0xffff0000, v247
    s_waitcnt lgkmcnt(0)
    v_pk_add_f32 v[156:157], v[156:157], v[172:173]
    v_pk_add_f32 v[158:159], v[158:159], v[174:175]
    v_pk_add_f32 v[156:157], v[156:157], v[188:189]
    v_pk_add_f32 v[158:159], v[158:159], v[190:191]
    v_cvt_pk_bf16_f32 v38, v156, v157
    v_cvt_pk_bf16_f32 v39, v158, v159
    s_nop 0
    v_permlane32_swap_b32 v36, v38
    v_permlane32_swap_b32 v37, v39
    buffer_store_dwordx4 v[36:39], v20, s[32:35], s3 offen offset:32
    s_endpgm
L_helper:
    s_barrier
    s_lshl_b32 s53, s44, 5
    s_add_u32 s53, s53, s45
    s_lshl_b32 s53, s53, 2
    s_add_u32 s53, s53, s46
    s_lshl_b32 s53, s53, 11
    s_add_u32 s53, s53, 4194304
    s_mov_b32 exec_lo, 65535
    s_mov_b32 exec_hi, 0
    buffer_load_dword v25, v24, s[40:43], s53 offen sc1
    s_mov_b64 exec, -1
    s_lshl_b32 s53, s44, 2
    s_add_u32 s53, s53, s45
    s_sub_u32 s53, s53, 28
    s_lshl_b32 s53, s53, 2
    s_add_u32 s53, s53, s46
    s_mul_i32 s53, s53, 14336
    s_add_u32 s53, s53, 6291456
    s_mov_b32 exec_lo, 4294967295
    s_mov_b32 exec_hi, 16777215
    buffer_load_dword v25, v24, s[40:43], s53 offen sc1
    s_mov_b64 exec, -1
    s_add_u32 s53, s53, 7168
    s_mov_b32 exec_lo, 4294967295
    s_mov_b32 exec_hi, 16777215
    buffer_load_dword v25, v24, s[40:43], s53 offen sc1
    s_mov_b64 exec, -1
    s_lshl_b32 s53, s44, 2
    s_add_u32 s53, s53, s45
    s_sub_u32 s53, s53, 28
    s_lshl_b32 s53, s53, 2
    s_add_u32 s53, s53, s46
    s_mul_i32 s53, s53, 1024
    s_add_u32 s53, s53, 8126464
    s_mov_b32 exec_lo, 255
    s_mov_b32 exec_hi, 0
    buffer_load_dword v25, v24, s[40:43], s53 offen sc1
    s_mov_b64 exec, -1
    s_mov_b32 exec_lo, 268435455
    s_mov_b32 exec_hi, 0
    buffer_load_dword v25, v24, s[40:43], s77 offen sc1
    s_mov_b64 exec, -1
    s_waitcnt vmcnt(5)
    s_barrier
    s_barrier
    s_sub_u32 s69, s45, 28
    s_lshl_b32 s69, s69, 2
    s_add_u32 s69, s69, s46
    s_barrier
    s_add_u32 s53, s44, 0
    s_cmp_ge_u32 s53, 7
    s_cselect_b32 s54, 14, 7
    s_sub_u32 s53, s53, s54
    s_lshl_b32 s53, s53, 2
    s_add_u32 s53, s53, s45
    s_lshl_b32 s53, s53, 2
    s_add_u32 s53, s53, s46
    s_mul_i32 s53, s53, 14336
    s_mov_b32 exec_lo, 4294967295
    s_mov_b32 exec_hi, 16777215
    buffer_load_dword v25, v24, s[24:27], s53 offen sc1
    s_mov_b64 exec, -1
    s_add_u32 s53, s53, 7168
    s_mov_b32 exec_lo, 4294967295
    s_mov_b32 exec_hi, 16777215
    buffer_load_dword v25, v24, s[24:27], s53 offen sc1
    s_mov_b64 exec, -1
    s_add_u32 s53, s44, 1
    s_cmp_ge_u32 s53, 7
    s_cselect_b32 s54, 14, 7
    s_sub_u32 s53, s53, s54
    s_lshl_b32 s53, s53, 2
    s_add_u32 s53, s53, s45
    s_lshl_b32 s53, s53, 2
    s_add_u32 s53, s53, s46
    s_mul_i32 s53, s53, 14336
    s_mov_b32 exec_lo, 4294967295
    s_mov_b32 exec_hi, 16777215
    buffer_load_dword v25, v24, s[24:27], s53 offen sc1
    s_mov_b64 exec, -1
    s_add_u32 s53, s53, 7168
    s_mov_b32 exec_lo, 4294967295
    s_mov_b32 exec_hi, 16777215
    buffer_load_dword v25, v24, s[24:27], s53 offen sc1
    s_mov_b64 exec, -1
    s_add_u32 s53, s44, 2
    s_cmp_ge_u32 s53, 7
    s_cselect_b32 s54, 14, 7
    s_sub_u32 s53, s53, s54
    s_lshl_b32 s53, s53, 2
    s_add_u32 s53, s53, s45
    s_lshl_b32 s53, s53, 2
    s_add_u32 s53, s53, s46
    s_mul_i32 s53, s53, 14336
    s_mov_b32 exec_lo, 4294967295
    s_mov_b32 exec_hi, 16777215
    buffer_load_dword v25, v24, s[24:27], s53 offen sc1
    s_mov_b64 exec, -1
    s_add_u32 s53, s53, 7168
    s_mov_b32 exec_lo, 4294967295
    s_mov_b32 exec_hi, 16777215
    buffer_load_dword v25, v24, s[24:27], s53 offen sc1
    s_mov_b64 exec, -1
    s_add_u32 s53, s44, 3
    s_cmp_ge_u32 s53, 7
    s_cselect_b32 s54, 14, 7
    s_sub_u32 s53, s53, s54
    s_lshl_b32 s53, s53, 2
    s_add_u32 s53, s53, s45
    s_lshl_b32 s53, s53, 2
    s_add_u32 s53, s53, s46
    s_mul_i32 s53, s53, 14336
    s_mov_b32 exec_lo, 4294967295
    s_mov_b32 exec_hi, 16777215
    buffer_load_dword v25, v24, s[24:27], s53 offen sc1
    s_mov_b64 exec, -1
    s_add_u32 s53, s53, 7168
    s_mov_b32 exec_lo, 4294967295
    s_mov_b32 exec_hi, 16777215
    buffer_load_dword v25, v24, s[24:27], s53 offen sc1
    s_mov_b64 exec, -1
    s_add_u32 s53, s44, 4
    s_cmp_ge_u32 s53, 7
    s_cselect_b32 s54, 14, 7
    s_sub_u32 s53, s53, s54
    s_lshl_b32 s53, s53, 2
    s_add_u32 s53, s53, s45
    s_lshl_b32 s53, s53, 2
    s_add_u32 s53, s53, s46
    s_mul_i32 s53, s53, 14336
    s_mov_b32 exec_lo, 4294967295
    s_mov_b32 exec_hi, 16777215
    buffer_load_dword v25, v24, s[24:27], s53 offen sc1
    s_mov_b64 exec, -1
    s_add_u32 s53, s53, 7168
    s_mov_b32 exec_lo, 4294967295
    s_mov_b32 exec_hi, 16777215
    buffer_load_dword v25, v24, s[24:27], s53 offen sc1
    s_mov_b64 exec, -1
    s_add_u32 s53, s44, 5
    s_cmp_ge_u32 s53, 7
    s_cselect_b32 s54, 14, 7
    s_sub_u32 s53, s53, s54
    s_lshl_b32 s53, s53, 2
    s_add_u32 s53, s53, s45
    s_lshl_b32 s53, s53, 2
    s_add_u32 s53, s53, s46
    s_mul_i32 s53, s53, 14336
    s_mov_b32 exec_lo, 4294967295
    s_mov_b32 exec_hi, 16777215
    buffer_load_dword v25, v24, s[24:27], s53 offen sc1
    s_mov_b64 exec, -1
    s_add_u32 s53, s53, 7168
    s_mov_b32 exec_lo, 4294967295
    s_mov_b32 exec_hi, 16777215
    buffer_load_dword v25, v24, s[24:27], s53 offen sc1
    s_mov_b64 exec, -1
    s_add_u32 s53, s44, 6
    s_cmp_ge_u32 s53, 7
    s_cselect_b32 s54, 14, 7
    s_sub_u32 s53, s53, s54
    s_lshl_b32 s53, s53, 2
    s_add_u32 s53, s53, s45
    s_lshl_b32 s53, s53, 2
    s_add_u32 s53, s53, s46
    s_mul_i32 s53, s53, 14336
    s_mov_b32 exec_lo, 4294967295
    s_mov_b32 exec_hi, 16777215
    buffer_load_dword v25, v24, s[24:27], s53 offen sc1
    s_mov_b64 exec, -1
    s_add_u32 s53, s53, 7168
    s_mov_b32 exec_lo, 4294967295
    s_mov_b32 exec_hi, 16777215
    buffer_load_dword v25, v24, s[24:27], s53 offen sc1
    s_mov_b64 exec, -1
    s_lshl_b32 s53, s44, 2
    s_add_u32 s53, s53, s45
    s_sub_u32 s53, s53, 28
    s_lshl_b32 s53, s53, 2
    s_add_u32 s53, s53, s46
    s_mul_i32 s53, s53, 12544
    s_mov_b32 exec_lo, 4294967295
    s_mov_b32 exec_hi, 131071
    buffer_load_dword v25, v24, s[28:31], s53 offen sc1
    s_mov_b64 exec, -1
    s_add_u32 s53, s53, 6272
    s_mov_b32 exec_lo, 4294967295
    s_mov_b32 exec_hi, 131071
    buffer_load_dword v25, v24, s[28:31], s53 offen sc1
    s_mov_b64 exec, -1
    s_endpgm
L_setup_end:
    .p2align 12
L_formK:
    s_barrier
    ds_read_b128 v[32:35], v8 offset:0
    ds_read_b128 v[36:39], v9 offset:0
    ds_read_b64_tr_b16 v[192:193], v12 offset:0
    ds_read_b64_tr_b16 v[194:195], v12 offset:512
    ds_read_b64_tr_b16 v[196:197], v13 offset:0
    ds_read_b64_tr_b16 v[198:199], v13 offset:512
    ds_read_b64_tr_b16 v[200:201], v12 offset:2048
    ds_read_b64_tr_b16 v[202:203], v12 offset:2560
    ds_read_b64_tr_b16 v[204:205], v13 offset:2048
    ds_read_b64_tr_b16 v[206:207], v13 offset:2560
    s_waitcnt lgkmcnt(8)
    v_mov_b32 v176, 0
    v_dot2c_f32_bf16 v176, v16, v32
    v_dot2c_f32_bf16 v176, v17, v33
    v_mov_b32 v180, 0
    v_dot2c_f32_bf16 v180, v32, v32
    v_dot2c_f32_bf16 v180, v33, v33
    v_mov_b32 v184, 0
    v_dot2c_f32_bf16 v184, v16, v34
    v_dot2c_f32_bf16 v184, v17, v35
    v_mov_b32_e64 v188, 0
    v_dot2c_f32_bf16 v188, v34, v34
    v_dot2c_f32_bf16 v188, v35, v35
    v_dot2c_f32_bf16 v176, v16, v36
    v_dot2c_f32_bf16 v176, v17, v37
    v_dot2c_f32_bf16 v180, v36, v36
    v_dot2c_f32_bf16 v180, v37, v37
    v_dot2c_f32_bf16 v184, v16, v38
    v_dot2c_f32_bf16 v184, v17, v39
    v_dot2c_f32_bf16 v188, v38, v38
    v_dot2c_f32_bf16 v188, v39, v39
    s_waitcnt lgkmcnt(6)
    v_mfma_f32_32x32x16_bf16 v[144:159], v[192:195], v[32:35], 0
    ds_read_b64_tr_b16 v[208:209], v12 offset:4096
    ds_read_b64_tr_b16 v[210:211], v12 offset:4608
    ds_read_b64_tr_b16 v[212:213], v13 offset:4096
    s_waitcnt lgkmcnt(7)
    v_mfma_f32_32x32x16_bf16 v[160:175], v[196:199], v[32:35], 0
    ds_read_b64_tr_b16 v[214:215], v13 offset:4608
    ds_read_b64_tr_b16 v[216:217], v12 offset:6144
    ds_read_b64_tr_b16 v[218:219], v12 offset:6656
    s_waitcnt lgkmcnt(8)
    v_mfma_f32_32x32x16_bf16 v[144:159], v[200:203], v[36:39], v[144:159]
    ds_read_b64_tr_b16 v[220:221], v13 offset:6144
    ds_read_b64_tr_b16 v[222:223], v13 offset:6656
    ds_read_b128 v[40:43], v10 offset:0
    s_waitcnt lgkmcnt(9)
    v_mfma_f32_32x32x16_bf16 v[160:175], v[204:207], v[36:39], v[160:175]
    ds_read_b128 v[44:47], v11 offset:0
    ds_read_b64_tr_b16 v[240:241], v5 offset:0
    ds_read_b64_tr_b16 v[242:243], v5 offset:512
    ds_read_b64_tr_b16 v[244:245], v6 offset:0
    ds_read_b64_tr_b16 v[246:247], v6 offset:512
    s_waitcnt lgkmcnt(0)
    v_mov_b32 v232, 0
    v_dot2c_f32_bf16 v232, v16, v240
    v_dot2c_f32_bf16 v232, v17, v241
    v_dot2c_f32_bf16 v176, v16, v40
    v_dot2c_f32_bf16 v176, v17, v41
    v_mov_b32_e64 v236, 0
    v_dot2c_f32_bf16 v236, v16, v244
    v_dot2c_f32_bf16 v236, v17, v245
    v_dot2c_f32_bf16 v180, v40, v40
    v_dot2c_f32_bf16 v180, v41, v41
    v_dot2c_f32_bf16 v232, v16, v242
    v_dot2c_f32_bf16 v232, v17, v243
    v_dot2c_f32_bf16 v184, v16, v42
    v_dot2c_f32_bf16 v184, v17, v43
    v_dot2c_f32_bf16 v236, v16, v246
    v_dot2c_f32_bf16 v236, v17, v247
    v_dot2c_f32_bf16 v188, v42, v42
    v_dot2c_f32_bf16 v188, v43, v43
    v_dot2c_f32_bf16 v176, v16, v44
    v_dot2c_f32_bf16 v176, v17, v45
    v_dot2c_f32_bf16 v180, v44, v44
    v_dot2c_f32_bf16 v180, v45, v45
    v_dot2c_f32_bf16 v184, v16, v46
    v_dot2c_f32_bf16 v184, v17, v47
    v_dot2c_f32_bf16 v188, v46, v46
    v_dot2c_f32_bf16 v188, v47, v47
    s_barrier
    v_mfma_f32_32x32x16_bf16 v[144:159], v[208:211], v[40:43], v[144:159]
    ds_read_b128 v[48:51], v8 offset:16384
    ds_read_b128 v[52:55], v9 offset:16384
    ds_read_b64_tr_b16 v[192:193], v12 offset:8192
    v_mfma_f32_32x32x16_bf16 v[160:175], v[212:215], v[40:43], v[160:175]
    ds_read_b64_tr_b16 v[194:195], v12 offset:8704
    ds_read_b64_tr_b16 v[196:197], v13 offset:8192
    ds_read_b64_tr_b16 v[198:199], v13 offset:8704
    v_mfma_f32_32x32x16_bf16 v[144:159], v[216:219], v[44:47], v[144:159]
    ds_read_b128 v[56:59], v10 offset:16384
    ds_read_b128 v[60:63], v11 offset:16384
    ds_read_b64_tr_b16 v[248:249], v5 offset:8192
    v_mfma_f32_32x32x16_bf16 v[160:175], v[220:223], v[44:47], v[160:175]
    ds_read_b64_tr_b16 v[250:251], v5 offset:8704
    ds_read_b64_tr_b16 v[252:253], v6 offset:8192
    ds_read_b64_tr_b16 v[254:255], v6 offset:8704
    s_waitcnt lgkmcnt(0)
    v_dot2c_f32_bf16 v232, v16, v248
    v_dot2c_f32_bf16 v232, v17, v249
    v_dot2c_f32_bf16 v176, v16, v48
    v_dot2c_f32_bf16 v176, v17, v49
    v_dot2c_f32_bf16 v236, v16, v252
    v_dot2c_f32_bf16 v236, v17, v253
    v_dot2c_f32_bf16 v180, v48, v48
    v_dot2c_f32_bf16 v180, v49, v49
    v_dot2c_f32_bf16 v232, v16, v250
    v_dot2c_f32_bf16 v232, v17, v251
    v_dot2c_f32_bf16 v184, v16, v50
    v_dot2c_f32_bf16 v184, v17, v51
    v_dot2c_f32_bf16 v236, v16, v254
    v_dot2c_f32_bf16 v236, v17, v255
    v_dot2c_f32_bf16 v188, v50, v50
    v_dot2c_f32_bf16 v188, v51, v51
    v_dot2c_f32_bf16 v176, v16, v52
    v_dot2c_f32_bf16 v176, v17, v53
    v_dot2c_f32_bf16 v180, v52, v52
    v_dot2c_f32_bf16 v180, v53, v53
    v_dot2c_f32_bf16 v184, v16, v54
    v_dot2c_f32_bf16 v184, v17, v55
    v_dot2c_f32_bf16 v188, v54, v54
    v_dot2c_f32_bf16 v188, v55, v55
    v_mfma_f32_32x32x16_bf16 v[144:159], v[192:195], v[48:51], v[144:159]
    ds_read_b64_tr_b16 v[200:201], v12 offset:10240
    ds_read_b64_tr_b16 v[202:203], v12 offset:10752
    ds_read_b64_tr_b16 v[204:205], v13 offset:10240
    v_mfma_f32_32x32x16_bf16 v[160:175], v[196:199], v[48:51], v[160:175]
    ds_read_b64_tr_b16 v[206:207], v13 offset:10752
    ds_read_b64_tr_b16 v[208:209], v12 offset:12288
    ds_read_b64_tr_b16 v[210:211], v12 offset:12800
    s_waitcnt lgkmcnt(4)
    v_mfma_f32_32x32x16_bf16 v[144:159], v[200:203], v[52:55], v[144:159]
    ds_read_b64_tr_b16 v[212:213], v13 offset:12288
    ds_read_b64_tr_b16 v[214:215], v13 offset:12800
    ds_read_b64_tr_b16 v[216:217], v12 offset:14336
    s_waitcnt lgkmcnt(5)
    v_mfma_f32_32x32x16_bf16 v[160:175], v[204:207], v[52:55], v[160:175]
    ds_read_b64_tr_b16 v[218:219], v12 offset:14848
    ds_read_b64_tr_b16 v[220:221], v13 offset:14336
    ds_read_b64_tr_b16 v[222:223], v13 offset:14848
    s_barrier
    v_dot2c_f32_bf16 v176, v16, v56
    v_dot2c_f32_bf16 v176, v17, v57
    v_dot2c_f32_bf16 v180, v56, v56
    v_dot2c_f32_bf16 v180, v57, v57
    v_dot2c_f32_bf16 v184, v16, v58
    v_dot2c_f32_bf16 v184, v17, v59
    v_dot2c_f32_bf16 v188, v58, v58
    v_dot2c_f32_bf16 v188, v59, v59
    v_dot2c_f32_bf16 v176, v16, v60
    v_dot2c_f32_bf16 v176, v17, v61
    v_dot2c_f32_bf16 v180, v60, v60
    v_dot2c_f32_bf16 v180, v61, v61
    v_dot2c_f32_bf16 v184, v16, v62
    v_dot2c_f32_bf16 v184, v17, v63
    v_dot2c_f32_bf16 v188, v62, v62
    v_dot2c_f32_bf16 v188, v63, v63
    s_waitcnt lgkmcnt(6)
    v_mfma_f32_32x32x16_bf16 v[144:159], v[208:211], v[56:59], v[144:159]
    ds_read_b128 v[64:67], v8 offset:32768
    ds_read_b128 v[68:71], v9 offset:32768
    ds_read_b64_tr_b16 v[192:193], v12 offset:16384
    s_waitcnt lgkmcnt(7)
    v_mfma_f32_32x32x16_bf16 v[160:175], v[212:215], v[56:59], v[160:175]
    ds_read_b64_tr_b16 v[194:195], v12 offset:16896
    ds_read_b64_tr_b16 v[196:197], v13 offset:16384
    ds_read_b64_tr_b16 v[198:199], v13 offset:16896
    s_waitcnt lgkmcnt(8)
    v_mfma_f32_32x32x16_bf16 v[144:159], v[216:219], v[60:63], v[144:159]
    ds_read_b128 v[72:75], v10 offset:32768
    ds_read_b128 v[76:79], v11 offset:32768
    ds_read_b64_tr_b16 v[240:241], v5 offset:16384
    s_waitcnt lgkmcnt(9)
    v_mfma_f32_32x32x16_bf16 v[160:175], v[220:223], v[60:63], v[160:175]
    ds_read_b64_tr_b16 v[242:243], v5 offset:16896
    ds_read_b64_tr_b16 v[244:245], v6 offset:16384
    ds_read_b64_tr_b16 v[246:247], v6 offset:16896
    ds_read_b64_tr_b16 v[248:249], v5 offset:24576
    ds_read_b64_tr_b16 v[250:251], v5 offset:25088
    ds_read_b64_tr_b16 v[252:253], v6 offset:24576
    ds_read_b64_tr_b16 v[254:255], v6 offset:25088
    s_waitcnt lgkmcnt(0)
    v_dot2c_f32_bf16 v232, v16, v240
    v_dot2c_f32_bf16 v232, v17, v241
    v_dot2c_f32_bf16 v176, v16, v64
    v_dot2c_f32_bf16 v176, v17, v65
    v_dot2c_f32_bf16 v236, v16, v244
    v_dot2c_f32_bf16 v236, v17, v245
    v_dot2c_f32_bf16 v180, v64, v64
    v_dot2c_f32_bf16 v180, v65, v65
    v_dot2c_f32_bf16 v232, v16, v242
    v_dot2c_f32_bf16 v232, v17, v243
    v_dot2c_f32_bf16 v184, v16, v66
    v_dot2c_f32_bf16 v184, v17, v67
    v_dot2c_f32_bf16 v236, v16, v246
    v_dot2c_f32_bf16 v236, v17, v247
    v_dot2c_f32_bf16 v188, v66, v66
    v_dot2c_f32_bf16 v188, v67, v67
    v_dot2c_f32_bf16 v232, v16, v248
    v_dot2c_f32_bf16 v232, v17, v249
    v_dot2c_f32_bf16 v176, v16, v68
    v_dot2c_f32_bf16 v176, v17, v69
    v_dot2c_f32_bf16 v236, v16, v252
    v_dot2c_f32_bf16 v236, v17, v253
    v_dot2c_f32_bf16 v180, v68, v68
    v_dot2c_f32_bf16 v180, v69, v69
    v_dot2c_f32_bf16 v232, v16, v250
    v_dot2c_f32_bf16 v232, v17, v251
    v_dot2c_f32_bf16 v184, v16, v70
    v_dot2c_f32_bf16 v184, v17, v71
    v_dot2c_f32_bf16 v236, v16, v254
    v_dot2c_f32_bf16 v236, v17, v255
    v_dot2c_f32_bf16 v188, v70, v70
    v_dot2c_f32_bf16 v188, v71, v71
    v_mfma_f32_32x32x16_bf16 v[144:159], v[192:195], v[64:67], v[144:159]
    ds_read_b64_tr_b16 v[200:201], v12 offset:18432
    ds_read_b64_tr_b16 v[202:203], v12 offset:18944
    ds_read_b64_tr_b16 v[204:205], v13 offset:18432
    v_mfma_f32_32x32x16_bf16 v[160:175], v[196:199], v[64:67], v[160:175]
    ds_read_b64_tr_b16 v[206:207], v13 offset:18944
    ds_read_b64_tr_b16 v[208:209], v12 offset:20480
    ds_read_b64_tr_b16 v[210:211], v12 offset:20992
    s_waitcnt lgkmcnt(4)
    v_mfma_f32_32x32x16_bf16 v[144:159], v[200:203], v[68:71], v[144:159]
    ds_read_b64_tr_b16 v[212:213], v13 offset:20480
    ds_read_b64_tr_b16 v[214:215], v13 offset:20992
    ds_read_b64_tr_b16 v[216:217], v12 offset:22528
    s_waitcnt lgkmcnt(5)
    v_mfma_f32_32x32x16_bf16 v[160:175], v[204:207], v[68:71], v[160:175]
    ds_read_b64_tr_b16 v[218:219], v12 offset:23040
    ds_read_b64_tr_b16 v[220:221], v13 offset:22528
    ds_read_b64_tr_b16 v[222:223], v13 offset:23040
    s_barrier
    v_dot2c_f32_bf16 v176, v16, v72
    v_dot2c_f32_bf16 v176, v17, v73
    v_dot2c_f32_bf16 v180, v72, v72
    v_dot2c_f32_bf16 v180, v73, v73
    v_dot2c_f32_bf16 v184, v16, v74
    v_dot2c_f32_bf16 v184, v17, v75
    v_dot2c_f32_bf16 v188, v74, v74
    v_dot2c_f32_bf16 v188, v75, v75
    v_dot2c_f32_bf16 v176, v16, v76
    v_dot2c_f32_bf16 v176, v17, v77
    v_dot2c_f32_bf16 v180, v76, v76
    v_dot2c_f32_bf16 v180, v77, v77
    v_dot2c_f32_bf16 v184, v16, v78
    v_dot2c_f32_bf16 v184, v17, v79
    v_dot2c_f32_bf16 v188, v78, v78
    v_dot2c_f32_bf16 v188, v79, v79
    s_waitcnt lgkmcnt(6)
    v_mfma_f32_32x32x16_bf16 v[144:159], v[208:211], v[72:75], v[144:159]
    ds_read_b64_tr_b16 v[192:193], v12 offset:24576
    ds_read_b64_tr_b16 v[194:195], v12 offset:25088
    ds_read_b64_tr_b16 v[196:197], v13 offset:24576
    s_waitcnt lgkmcnt(7)
    v_mfma_f32_32x32x16_bf16 v[160:175], v[212:215], v[72:75], v[160:175]
    ds_read_b64_tr_b16 v[198:199], v13 offset:25088
    ds_read_b128 v[80:83], v8 offset:49152
    ds_read_b128 v[84:87], v9 offset:49152
    s_waitcnt lgkmcnt(8)
    v_mfma_f32_32x32x16_bf16 v[144:159], v[216:219], v[76:79], v[144:159]
    ds_read_b128 v[88:91], v10 offset:49152
    ds_read_b128 v[92:95], v11 offset:49152
    ds_read_b64_tr_b16 v[240:241], v5 offset:32768
    s_waitcnt lgkmcnt(9)
    v_mfma_f32_32x32x16_bf16 v[160:175], v[220:223], v[76:79], v[160:175]
    ds_read_b64_tr_b16 v[242:243], v5 offset:33280
    ds_read_b64_tr_b16 v[244:245], v6 offset:32768
    ds_read_b64_tr_b16 v[246:247], v6 offset:33280
    s_waitcnt lgkmcnt(0)
    v_dot2c_f32_bf16 v232, v16, v240
    v_dot2c_f32_bf16 v232, v17, v241
    v_dot2c_f32_bf16 v176, v16, v80
    v_dot2c_f32_bf16 v176, v17, v81
    v_dot2c_f32_bf16 v236, v16, v244
    v_dot2c_f32_bf16 v236, v17, v245
    v_dot2c_f32_bf16 v180, v80, v80
    v_dot2c_f32_bf16 v180, v81, v81
    v_dot2c_f32_bf16 v232, v16, v242
    v_dot2c_f32_bf16 v232, v17, v243
    v_dot2c_f32_bf16 v184, v16, v82
    v_dot2c_f32_bf16 v184, v17, v83
    v_dot2c_f32_bf16 v236, v16, v246
    v_dot2c_f32_bf16 v236, v17, v247
    v_dot2c_f32_bf16 v188, v82, v82
    v_dot2c_f32_bf16 v188, v83, v83
    v_dot2c_f32_bf16 v176, v16, v84
    v_dot2c_f32_bf16 v176, v17, v85
    v_dot2c_f32_bf16 v180, v84, v84
    v_dot2c_f32_bf16 v180, v85, v85
    v_dot2c_f32_bf16 v184, v16, v86
    v_dot2c_f32_bf16 v184, v17, v87
    v_dot2c_f32_bf16 v188, v86, v86
    v_dot2c_f32_bf16 v188, v87, v87
    v_mfma_f32_32x32x16_bf16 v[144:159], v[192:195], v[80:83], v[144:159]
    ds_read_b64_tr_b16 v[200:201], v12 offset:26624
    ds_read_b64_tr_b16 v[202:203], v12 offset:27136
    ds_read_b64_tr_b16 v[204:205], v13 offset:26624
    v_mfma_f32_32x32x16_bf16 v[160:175], v[196:199], v[80:83], v[160:175]
    ds_read_b64_tr_b16 v[206:207], v13 offset:27136
    ds_read_b64_tr_b16 v[208:209], v12 offset:28672
    ds_read_b64_tr_b16 v[210:211], v12 offset:29184
    s_waitcnt lgkmcnt(4)
    v_mfma_f32_32x32x16_bf16 v[144:159], v[200:203], v[84:87], v[144:159]
    ds_read_b64_tr_b16 v[212:213], v13 offset:28672
    ds_read_b64_tr_b16 v[214:215], v13 offset:29184
    ds_read_b64_tr_b16 v[216:217], v12 offset:30720
    s_waitcnt lgkmcnt(5)
    v_mfma_f32_32x32x16_bf16 v[160:175], v[204:207], v[84:87], v[160:175]
    ds_read_b64_tr_b16 v[218:219], v12 offset:31232
    ds_read_b64_tr_b16 v[220:221], v13 offset:30720
    ds_read_b64_tr_b16 v[222:223], v13 offset:31232
    s_barrier
    v_dot2c_f32_bf16 v176, v16, v88
    v_dot2c_f32_bf16 v176, v17, v89
    v_dot2c_f32_bf16 v180, v88, v88
    v_dot2c_f32_bf16 v180, v89, v89
    v_dot2c_f32_bf16 v184, v16, v90
    v_dot2c_f32_bf16 v184, v17, v91
    v_dot2c_f32_bf16 v188, v90, v90
    v_dot2c_f32_bf16 v188, v91, v91
    v_dot2c_f32_bf16 v176, v16, v92
    v_dot2c_f32_bf16 v176, v17, v93
    v_dot2c_f32_bf16 v180, v92, v92
    v_dot2c_f32_bf16 v180, v93, v93
    v_dot2c_f32_bf16 v184, v16, v94
    v_dot2c_f32_bf16 v184, v17, v95
    v_dot2c_f32_bf16 v188, v94, v94
    v_dot2c_f32_bf16 v188, v95, v95
    s_waitcnt lgkmcnt(6)
    v_mfma_f32_32x32x16_bf16 v[144:159], v[208:211], v[88:91], v[144:159]
    ds_read_b64_tr_b16 v[192:193], v12 offset:32768
    ds_read_b64_tr_b16 v[194:195], v12 offset:33280
    ds_read_b64_tr_b16 v[196:197], v13 offset:32768
    s_waitcnt lgkmcnt(7)
    v_mfma_f32_32x32x16_bf16 v[160:175], v[212:215], v[88:91], v[160:175]
    ds_read_b64_tr_b16 v[198:199], v13 offset:33280
    ds_read_b128 v[96:99], v8 offset:0
    ds_read_b128 v[100:103], v9 offset:0
    s_waitcnt lgkmcnt(8)
    v_mfma_f32_32x32x16_bf16 v[144:159], v[216:219], v[92:95], v[144:159]
    ds_read_b128 v[104:107], v10 offset:0
    ds_read_b128 v[108:111], v11 offset:0
    ds_read_b64_tr_b16 v[248:249], v5 offset:40960
    s_waitcnt lgkmcnt(9)
    v_mfma_f32_32x32x16_bf16 v[160:175], v[220:223], v[92:95], v[160:175]
    ds_read_b64_tr_b16 v[250:251], v5 offset:41472
    ds_read_b64_tr_b16 v[252:253], v6 offset:40960
    ds_read_b64_tr_b16 v[254:255], v6 offset:41472
    s_waitcnt lgkmcnt(0)
    v_dot2c_f32_bf16 v232, v16, v248
    v_dot2c_f32_bf16 v232, v17, v249
    v_dot2c_f32_bf16 v176, v16, v96
    v_dot2c_f32_bf16 v176, v17, v97
    v_dot2c_f32_bf16 v236, v16, v252
    v_dot2c_f32_bf16 v236, v17, v253
    v_dot2c_f32_bf16 v180, v96, v96
    v_dot2c_f32_bf16 v180, v97, v97
    v_dot2c_f32_bf16 v232, v16, v250
    v_dot2c_f32_bf16 v232, v17, v251
    v_dot2c_f32_bf16 v184, v16, v98
    v_dot2c_f32_bf16 v184, v17, v99
    v_dot2c_f32_bf16 v236, v16, v254
    v_dot2c_f32_bf16 v236, v17, v255
    v_dot2c_f32_bf16 v188, v98, v98
    v_dot2c_f32_bf16 v188, v99, v99
    v_dot2c_f32_bf16 v176, v16, v100
    v_dot2c_f32_bf16 v176, v17, v101
    v_dot2c_f32_bf16 v180, v100, v100
    v_dot2c_f32_bf16 v180, v101, v101
    v_dot2c_f32_bf16 v184, v16, v102
    v_dot2c_f32_bf16 v184, v17, v103
    v_dot2c_f32_bf16 v188, v102, v102
    v_dot2c_f32_bf16 v188, v103, v103
    v_mfma_f32_32x32x16_bf16 v[144:159], v[192:195], v[96:99], v[144:159]
    ds_read_b64_tr_b16 v[200:201], v12 offset:34816
    ds_read_b64_tr_b16 v[202:203], v12 offset:35328
    ds_read_b64_tr_b16 v[204:205], v13 offset:34816
    v_mfma_f32_32x32x16_bf16 v[160:175], v[196:199], v[96:99], v[160:175]
    ds_read_b64_tr_b16 v[206:207], v13 offset:35328
    ds_read_b64_tr_b16 v[208:209], v12 offset:36864
    ds_read_b64_tr_b16 v[210:211], v12 offset:37376
    s_waitcnt lgkmcnt(4)
    v_mfma_f32_32x32x16_bf16 v[144:159], v[200:203], v[100:103], v[144:159]
    ds_read_b64_tr_b16 v[212:213], v13 offset:36864
    ds_read_b64_tr_b16 v[214:215], v13 offset:37376
    ds_read_b64_tr_b16 v[216:217], v12 offset:38912
    s_waitcnt lgkmcnt(5)
    v_mfma_f32_32x32x16_bf16 v[160:175], v[204:207], v[100:103], v[160:175]
    ds_read_b64_tr_b16 v[218:219], v12 offset:39424
    ds_read_b64_tr_b16 v[220:221], v13 offset:38912
    ds_read_b64_tr_b16 v[222:223], v13 offset:39424
    s_barrier
    v_dot2c_f32_bf16 v176, v16, v104
    v_dot2c_f32_bf16 v176, v17, v105
    v_dot2c_f32_bf16 v180, v104, v104
    v_dot2c_f32_bf16 v180, v105, v105
    v_dot2c_f32_bf16 v184, v16, v106
    v_dot2c_f32_bf16 v184, v17, v107
    v_dot2c_f32_bf16 v188, v106, v106
    v_dot2c_f32_bf16 v188, v107, v107
    v_dot2c_f32_bf16 v176, v16, v108
    v_dot2c_f32_bf16 v176, v17, v109
    v_dot2c_f32_bf16 v180, v108, v108
    v_dot2c_f32_bf16 v180, v109, v109
    v_dot2c_f32_bf16 v184, v16, v110
    v_dot2c_f32_bf16 v184, v17, v111
    v_dot2c_f32_bf16 v188, v110, v110
    v_dot2c_f32_bf16 v188, v111, v111
    s_waitcnt lgkmcnt(6)
    v_mfma_f32_32x32x16_bf16 v[144:159], v[208:211], v[104:107], v[144:159]
    ds_read_b64_tr_b16 v[192:193], v12 offset:40960
    ds_read_b64_tr_b16 v[194:195], v12 offset:41472
    ds_read_b64_tr_b16 v[196:197], v13 offset:40960
    s_waitcnt lgkmcnt(7)
    v_mfma_f32_32x32x16_bf16 v[160:175], v[212:215], v[104:107], v[160:175]
    ds_read_b64_tr_b16 v[198:199], v13 offset:41472
    ds_read_b128 v[112:115], v8 offset:16384
    ds_read_b128 v[116:119], v9 offset:16384
    s_waitcnt lgkmcnt(8)
    v_mfma_f32_32x32x16_bf16 v[144:159], v[216:219], v[108:111], v[144:159]
    ds_read_b128 v[120:123], v10 offset:16384
    ds_read_b128 v[124:127], v11 offset:16384
    ds_read_b64_tr_b16 v[240:241], v5 offset:49152
    s_waitcnt lgkmcnt(9)
    v_mfma_f32_32x32x16_bf16 v[160:175], v[220:223], v[108:111], v[160:175]
    ds_read_b64_tr_b16 v[242:243], v5 offset:49664
    ds_read_b64_tr_b16 v[244:245], v6 offset:49152
    ds_read_b64_tr_b16 v[246:247], v6 offset:49664
    s_waitcnt lgkmcnt(0)
    v_dot2c_f32_bf16 v232, v16, v240
    v_dot2c_f32_bf16 v232, v17, v241
    v_dot2c_f32_bf16 v176, v16, v112
    v_dot2c_f32_bf16 v176, v17, v113
    v_dot2c_f32_bf16 v236, v16, v244
    v_dot2c_f32_bf16 v236, v17, v245
    v_dot2c_f32_bf16 v180, v112, v112
    v_dot2c_f32_bf16 v180, v113, v113
    v_dot2c_f32_bf16 v232, v16, v242
    v_dot2c_f32_bf16 v232, v17, v243
    v_dot2c_f32_bf16 v184, v16, v114
    v_dot2c_f32_bf16 v184, v17, v115
    v_dot2c_f32_bf16 v236, v16, v246
    v_dot2c_f32_bf16 v236, v17, v247
    v_dot2c_f32_bf16 v188, v114, v114
    v_dot2c_f32_bf16 v188, v115, v115
    v_dot2c_f32_bf16 v176, v16, v116
    v_dot2c_f32_bf16 v176, v17, v117
    v_dot2c_f32_bf16 v180, v116, v116
    v_dot2c_f32_bf16 v180, v117, v117
    v_dot2c_f32_bf16 v184, v16, v118
    v_dot2c_f32_bf16 v184, v17, v119
    v_dot2c_f32_bf16 v188, v118, v118
    v_dot2c_f32_bf16 v188, v119, v119
    v_mfma_f32_32x32x16_bf16 v[144:159], v[192:195], v[112:115], v[144:159]
    ds_write2st64_b32 v3, v232, v236 offset0:0 offset1:4
    ds_read_b64_tr_b16 v[200:201], v12 offset:43008
    ds_read_b64_tr_b16 v[202:203], v12 offset:43520
    ds_read_b64_tr_b16 v[204:205], v13 offset:43008
    v_mfma_f32_32x32x16_bf16 v[160:175], v[196:199], v[112:115], v[160:175]
    ds_read_b64_tr_b16 v[206:207], v13 offset:43520
    ds_read_b64_tr_b16 v[208:209], v12 offset:45056
    ds_read_b64_tr_b16 v[210:211], v12 offset:45568
    s_mov_b64 exec, 3
    buffer_load_dword v15, v4, s[36:39], 0 offen sc1
    s_mov_b64 exec, -1
    s_waitcnt lgkmcnt(4)
    v_mfma_f32_32x32x16_bf16 v[144:159], v[200:203], v[116:119], v[144:159]
    ds_read_b64_tr_b16 v[212:213], v13 offset:45056
    ds_read_b64_tr_b16 v[214:215], v13 offset:45568
    ds_read_b64_tr_b16 v[216:217], v12 offset:47104
    s_waitcnt lgkmcnt(5)
    v_mfma_f32_32x32x16_bf16 v[160:175], v[204:207], v[116:119], v[160:175]
    ds_read_b64_tr_b16 v[218:219], v12 offset:47616
    ds_read_b64_tr_b16 v[220:221], v13 offset:47104
    ds_read_b64_tr_b16 v[222:223], v13 offset:47616
    s_barrier
    v_dot2c_f32_bf16 v176, v16, v120
    v_dot2c_f32_bf16 v176, v17, v121
    v_dot2c_f32_bf16 v180, v120, v120
    v_dot2c_f32_bf16 v180, v121, v121
    v_dot2c_f32_bf16 v184, v16, v122
    v_dot2c_f32_bf16 v184, v17, v123
    v_dot2c_f32_bf16 v188, v122, v122
    v_dot2c_f32_bf16 v188, v123, v123
    v_dot2c_f32_bf16 v176, v16, v124
    v_dot2c_f32_bf16 v176, v17, v125
    v_dot2c_f32_bf16 v180, v124, v124
    v_dot2c_f32_bf16 v180, v125, v125
    v_dot2c_f32_bf16 v184, v16, v126
    v_dot2c_f32_bf16 v184, v17, v127
    v_dot2c_f32_bf16 v188, v126, v126
    v_dot2c_f32_bf16 v188, v127, v127
    s_waitcnt lgkmcnt(6)
    v_mfma_f32_32x32x16_bf16 v[144:159], v[208:211], v[120:123], v[144:159]
    ds_read_b64_tr_b16 v[192:193], v12 offset:49152
    ds_read_b64_tr_b16 v[194:195], v12 offset:49664
    ds_read_b64_tr_b16 v[196:197], v13 offset:49152
    s_waitcnt lgkmcnt(7)
    v_mfma_f32_32x32x16_bf16 v[160:175], v[212:215], v[120:123], v[160:175]
    ds_read_b64_tr_b16 v[198:199], v13 offset:49664
    ds_read_b128 v[128:131], v8 offset:32768
    ds_read_b128 v[132:135], v9 offset:32768
    s_waitcnt lgkmcnt(8)
    v_mfma_f32_32x32x16_bf16 v[144:159], v[216:219], v[124:127], v[144:159]
    ds_read_b128 v[136:139], v10 offset:32768
    ds_read_b128 v[140:143], v11 offset:32768
    ds_read_b128 v[240:243], v7 offset:0
    s_waitcnt lgkmcnt(9)
    v_mfma_f32_32x32x16_bf16 v[160:175], v[220:223], v[124:127], v[160:175]
    ds_read_b128 v[244:247], v7 offset:1024
    ds_read_b64_tr_b16 v[200:201], v12 offset:51200
    ds_read_b64_tr_b16 v[202:203], v12 offset:51712
    s_waitcnt lgkmcnt(4)
    v_dot2c_f32_bf16 v176, v16, v128
    v_dot2c_f32_bf16 v176, v17, v129
    v_dot2c_f32_bf16 v180, v128, v128
    v_dot2c_f32_bf16 v180, v129, v129
    v_dot2c_f32_bf16 v184, v16, v130
    v_dot2c_f32_bf16 v184, v17, v131
    v_dot2c_f32_bf16 v188, v130, v130
    v_dot2c_f32_bf16 v188, v131, v131
    v_dot2c_f32_bf16 v176, v16, v132
    v_dot2c_f32_bf16 v176, v17, v133
    v_dot2c_f32_bf16 v180, v132, v132
    v_dot2c_f32_bf16 v180, v133, v133
    v_dot2c_f32_bf16 v184, v16, v134
    v_dot2c_f32_bf16 v184, v17, v135
    v_dot2c_f32_bf16 v188, v134, v134
    v_dot2c_f32_bf16 v188, v135, v135
    v_dot2c_f32_bf16 v176, v16, v136
    v_dot2c_f32_bf16 v176, v17, v137
    v_dot2c_f32_bf16 v180, v136, v136
    v_dot2c_f32_bf16 v180, v137, v137
    v_dot2c_f32_bf16 v184, v16, v138
    v_dot2c_f32_bf16 v184, v17, v139
    v_dot2c_f32_bf16 v188, v138, v138
    v_dot2c_f32_bf16 v188, v139, v139
    v_dot2c_f32_bf16 v176, v16, v140
    v_dot2c_f32_bf16 v176, v17, v141
    v_dot2c_f32_bf16 v180, v140, v140
    v_dot2c_f32_bf16 v180, v141, v141
    v_dot2c_f32_bf16 v184, v16, v142
    v_dot2c_f32_bf16 v184, v17, v143
    v_dot2c_f32_bf16 v188, v142, v142
    v_dot2c_f32_bf16 v188, v143, v143
    s_waitcnt lgkmcnt(2)
    v_mfma_f32_32x32x16_bf16 v[144:159], v[192:195], v[128:131], v[144:159]
    ds_read_b64_tr_b16 v[204:205], v13 offset:51200
    ds_read_b64_tr_b16 v[206:207], v13 offset:51712
    ds_read_b64_tr_b16 v[208:209], v12 offset:53248
    v_mfma_f32_32x32x16_bf16 v[160:175], v[196:199], v[128:131], v[160:175]
    ds_read_b64_tr_b16 v[210:211], v12 offset:53760
    ds_read_b64_tr_b16 v[212:213], v13 offset:53248
    ds_read_b64_tr_b16 v[214:215], v13 offset:53760
    s_waitcnt lgkmcnt(6)
    v_mfma_f32_32x32x16_bf16 v[144:159], v[200:203], v[132:135], v[144:159]
    ds_read_b64_tr_b16 v[216:217], v12 offset:55296
    ds_read_b64_tr_b16 v[218:219], v12 offset:55808
    ds_read_b64_tr_b16 v[220:221], v13 offset:55296
    s_waitcnt lgkmcnt(7)
    v_mfma_f32_32x32x16_bf16 v[160:175], v[204:207], v[132:135], v[160:175]
    ds_read_b64_tr_b16 v[222:223], v13 offset:55808
    v_add_f32 v240, v240, v241
    v_add_f32 v242, v242, v243
    s_waitcnt lgkmcnt(6)
    v_mfma_f32_32x32x16_bf16 v[144:159], v[208:211], v[136:139], v[144:159]
    v_add_f32 v244, v244, v245
    v_add_f32 v246, v246, v247
    v_add_f32 v232, v240, v242
    v_add_f32 v236, v244, v246
    v_add_f32 v176, v176, v184
    s_waitcnt lgkmcnt(4)
    v_mfma_f32_32x32x16_bf16 v[160:175], v[212:215], v[136:139], v[160:175]
    v_add_f32 v180, v180, v188
    v_cvt_pk_bf16_f32 v235, v232, v232
    v_and_b32 v26, 0xffff0000, v235
    v_sub_f32 v26, v232, v26
    v_cvt_pk_bf16_f32 v234, v232, v26
    s_waitcnt lgkmcnt(2)
    v_mfma_f32_32x32x16_bf16 v[144:159], v[216:219], v[140:143], v[144:159]
    v_permlane32_swap_b32 v176, v180
    v_add_f32 v176, v176, v180
    v_mov_b32_e64 v180, v176
    v_cvt_pk_bf16_f32 v239, v236, v236
    v_and_b32 v26, 0xffff0000, v239
    s_waitcnt lgkmcnt(0)
    v_mfma_f32_32x32x16_bf16 v[160:175], v[220:223], v[140:143], v[160:175]
    v_sub_f32 v26, v236, v26
    v_cvt_pk_bf16_f32 v238, v236, v26
    v_permlane32_swap_b32 v176, v180
    v_mul_f32 v20, 991054117, v176
    v_mul_f32 v180, 991054117, v180
    v_cvt_pk_bf16_f32 v22, -v20, -v20
    v_fma_f32 v180, -v20, v20, v180
    v_and_b32 v26, 0xffff0000, v22
    v_max_f32 v180, 0, v180
    v_add_f32_e64 v26, v20, v26
    v_add_f32 v180, 925353388, v180
    v_cvt_pk_bf16_f32 v23, -v26, 0
    v_rsq_f32 v21, v180
    s_nop 0
    v_mfma_f32_32x32x8_bf16 v[144:159], v[234:235], v[22:23], v[144:159]
    v_mfma_f32_32x32x8_bf16 v[160:175], v[238:239], v[22:23], v[160:175]
    s_mul_i32 s53, s68, 28672
    s_lshl_b32 s54, s48, 12
    s_add_u32 s53, s53, s54
    v_and_b32 v26, 15, v1
    v_bfe_u32 v27, v1, 4, 1
    v_lshlrev_b32 v27, 9, v27
    v_lshl_add_u32 v27, v26, 4, v27
    v_lshrrev_b32 v26, 5, v1
    v_lshl_add_u32 v27, v26, 8, v27
    s_nop 1
    v_pk_mul_f32 v[144:145], v[144:145], v[20:21] op_sel:[0,1] op_sel_hi:[1,1]
    v_pk_mul_f32 v[146:147], v[146:147], v[20:21] op_sel:[0,1] op_sel_hi:[1,1]
    v_pk_mul_f32 v[148:149], v[148:149], v[20:21] op_sel:[0,1] op_sel_hi:[1,1]
    v_pk_mul_f32 v[150:151], v[150:151], v[20:21] op_sel:[0,1] op_sel_hi:[1,1]
    v_cvt_pk_bf16_f32 v192, v144, v145
    v_cvt_pk_bf16_f32 v193, v146, v147
    v_cvt_pk_bf16_f32 v194, v148, v149
    v_cvt_pk_bf16_f32 v195, v150, v151
    s_nop 0
    v_permlane16_swap_b32 v192, v194
    v_permlane16_swap_b32 v193, v195
    buffer_store_dwordx4 v[192:195], v27, s[40:43], s53 offen offset:0 sc1
    v_pk_mul_f32 v[152:153], v[152:153], v[20:21] op_sel:[0,1] op_sel_hi:[1,1]
    v_pk_mul_f32 v[154:155], v[154:155], v[20:21] op_sel:[0,1] op_sel_hi:[1,1]
    v_pk_mul_f32 v[156:157], v[156:157], v[20:21] op_sel:[0,1] op_sel_hi:[1,1]
    v_pk_mul_f32 v[158:159], v[158:159], v[20:21] op_sel:[0,1] op_sel_hi:[1,1]
    v_cvt_pk_bf16_f32 v196, v152, v153
    v_cvt_pk_bf16_f32 v197, v154, v155
    v_cvt_pk_bf16_f32 v198, v156, v157
    v_cvt_pk_bf16_f32 v199, v158, v159
    s_nop 0
    v_permlane16_swap_b32 v196, v198
    v_permlane16_swap_b32 v197, v199
    buffer_store_dwordx4 v[196:199], v27, s[40:43], s53 offen offset:1024 sc1
    v_pk_mul_f32 v[160:161], v[160:161], v[20:21] op_sel:[0,1] op_sel_hi:[1,1]
    v_pk_mul_f32 v[162:163], v[162:163], v[20:21] op_sel:[0,1] op_sel_hi:[1,1]
    v_pk_mul_f32 v[164:165], v[164:165], v[20:21] op_sel:[0,1] op_sel_hi:[1,1]
    v_pk_mul_f32 v[166:167], v[166:167], v[20:21] op_sel:[0,1] op_sel_hi:[1,1]
    v_cvt_pk_bf16_f32 v200, v160, v161
    v_cvt_pk_bf16_f32 v201, v162, v163
    v_cvt_pk_bf16_f32 v202, v164, v165
    v_cvt_pk_bf16_f32 v203, v166, v167
    s_nop 0
    v_permlane16_swap_b32 v200, v202
    v_permlane16_swap_b32 v201, v203
    buffer_store_dwordx4 v[200:203], v27, s[40:43], s53 offen offset:2048 sc1
    v_pk_mul_f32 v[168:169], v[168:169], v[20:21] op_sel:[0,1] op_sel_hi:[1,1]
    v_pk_mul_f32 v[170:171], v[170:171], v[20:21] op_sel:[0,1] op_sel_hi:[1,1]
    v_pk_mul_f32 v[172:173], v[172:173], v[20:21] op_sel:[0,1] op_sel_hi:[1,1]
    v_pk_mul_f32 v[174:175], v[174:175], v[20:21] op_sel:[0,1] op_sel_hi:[1,1]
    v_cvt_pk_bf16_f32 v204, v168, v169
    v_cvt_pk_bf16_f32 v205, v170, v171
    v_cvt_pk_bf16_f32 v206, v172, v173
    v_cvt_pk_bf16_f32 v207, v174, v175
    s_nop 0
    v_permlane16_swap_b32 v204, v206
    v_permlane16_swap_b32 v205, v207
    buffer_store_dwordx4 v[204:207], v27, s[40:43], s53 offen offset:3072 sc1
    s_branch L_kvjoin_39
    .p2align 12
L_formV_37:
    s_barrier
    ds_read_b128 v[32:35], v8 offset:0
    ds_read_b128 v[36:39], v9 offset:0
    ds_read_b64_tr_b16 v[192:193], v12 offset:0
    ds_read_b64_tr_b16 v[194:195], v12 offset:512
    ds_read_b64_tr_b16 v[196:197], v13 offset:0
    ds_read_b64_tr_b16 v[198:199], v13 offset:512
    ds_read_b64_tr_b16 v[200:201], v12 offset:2048
    ds_read_b64_tr_b16 v[202:203], v12 offset:2560
    ds_read_b64_tr_b16 v[204:205], v13 offset:2048
    ds_read_b64_tr_b16 v[206:207], v13 offset:2560
    s_waitcnt lgkmcnt(8)
    v_mov_b32 v176, 0
    v_dot2c_f32_bf16 v176, v16, v32
    v_dot2c_f32_bf16 v176, v17, v33
    v_mov_b32 v180, 0
    v_dot2c_f32_bf16 v180, v32, v32
    v_dot2c_f32_bf16 v180, v33, v33
    v_mov_b32 v184, 0
    v_dot2c_f32_bf16 v184, v16, v34
    v_dot2c_f32_bf16 v184, v17, v35
    v_mov_b32_e64 v188, 0
    v_dot2c_f32_bf16 v188, v34, v34
    v_dot2c_f32_bf16 v188, v35, v35
    v_dot2c_f32_bf16 v176, v16, v36
    v_dot2c_f32_bf16 v176, v17, v37
    v_dot2c_f32_bf16 v180, v36, v36
    v_dot2c_f32_bf16 v180, v37, v37
    v_dot2c_f32_bf16 v184, v16, v38
    v_dot2c_f32_bf16 v184, v17, v39
    v_dot2c_f32_bf16 v188, v38, v38
    v_dot2c_f32_bf16 v188, v39, v39
    s_waitcnt lgkmcnt(6)
    v_mfma_f32_32x32x16_bf16 v[144:159], v[32:35], v[192:195], 0
    ds_read_b64_tr_b16 v[208:209], v12 offset:4096
    ds_read_b64_tr_b16 v[210:211], v12 offset:4608
    ds_read_b64_tr_b16 v[212:213], v13 offset:4096
    s_waitcnt lgkmcnt(7)
    v_mfma_f32_32x32x16_bf16 v[160:175], v[32:35], v[196:199], 0
    ds_read_b64_tr_b16 v[214:215], v13 offset:4608
    ds_read_b64_tr_b16 v[216:217], v12 offset:6144
    ds_read_b64_tr_b16 v[218:219], v12 offset:6656
    s_waitcnt lgkmcnt(8)
    v_mfma_f32_32x32x16_bf16 v[144:159], v[36:39], v[200:203], v[144:159]
    ds_read_b64_tr_b16 v[220:221], v13 offset:6144
    ds_read_b64_tr_b16 v[222:223], v13 offset:6656
    ds_read_b128 v[40:43], v10 offset:0
    s_waitcnt lgkmcnt(9)
    v_mfma_f32_32x32x16_bf16 v[160:175], v[36:39], v[204:207], v[160:175]
    ds_read_b128 v[44:47], v11 offset:0
    ds_read_b64_tr_b16 v[240:241], v5 offset:0
    ds_read_b64_tr_b16 v[242:243], v5 offset:512
    ds_read_b64_tr_b16 v[244:245], v6 offset:0
    ds_read_b64_tr_b16 v[246:247], v6 offset:512
    s_waitcnt lgkmcnt(0)
    v_mov_b32 v232, 0
    v_dot2c_f32_bf16 v232, v16, v240
    v_dot2c_f32_bf16 v232, v17, v241
    v_dot2c_f32_bf16 v176, v16, v40
    v_dot2c_f32_bf16 v176, v17, v41
    v_mov_b32_e64 v236, 0
    v_dot2c_f32_bf16 v236, v16, v244
    v_dot2c_f32_bf16 v236, v17, v245
    v_dot2c_f32_bf16 v180, v40, v40
    v_dot2c_f32_bf16 v180, v41, v41
    v_dot2c_f32_bf16 v232, v16, v242
    v_dot2c_f32_bf16 v232, v17, v243
    v_dot2c_f32_bf16 v184, v16, v42
    v_dot2c_f32_bf16 v184, v17, v43
    v_dot2c_f32_bf16 v236, v16, v246
    v_dot2c_f32_bf16 v236, v17, v247
    v_dot2c_f32_bf16 v188, v42, v42
    v_dot2c_f32_bf16 v188, v43, v43
    v_dot2c_f32_bf16 v176, v16, v44
    v_dot2c_f32_bf16 v176, v17, v45
    v_dot2c_f32_bf16 v180, v44, v44
    v_dot2c_f32_bf16 v180, v45, v45
    v_dot2c_f32_bf16 v184, v16, v46
    v_dot2c_f32_bf16 v184, v17, v47
    v_dot2c_f32_bf16 v188, v46, v46
    v_dot2c_f32_bf16 v188, v47, v47
    s_barrier
    v_mfma_f32_32x32x16_bf16 v[144:159], v[40:43], v[208:211], v[144:159]
    ds_read_b128 v[48:51], v8 offset:16384
    ds_read_b128 v[52:55], v9 offset:16384
    ds_read_b64_tr_b16 v[192:193], v12 offset:8192
    v_mfma_f32_32x32x16_bf16 v[160:175], v[40:43], v[212:215], v[160:175]
    ds_read_b64_tr_b16 v[194:195], v12 offset:8704
    ds_read_b64_tr_b16 v[196:197], v13 offset:8192
    ds_read_b64_tr_b16 v[198:199], v13 offset:8704
    v_mfma_f32_32x32x16_bf16 v[144:159], v[44:47], v[216:219], v[144:159]
    ds_read_b128 v[56:59], v10 offset:16384
    ds_read_b128 v[60:63], v11 offset:16384
    ds_read_b64_tr_b16 v[248:249], v5 offset:8192
    v_mfma_f32_32x32x16_bf16 v[160:175], v[44:47], v[220:223], v[160:175]
    ds_read_b64_tr_b16 v[250:251], v5 offset:8704
    ds_read_b64_tr_b16 v[252:253], v6 offset:8192
    ds_read_b64_tr_b16 v[254:255], v6 offset:8704
    s_waitcnt lgkmcnt(0)
    v_dot2c_f32_bf16 v232, v16, v248
    v_dot2c_f32_bf16 v232, v17, v249
    v_dot2c_f32_bf16 v176, v16, v48
    v_dot2c_f32_bf16 v176, v17, v49
    v_dot2c_f32_bf16 v236, v16, v252
    v_dot2c_f32_bf16 v236, v17, v253
    v_dot2c_f32_bf16 v180, v48, v48
    v_dot2c_f32_bf16 v180, v49, v49
    v_dot2c_f32_bf16 v232, v16, v250
    v_dot2c_f32_bf16 v232, v17, v251
    v_dot2c_f32_bf16 v184, v16, v50
    v_dot2c_f32_bf16 v184, v17, v51
    v_dot2c_f32_bf16 v236, v16, v254
    v_dot2c_f32_bf16 v236, v17, v255
    v_dot2c_f32_bf16 v188, v50, v50
    v_dot2c_f32_bf16 v188, v51, v51
    v_dot2c_f32_bf16 v176, v16, v52
    v_dot2c_f32_bf16 v176, v17, v53
    v_dot2c_f32_bf16 v180, v52, v52
    v_dot2c_f32_bf16 v180, v53, v53
    v_dot2c_f32_bf16 v184, v16, v54
    v_dot2c_f32_bf16 v184, v17, v55
    v_dot2c_f32_bf16 v188, v54, v54
    v_dot2c_f32_bf16 v188, v55, v55
    v_mfma_f32_32x32x16_bf16 v[144:159], v[48:51], v[192:195], v[144:159]
    ds_read_b64_tr_b16 v[200:201], v12 offset:10240
    ds_read_b64_tr_b16 v[202:203], v12 offset:10752
    ds_read_b64_tr_b16 v[204:205], v13 offset:10240
    v_mfma_f32_32x32x16_bf16 v[160:175], v[48:51], v[196:199], v[160:175]
    ds_read_b64_tr_b16 v[206:207], v13 offset:10752
    ds_read_b64_tr_b16 v[208:209], v12 offset:12288
    ds_read_b64_tr_b16 v[210:211], v12 offset:12800
    s_waitcnt lgkmcnt(4)
    v_mfma_f32_32x32x16_bf16 v[144:159], v[52:55], v[200:203], v[144:159]
    ds_read_b64_tr_b16 v[212:213], v13 offset:12288
    ds_read_b64_tr_b16 v[214:215], v13 offset:12800
    ds_read_b64_tr_b16 v[216:217], v12 offset:14336
    s_waitcnt lgkmcnt(5)
    v_mfma_f32_32x32x16_bf16 v[160:175], v[52:55], v[204:207], v[160:175]
    ds_read_b64_tr_b16 v[218:219], v12 offset:14848
    ds_read_b64_tr_b16 v[220:221], v13 offset:14336
    ds_read_b64_tr_b16 v[222:223], v13 offset:14848
    s_barrier
    v_dot2c_f32_bf16 v176, v16, v56
    v_dot2c_f32_bf16 v176, v17, v57
    v_dot2c_f32_bf16 v180, v56, v56
    v_dot2c_f32_bf16 v180, v57, v57
    v_dot2c_f32_bf16 v184, v16, v58
    v_dot2c_f32_bf16 v184, v17, v59
    v_dot2c_f32_bf16 v188, v58, v58
    v_dot2c_f32_bf16 v188, v59, v59
    v_dot2c_f32_bf16 v176, v16, v60
    v_dot2c_f32_bf16 v176, v17, v61
    v_dot2c_f32_bf16 v180, v60, v60
    v_dot2c_f32_bf16 v180, v61, v61
    v_dot2c_f32_bf16 v184, v16, v62
    v_dot2c_f32_bf16 v184, v17, v63
    v_dot2c_f32_bf16 v188, v62, v62
    v_dot2c_f32_bf16 v188, v63, v63
    s_waitcnt lgkmcnt(6)
    v_mfma_f32_32x32x16_bf16 v[144:159], v[56:59], v[208:211], v[144:159]
    ds_read_b128 v[64:67], v8 offset:32768
    ds_read_b128 v[68:71], v9 offset:32768
    ds_read_b64_tr_b16 v[192:193], v12 offset:16384
    s_waitcnt lgkmcnt(7)
    v_mfma_f32_32x32x16_bf16 v[160:175], v[56:59], v[212:215], v[160:175]
    ds_read_b64_tr_b16 v[194:195], v12 offset:16896
    ds_read_b64_tr_b16 v[196:197], v13 offset:16384
    ds_read_b64_tr_b16 v[198:199], v13 offset:16896
    s_waitcnt lgkmcnt(8)
    v_mfma_f32_32x32x16_bf16 v[144:159], v[60:63], v[216:219], v[144:159]
    ds_read_b128 v[72:75], v10 offset:32768
    ds_read_b128 v[76:79], v11 offset:32768
    ds_read_b64_tr_b16 v[240:241], v5 offset:16384
    s_waitcnt lgkmcnt(9)
    v_mfma_f32_32x32x16_bf16 v[160:175], v[60:63], v[220:223], v[160:175]
    ds_read_b64_tr_b16 v[242:243], v5 offset:16896
    ds_read_b64_tr_b16 v[244:245], v6 offset:16384
    ds_read_b64_tr_b16 v[246:247], v6 offset:16896
    ds_read_b64_tr_b16 v[248:249], v5 offset:24576
    ds_read_b64_tr_b16 v[250:251], v5 offset:25088
    ds_read_b64_tr_b16 v[252:253], v6 offset:24576
    ds_read_b64_tr_b16 v[254:255], v6 offset:25088
    s_waitcnt lgkmcnt(0)
    v_dot2c_f32_bf16 v232, v16, v240
    v_dot2c_f32_bf16 v232, v17, v241
    v_dot2c_f32_bf16 v176, v16, v64
    v_dot2c_f32_bf16 v176, v17, v65
    v_dot2c_f32_bf16 v236, v16, v244
    v_dot2c_f32_bf16 v236, v17, v245
    v_dot2c_f32_bf16 v180, v64, v64
    v_dot2c_f32_bf16 v180, v65, v65
    v_dot2c_f32_bf16 v232, v16, v242
    v_dot2c_f32_bf16 v232, v17, v243
    v_dot2c_f32_bf16 v184, v16, v66
    v_dot2c_f32_bf16 v184, v17, v67
    v_dot2c_f32_bf16 v236, v16, v246
    v_dot2c_f32_bf16 v236, v17, v247
    v_dot2c_f32_bf16 v188, v66, v66
    v_dot2c_f32_bf16 v188, v67, v67
    v_dot2c_f32_bf16 v232, v16, v248
    v_dot2c_f32_bf16 v232, v17, v249
    v_dot2c_f32_bf16 v176, v16, v68
    v_dot2c_f32_bf16 v176, v17, v69
    v_dot2c_f32_bf16 v236, v16, v252
    v_dot2c_f32_bf16 v236, v17, v253
    v_dot2c_f32_bf16 v180, v68, v68
    v_dot2c_f32_bf16 v180, v69, v69
    v_dot2c_f32_bf16 v232, v16, v250
    v_dot2c_f32_bf16 v232, v17, v251
    v_dot2c_f32_bf16 v184, v16, v70
    v_dot2c_f32_bf16 v184, v17, v71
    v_dot2c_f32_bf16 v236, v16, v254
    v_dot2c_f32_bf16 v236, v17, v255
    v_dot2c_f32_bf16 v188, v70, v70
    v_dot2c_f32_bf16 v188, v71, v71
    v_mfma_f32_32x32x16_bf16 v[144:159], v[64:67], v[192:195], v[144:159]
    ds_read_b64_tr_b16 v[200:201], v12 offset:18432
    ds_read_b64_tr_b16 v[202:203], v12 offset:18944
    ds_read_b64_tr_b16 v[204:205], v13 offset:18432
    v_mfma_f32_32x32x16_bf16 v[160:175], v[64:67], v[196:199], v[160:175]
    ds_read_b64_tr_b16 v[206:207], v13 offset:18944
    ds_read_b64_tr_b16 v[208:209], v12 offset:20480
    ds_read_b64_tr_b16 v[210:211], v12 offset:20992
    s_waitcnt lgkmcnt(4)
    v_mfma_f32_32x32x16_bf16 v[144:159], v[68:71], v[200:203], v[144:159]
    ds_read_b64_tr_b16 v[212:213], v13 offset:20480
    ds_read_b64_tr_b16 v[214:215], v13 offset:20992
    ds_read_b64_tr_b16 v[216:217], v12 offset:22528
    s_waitcnt lgkmcnt(5)
    v_mfma_f32_32x32x16_bf16 v[160:175], v[68:71], v[204:207], v[160:175]
    ds_read_b64_tr_b16 v[218:219], v12 offset:23040
    ds_read_b64_tr_b16 v[220:221], v13 offset:22528
    ds_read_b64_tr_b16 v[222:223], v13 offset:23040
    s_barrier
    v_dot2c_f32_bf16 v176, v16, v72
    v_dot2c_f32_bf16 v176, v17, v73
    v_dot2c_f32_bf16 v180, v72, v72
    v_dot2c_f32_bf16 v180, v73, v73
    v_dot2c_f32_bf16 v184, v16, v74
    v_dot2c_f32_bf16 v184, v17, v75
    v_dot2c_f32_bf16 v188, v74, v74
    v_dot2c_f32_bf16 v188, v75, v75
    v_dot2c_f32_bf16 v176, v16, v76
    v_dot2c_f32_bf16 v176, v17, v77
    v_dot2c_f32_bf16 v180, v76, v76
    v_dot2c_f32_bf16 v180, v77, v77
    v_dot2c_f32_bf16 v184, v16, v78
    v_dot2c_f32_bf16 v184, v17, v79
    v_dot2c_f32_bf16 v188, v78, v78
    v_dot2c_f32_bf16 v188, v79, v79
    s_waitcnt lgkmcnt(6)
    v_mfma_f32_32x32x16_bf16 v[144:159], v[72:75], v[208:211], v[144:159]
    ds_read_b64_tr_b16 v[192:193], v12 offset:24576
    ds_read_b64_tr_b16 v[194:195], v12 offset:25088
    ds_read_b64_tr_b16 v[196:197], v13 offset:24576
    s_waitcnt lgkmcnt(7)
    v_mfma_f32_32x32x16_bf16 v[160:175], v[72:75], v[212:215], v[160:175]
    ds_read_b64_tr_b16 v[198:199], v13 offset:25088
    ds_read_b128 v[80:83], v8 offset:49152
    ds_read_b128 v[84:87], v9 offset:49152
    s_waitcnt lgkmcnt(8)
    v_mfma_f32_32x32x16_bf16 v[144:159], v[76:79], v[216:219], v[144:159]
    ds_read_b128 v[88:91], v10 offset:49152
    ds_read_b128 v[92:95], v11 offset:49152
    ds_read_b64_tr_b16 v[240:241], v5 offset:32768
    s_waitcnt lgkmcnt(9)
    v_mfma_f32_32x32x16_bf16 v[160:175], v[76:79], v[220:223], v[160:175]
    ds_read_b64_tr_b16 v[242:243], v5 offset:33280
    ds_read_b64_tr_b16 v[244:245], v6 offset:32768
    ds_read_b64_tr_b16 v[246:247], v6 offset:33280
    s_waitcnt lgkmcnt(0)
    v_dot2c_f32_bf16 v232, v16, v240
    v_dot2c_f32_bf16 v232, v17, v241
    v_dot2c_f32_bf16 v176, v16, v80
    v_dot2c_f32_bf16 v176, v17, v81
    v_dot2c_f32_bf16 v236, v16, v244
    v_dot2c_f32_bf16 v236, v17, v245
    v_dot2c_f32_bf16 v180, v80, v80
    v_dot2c_f32_bf16 v180, v81, v81
    v_dot2c_f32_bf16 v232, v16, v242
    v_dot2c_f32_bf16 v232, v17, v243
    v_dot2c_f32_bf16 v184, v16, v82
    v_dot2c_f32_bf16 v184, v17, v83
    v_dot2c_f32_bf16 v236, v16, v246
    v_dot2c_f32_bf16 v236, v17, v247
    v_dot2c_f32_bf16 v188, v82, v82
    v_dot2c_f32_bf16 v188, v83, v83
    v_dot2c_f32_bf16 v176, v16, v84
    v_dot2c_f32_bf16 v176, v17, v85
    v_dot2c_f32_bf16 v180, v84, v84
    v_dot2c_f32_bf16 v180, v85, v85
    v_dot2c_f32_bf16 v184, v16, v86
    v_dot2c_f32_bf16 v184, v17, v87
    v_dot2c_f32_bf16 v188, v86, v86
    v_dot2c_f32_bf16 v188, v87, v87
    v_mfma_f32_32x32x16_bf16 v[144:159], v[80:83], v[192:195], v[144:159]
    ds_read_b64_tr_b16 v[200:201], v12 offset:26624
    ds_read_b64_tr_b16 v[202:203], v12 offset:27136
    ds_read_b64_tr_b16 v[204:205], v13 offset:26624
    v_mfma_f32_32x32x16_bf16 v[160:175], v[80:83], v[196:199], v[160:175]
    ds_read_b64_tr_b16 v[206:207], v13 offset:27136
    ds_read_b64_tr_b16 v[208:209], v12 offset:28672
    ds_read_b64_tr_b16 v[210:211], v12 offset:29184
    s_waitcnt lgkmcnt(4)
    v_mfma_f32_32x32x16_bf16 v[144:159], v[84:87], v[200:203], v[144:159]
    ds_read_b64_tr_b16 v[212:213], v13 offset:28672
    ds_read_b64_tr_b16 v[214:215], v13 offset:29184
    ds_read_b64_tr_b16 v[216:217], v12 offset:30720
    s_waitcnt lgkmcnt(5)
    v_mfma_f32_32x32x16_bf16 v[160:175], v[84:87], v[204:207], v[160:175]
    ds_read_b64_tr_b16 v[218:219], v12 offset:31232
    ds_read_b64_tr_b16 v[220:221], v13 offset:30720
    ds_read_b64_tr_b16 v[222:223], v13 offset:31232
    s_barrier
    v_dot2c_f32_bf16 v176, v16, v88
    v_dot2c_f32_bf16 v176, v17, v89
    v_dot2c_f32_bf16 v180, v88, v88
    v_dot2c_f32_bf16 v180, v89, v89
    v_dot2c_f32_bf16 v184, v16, v90
    v_dot2c_f32_bf16 v184, v17, v91
    v_dot2c_f32_bf16 v188, v90, v90
    v_dot2c_f32_bf16 v188, v91, v91
    v_dot2c_f32_bf16 v176, v16, v92
    v_dot2c_f32_bf16 v176, v17, v93
    v_dot2c_f32_bf16 v180, v92, v92
    v_dot2c_f32_bf16 v180, v93, v93
    v_dot2c_f32_bf16 v184, v16, v94
    v_dot2c_f32_bf16 v184, v17, v95
    v_dot2c_f32_bf16 v188, v94, v94
    v_dot2c_f32_bf16 v188, v95, v95
    s_waitcnt lgkmcnt(6)
    v_mfma_f32_32x32x16_bf16 v[144:159], v[88:91], v[208:211], v[144:159]
    ds_read_b64_tr_b16 v[192:193], v12 offset:32768
    ds_read_b64_tr_b16 v[194:195], v12 offset:33280
    ds_read_b64_tr_b16 v[196:197], v13 offset:32768
    s_waitcnt lgkmcnt(7)
    v_mfma_f32_32x32x16_bf16 v[160:175], v[88:91], v[212:215], v[160:175]
    ds_read_b64_tr_b16 v[198:199], v13 offset:33280
    ds_read_b128 v[96:99], v8 offset:0
    ds_read_b128 v[100:103], v9 offset:0
    s_waitcnt lgkmcnt(8)
    v_mfma_f32_32x32x16_bf16 v[144:159], v[92:95], v[216:219], v[144:159]
    ds_read_b128 v[104:107], v10 offset:0
    ds_read_b128 v[108:111], v11 offset:0
    ds_read_b64_tr_b16 v[248:249], v5 offset:40960
    s_waitcnt lgkmcnt(9)
    v_mfma_f32_32x32x16_bf16 v[160:175], v[92:95], v[220:223], v[160:175]
    ds_read_b64_tr_b16 v[250:251], v5 offset:41472
    ds_read_b64_tr_b16 v[252:253], v6 offset:40960
    ds_read_b64_tr_b16 v[254:255], v6 offset:41472
    s_waitcnt lgkmcnt(0)
    v_dot2c_f32_bf16 v232, v16, v248
    v_dot2c_f32_bf16 v232, v17, v249
    v_dot2c_f32_bf16 v176, v16, v96
    v_dot2c_f32_bf16 v176, v17, v97
    v_dot2c_f32_bf16 v236, v16, v252
    v_dot2c_f32_bf16 v236, v17, v253
    v_dot2c_f32_bf16 v180, v96, v96
    v_dot2c_f32_bf16 v180, v97, v97
    v_dot2c_f32_bf16 v232, v16, v250
    v_dot2c_f32_bf16 v232, v17, v251
    v_dot2c_f32_bf16 v184, v16, v98
    v_dot2c_f32_bf16 v184, v17, v99
    v_dot2c_f32_bf16 v236, v16, v254
    v_dot2c_f32_bf16 v236, v17, v255
    v_dot2c_f32_bf16 v188, v98, v98
    v_dot2c_f32_bf16 v188, v99, v99
    v_dot2c_f32_bf16 v176, v16, v100
    v_dot2c_f32_bf16 v176, v17, v101
    v_dot2c_f32_bf16 v180, v100, v100
    v_dot2c_f32_bf16 v180, v101, v101
    v_dot2c_f32_bf16 v184, v16, v102
    v_dot2c_f32_bf16 v184, v17, v103
    v_dot2c_f32_bf16 v188, v102, v102
    v_dot2c_f32_bf16 v188, v103, v103
    v_mfma_f32_32x32x16_bf16 v[144:159], v[96:99], v[192:195], v[144:159]
    ds_read_b64_tr_b16 v[200:201], v12 offset:34816
    ds_read_b64_tr_b16 v[202:203], v12 offset:35328
    ds_read_b64_tr_b16 v[204:205], v13 offset:34816
    v_mfma_f32_32x32x16_bf16 v[160:175], v[96:99], v[196:199], v[160:175]
    ds_read_b64_tr_b16 v[206:207], v13 offset:35328
    ds_read_b64_tr_b16 v[208:209], v12 offset:36864
    ds_read_b64_tr_b16 v[210:211], v12 offset:37376
    s_waitcnt lgkmcnt(4)
    v_mfma_f32_32x32x16_bf16 v[144:159], v[100:103], v[200:203], v[144:159]
    ds_read_b64_tr_b16 v[212:213], v13 offset:36864
    ds_read_b64_tr_b16 v[214:215], v13 offset:37376
    ds_read_b64_tr_b16 v[216:217], v12 offset:38912
    s_waitcnt lgkmcnt(5)
    v_mfma_f32_32x32x16_bf16 v[160:175], v[100:103], v[204:207], v[160:175]
    ds_read_b64_tr_b16 v[218:219], v12 offset:39424
    ds_read_b64_tr_b16 v[220:221], v13 offset:38912
    ds_read_b64_tr_b16 v[222:223], v13 offset:39424
    s_barrier
    v_dot2c_f32_bf16 v176, v16, v104
    v_dot2c_f32_bf16 v176, v17, v105
    v_dot2c_f32_bf16 v180, v104, v104
    v_dot2c_f32_bf16 v180, v105, v105
    v_dot2c_f32_bf16 v184, v16, v106
    v_dot2c_f32_bf16 v184, v17, v107
    v_dot2c_f32_bf16 v188, v106, v106
    v_dot2c_f32_bf16 v188, v107, v107
    v_dot2c_f32_bf16 v176, v16, v108
    v_dot2c_f32_bf16 v176, v17, v109
    v_dot2c_f32_bf16 v180, v108, v108
    v_dot2c_f32_bf16 v180, v109, v109
    v_dot2c_f32_bf16 v184, v16, v110
    v_dot2c_f32_bf16 v184, v17, v111
    v_dot2c_f32_bf16 v188, v110, v110
    v_dot2c_f32_bf16 v188, v111, v111
    s_waitcnt lgkmcnt(6)
    v_mfma_f32_32x32x16_bf16 v[144:159], v[104:107], v[208:211], v[144:159]
    ds_read_b64_tr_b16 v[192:193], v12 offset:40960
    ds_read_b64_tr_b16 v[194:195], v12 offset:41472
    ds_read_b64_tr_b16 v[196:197], v13 offset:40960
    s_waitcnt lgkmcnt(7)
    v_mfma_f32_32x32x16_bf16 v[160:175], v[104:107], v[212:215], v[160:175]
    ds_read_b64_tr_b16 v[198:199], v13 offset:41472
    ds_read_b128 v[112:115], v8 offset:16384
    ds_read_b128 v[116:119], v9 offset:16384
    s_waitcnt lgkmcnt(8)
    v_mfma_f32_32x32x16_bf16 v[144:159], v[108:111], v[216:219], v[144:159]
    ds_read_b128 v[120:123], v10 offset:16384
    ds_read_b128 v[124:127], v11 offset:16384
    ds_read_b64_tr_b16 v[240:241], v5 offset:49152
    s_waitcnt lgkmcnt(9)
    v_mfma_f32_32x32x16_bf16 v[160:175], v[108:111], v[220:223], v[160:175]
    ds_read_b64_tr_b16 v[242:243], v5 offset:49664
    ds_read_b64_tr_b16 v[244:245], v6 offset:49152
    ds_read_b64_tr_b16 v[246:247], v6 offset:49664
    s_waitcnt lgkmcnt(0)
    v_dot2c_f32_bf16 v232, v16, v240
    v_dot2c_f32_bf16 v232, v17, v241
    v_dot2c_f32_bf16 v176, v16, v112
    v_dot2c_f32_bf16 v176, v17, v113
    v_dot2c_f32_bf16 v236, v16, v244
    v_dot2c_f32_bf16 v236, v17, v245
    v_dot2c_f32_bf16 v180, v112, v112
    v_dot2c_f32_bf16 v180, v113, v113
    v_dot2c_f32_bf16 v232, v16, v242
    v_dot2c_f32_bf16 v232, v17, v243
    v_dot2c_f32_bf16 v184, v16, v114
    v_dot2c_f32_bf16 v184, v17, v115
    v_dot2c_f32_bf16 v236, v16, v246
    v_dot2c_f32_bf16 v236, v17, v247
    v_dot2c_f32_bf16 v188, v114, v114
    v_dot2c_f32_bf16 v188, v115, v115
    v_dot2c_f32_bf16 v176, v16, v116
    v_dot2c_f32_bf16 v176, v17, v117
    v_dot2c_f32_bf16 v180, v116, v116
    v_dot2c_f32_bf16 v180, v117, v117
    v_dot2c_f32_bf16 v184, v16, v118
    v_dot2c_f32_bf16 v184, v17, v119
    v_dot2c_f32_bf16 v188, v118, v118
    v_dot2c_f32_bf16 v188, v119, v119
    v_mfma_f32_32x32x16_bf16 v[144:159], v[112:115], v[192:195], v[144:159]
    ds_write2st64_b32 v3, v232, v236 offset0:0 offset1:4
    ds_read_b64_tr_b16 v[200:201], v12 offset:43008
    ds_read_b64_tr_b16 v[202:203], v12 offset:43520
    ds_read_b64_tr_b16 v[204:205], v13 offset:43008
    v_mfma_f32_32x32x16_bf16 v[160:175], v[112:115], v[196:199], v[160:175]
    ds_read_b64_tr_b16 v[206:207], v13 offset:43520
    ds_read_b64_tr_b16 v[208:209], v12 offset:45056
    ds_read_b64_tr_b16 v[210:211], v12 offset:45568
    s_mov_b64 exec, 3
    buffer_load_dword v15, v4, s[36:39], 0 offen sc1
    s_mov_b64 exec, -1
    s_waitcnt lgkmcnt(4)
    v_mfma_f32_32x32x16_bf16 v[144:159], v[116:119], v[200:203], v[144:159]
    ds_read_b64_tr_b16 v[212:213], v13 offset:45056
    ds_read_b64_tr_b16 v[214:215], v13 offset:45568
    ds_read_b64_tr_b16 v[216:217], v12 offset:47104
    s_waitcnt lgkmcnt(5)
    v_mfma_f32_32x32x16_bf16 v[160:175], v[116:119], v[204:207], v[160:175]
    ds_read_b64_tr_b16 v[218:219], v12 offset:47616
    ds_read_b64_tr_b16 v[220:221], v13 offset:47104
    ds_read_b64_tr_b16 v[222:223], v13 offset:47616
    s_barrier
    v_dot2c_f32_bf16 v176, v16, v120
    v_dot2c_f32_bf16 v176, v17, v121
    v_dot2c_f32_bf16 v180, v120, v120
    v_dot2c_f32_bf16 v180, v121, v121
    v_dot2c_f32_bf16 v184, v16, v122
    v_dot2c_f32_bf16 v184, v17, v123
    v_dot2c_f32_bf16 v188, v122, v122
    v_dot2c_f32_bf16 v188, v123, v123
    v_dot2c_f32_bf16 v176, v16, v124
    v_dot2c_f32_bf16 v176, v17, v125
    v_dot2c_f32_bf16 v180, v124, v124
    v_dot2c_f32_bf16 v180, v125, v125
    v_dot2c_f32_bf16 v184, v16, v126
    v_dot2c_f32_bf16 v184, v17, v127
    v_dot2c_f32_bf16 v188, v126, v126
    v_dot2c_f32_bf16 v188, v127, v127
    s_waitcnt lgkmcnt(6)
    v_mfma_f32_32x32x16_bf16 v[144:159], v[120:123], v[208:211], v[144:159]
    ds_read_b64_tr_b16 v[192:193], v12 offset:49152
    ds_read_b64_tr_b16 v[194:195], v12 offset:49664
    ds_read_b64_tr_b16 v[196:197], v13 offset:49152
    s_waitcnt lgkmcnt(7)
    v_mfma_f32_32x32x16_bf16 v[160:175], v[120:123], v[212:215], v[160:175]
    ds_read_b64_tr_b16 v[198:199], v13 offset:49664
    ds_read_b128 v[128:131], v8 offset:32768
    ds_read_b128 v[132:135], v9 offset:32768
    s_waitcnt lgkmcnt(8)
    v_mfma_f32_32x32x16_bf16 v[144:159], v[124:127], v[216:219], v[144:159]
    ds_read_b128 v[136:139], v10 offset:32768
    ds_read_b128 v[140:143], v11 offset:32768
    ds_read_b128 v[240:243], v7 offset:0
    s_waitcnt lgkmcnt(9)
    v_mfma_f32_32x32x16_bf16 v[160:175], v[124:127], v[220:223], v[160:175]
    ds_read_b128 v[244:247], v7 offset:1024
    ds_read_b64_tr_b16 v[200:201], v12 offset:51200
    ds_read_b64_tr_b16 v[202:203], v12 offset:51712
    s_waitcnt lgkmcnt(4)
    v_dot2c_f32_bf16 v176, v16, v128
    v_dot2c_f32_bf16 v176, v17, v129
    v_dot2c_f32_bf16 v180, v128, v128
    v_dot2c_f32_bf16 v180, v129, v129
    v_dot2c_f32_bf16 v184, v16, v130
    v_dot2c_f32_bf16 v184, v17, v131
    v_dot2c_f32_bf16 v188, v130, v130
    v_dot2c_f32_bf16 v188, v131, v131
    v_dot2c_f32_bf16 v176, v16, v132
    v_dot2c_f32_bf16 v176, v17, v133
    v_dot2c_f32_bf16 v180, v132, v132
    v_dot2c_f32_bf16 v180, v133, v133
    v_dot2c_f32_bf16 v184, v16, v134
    v_dot2c_f32_bf16 v184, v17, v135
    v_dot2c_f32_bf16 v188, v134, v134
    v_dot2c_f32_bf16 v188, v135, v135
    v_dot2c_f32_bf16 v176, v16, v136
    v_dot2c_f32_bf16 v176, v17, v137
    v_dot2c_f32_bf16 v180, v136, v136
    v_dot2c_f32_bf16 v180, v137, v137
    v_dot2c_f32_bf16 v184, v16, v138
    v_dot2c_f32_bf16 v184, v17, v139
    v_dot2c_f32_bf16 v188, v138, v138
    v_dot2c_f32_bf16 v188, v139, v139
    v_dot2c_f32_bf16 v176, v16, v140
    v_dot2c_f32_bf16 v176, v17, v141
    v_dot2c_f32_bf16 v180, v140, v140
    v_dot2c_f32_bf16 v180, v141, v141
    v_dot2c_f32_bf16 v184, v16, v142
    v_dot2c_f32_bf16 v184, v17, v143
    v_dot2c_f32_bf16 v188, v142, v142
    v_dot2c_f32_bf16 v188, v143, v143
    s_waitcnt lgkmcnt(2)
    v_mfma_f32_32x32x16_bf16 v[144:159], v[128:131], v[192:195], v[144:159]
    ds_read_b64_tr_b16 v[204:205], v13 offset:51200
    ds_read_b64_tr_b16 v[206:207], v13 offset:51712
    ds_read_b64_tr_b16 v[208:209], v12 offset:53248
    v_mfma_f32_32x32x16_bf16 v[160:175], v[128:131], v[196:199], v[160:175]
    ds_read_b64_tr_b16 v[210:211], v12 offset:53760
    ds_read_b64_tr_b16 v[212:213], v13 offset:53248
    ds_read_b64_tr_b16 v[214:215], v13 offset:53760
    s_waitcnt lgkmcnt(6)
    v_mfma_f32_32x32x16_bf16 v[144:159], v[132:135], v[200:203], v[144:159]
    ds_read_b64_tr_b16 v[216:217], v12 offset:55296
    ds_read_b64_tr_b16 v[218:219], v12 offset:55808
    ds_read_b64_tr_b16 v[220:221], v13 offset:55296
    s_waitcnt lgkmcnt(7)
    v_mfma_f32_32x32x16_bf16 v[160:175], v[132:135], v[204:207], v[160:175]
    ds_read_b64_tr_b16 v[222:223], v13 offset:55808
    v_add_f32 v240, v240, v241
    v_add_f32 v242, v242, v243
    s_waitcnt lgkmcnt(6)
    v_mfma_f32_32x32x16_bf16 v[144:159], v[136:139], v[208:211], v[144:159]
    v_add_f32 v244, v244, v245
    v_add_f32 v246, v246, v247
    v_add_f32 v232, v240, v242
    v_add_f32 v236, v244, v246
    v_add_f32 v176, v176, v184
    s_waitcnt lgkmcnt(4)
    v_mfma_f32_32x32x16_bf16 v[160:175], v[136:139], v[212:215], v[160:175]
    v_add_f32 v180, v180, v188
    v_cvt_pk_bf16_f32 v235, v232, v232
    v_and_b32 v26, 0xffff0000, v235
    v_sub_f32 v26, v232, v26
    v_cvt_pk_bf16_f32 v234, v232, v26
    s_waitcnt lgkmcnt(2)
    v_mfma_f32_32x32x16_bf16 v[144:159], v[140:143], v[216:219], v[144:159]
    v_permlane32_swap_b32 v176, v180
    v_add_f32 v176, v176, v180
    v_mov_b32_e64 v180, v176
    v_cvt_pk_bf16_f32 v239, v236, v236
    v_and_b32 v26, 0xffff0000, v239
    s_waitcnt lgkmcnt(0)
    v_mfma_f32_32x32x16_bf16 v[160:175], v[140:143], v[220:223], v[160:175]
    v_sub_f32 v26, v236, v26
    v_cvt_pk_bf16_f32 v238, v236, v26
    v_permlane32_swap_b32 v176, v180
    v_mul_f32 v20, 991054117, v176
    v_mul_f32 v180, 991054117, v180
    v_cvt_pk_bf16_f32 v22, -v20, -v20
    v_fma_f32 v180, -v20, v20, v180
    v_and_b32 v26, 0xffff0000, v22
    v_max_f32 v180, 0, v180
    v_add_f32_e64 v26, v20, v26
    v_add_f32 v180, 925353388, v180
    v_cvt_pk_bf16_f32 v23, -v26, 0
    v_rsq_f32 v21, v180
    s_nop 0
    v_mfma_f32_32x32x8_bf16 v[144:159], v[22:23], v[234:235], v[144:159]
    v_cvt_pk_bf16_f32 v25, v21, v21
    v_and_b32 v26, 0xffff0000, v25
    v_sub_f32 v26, v21, v26
    v_cvt_pk_bf16_f32 v24, v21, v26
    s_nop 1
    v_mfma_f32_32x32x8_bf16 v[240:255], v[24:25], v[18:19], 0
    v_mfma_f32_32x32x8_bf16 v[160:175], v[22:23], v[238:239], v[160:175]
    s_mul_i32 s53, s68, 28672
    s_lshl_b32 s54, s48, 10
    s_add_u32 s53, s53, s54
    s_add_u32 s53, s53, 2089984
    s_add_u32 s54, s53, 14336
    s_nop 5
    v_pk_mul_f32 v[144:145], v[144:145], v[240:241]
    v_pk_mul_f32 v[146:147], v[146:147], v[242:243]
    v_pk_mul_f32 v[148:149], v[148:149], v[244:245]
    v_pk_mul_f32 v[150:151], v[150:151], v[246:247]
    v_cvt_pk_bf16_f32 v192, v144, v145
    v_cvt_pk_bf16_f32 v193, v146, v147
    v_cvt_pk_bf16_f32 v194, v148, v149
    v_cvt_pk_bf16_f32 v195, v150, v151
    buffer_store_dwordx4 v[192:195], v30, s[40:43], s53 offen offset:0 sc1
    v_pk_mul_f32 v[152:153], v[152:153], v[248:249]
    v_pk_mul_f32 v[154:155], v[154:155], v[250:251]
    v_pk_mul_f32 v[156:157], v[156:157], v[252:253]
    v_pk_mul_f32 v[158:159], v[158:159], v[254:255]
    v_cvt_pk_bf16_f32 v196, v152, v153
    v_cvt_pk_bf16_f32 v197, v154, v155
    v_cvt_pk_bf16_f32 v198, v156, v157
    v_cvt_pk_bf16_f32 v199, v158, v159
    buffer_store_dwordx4 v[196:199], v30, s[40:43], s54 offen offset:0 sc1
    v_pk_mul_f32 v[160:161], v[160:161], v[240:241]
    v_pk_mul_f32 v[162:163], v[162:163], v[242:243]
    v_pk_mul_f32 v[164:165], v[164:165], v[244:245]
    v_pk_mul_f32 v[166:167], v[166:167], v[246:247]
    v_cvt_pk_bf16_f32 v200, v160, v161
    v_cvt_pk_bf16_f32 v201, v162, v163
    v_cvt_pk_bf16_f32 v202, v164, v165
    v_cvt_pk_bf16_f32 v203, v166, v167
    buffer_store_dwordx4 v[200:203], v30, s[40:43], s53 offen offset:512 sc1
    v_pk_mul_f32 v[168:169], v[168:169], v[248:249]
    v_pk_mul_f32 v[170:171], v[170:171], v[250:251]
    v_pk_mul_f32 v[172:173], v[172:173], v[252:253]
    v_pk_mul_f32 v[174:175], v[174:175], v[254:255]
    v_cvt_pk_bf16_f32 v204, v168, v169
    v_cvt_pk_bf16_f32 v205, v170, v171
    v_cvt_pk_bf16_f32 v206, v172, v173
    v_cvt_pk_bf16_f32 v207, v174, v175
    buffer_store_dwordx4 v[204:207], v30, s[40:43], s54 offen offset:512 sc1
    s_branch L_kvjoin_39
    .p2align 12
L_formN_38:
    s_barrier
    ds_read_b128 v[32:35], v8 offset:0
    ds_read_b128 v[36:39], v9 offset:0
    ds_read_b128 v[40:43], v10 offset:0
    ds_read_b128 v[44:47], v11 offset:0
    s_waitcnt lgkmcnt(2)
    v_mov_b32 v176, 0
    v_dot2c_f32_bf16 v176, v16, v32
    v_dot2c_f32_bf16 v176, v17, v33
    v_mov_b32 v180, 0
    v_dot2c_f32_bf16 v180, v32, v32
    v_dot2c_f32_bf16 v180, v33, v33
    v_mov_b32 v184, 0
    v_dot2c_f32_bf16 v184, v16, v34
    v_dot2c_f32_bf16 v184, v17, v35
    v_mov_b32 v188, 0
    v_dot2c_f32_bf16 v188, v34, v34
    v_dot2c_f32_bf16 v188, v35, v35
    v_dot2c_f32_bf16 v176, v16, v36
    v_dot2c_f32_bf16 v176, v17, v37
    v_dot2c_f32_bf16 v180, v36, v36
    v_dot2c_f32_bf16 v180, v37, v37
    v_dot2c_f32_bf16 v184, v16, v38
    v_dot2c_f32_bf16 v184, v17, v39
    v_dot2c_f32_bf16 v188, v38, v38
    v_dot2c_f32_bf16 v188, v39, v39
    s_waitcnt lgkmcnt(0)
    v_dot2c_f32_bf16 v176, v16, v40
    v_dot2c_f32_bf16 v176, v17, v41
    v_dot2c_f32_bf16 v180, v40, v40
    v_dot2c_f32_bf16 v180, v41, v41
    v_dot2c_f32_bf16 v184, v16, v42
    v_dot2c_f32_bf16 v184, v17, v43
    v_dot2c_f32_bf16 v188, v42, v42
    v_dot2c_f32_bf16 v188, v43, v43
    v_dot2c_f32_bf16 v176, v16, v44
    v_dot2c_f32_bf16 v176, v17, v45
    v_dot2c_f32_bf16 v180, v44, v44
    v_dot2c_f32_bf16 v180, v45, v45
    v_dot2c_f32_bf16 v184, v16, v46
    v_dot2c_f32_bf16 v184, v17, v47
    v_dot2c_f32_bf16 v188, v46, v46
    v_dot2c_f32_bf16 v188, v47, v47
    s_barrier
    ds_read_b128 v[48:51], v8 offset:16384
    ds_read_b128 v[52:55], v9 offset:16384
    s_waitcnt lgkmcnt(0)
    v_dot2c_f32_bf16 v176, v16, v48
    v_dot2c_f32_bf16 v176, v17, v49
    v_dot2c_f32_bf16 v180, v48, v48
    v_dot2c_f32_bf16 v180, v49, v49
    v_dot2c_f32_bf16 v184, v16, v50
    v_dot2c_f32_bf16 v184, v17, v51
    v_dot2c_f32_bf16 v188, v50, v50
    v_dot2c_f32_bf16 v188, v51, v51
    v_dot2c_f32_bf16 v176, v16, v52
    v_dot2c_f32_bf16 v176, v17, v53
    v_dot2c_f32_bf16 v180, v52, v52
    v_dot2c_f32_bf16 v180, v53, v53
    v_dot2c_f32_bf16 v184, v16, v54
    v_dot2c_f32_bf16 v184, v17, v55
    v_dot2c_f32_bf16 v188, v54, v54
    v_dot2c_f32_bf16 v188, v55, v55
    ds_read_b128 v[56:59], v10 offset:16384
    ds_read_b128 v[60:63], v11 offset:16384
    s_waitcnt lgkmcnt(0)
    s_barrier
    v_dot2c_f32_bf16 v176, v16, v56
    v_dot2c_f32_bf16 v176, v17, v57
    v_dot2c_f32_bf16 v180, v56, v56
    v_dot2c_f32_bf16 v180, v57, v57
    v_dot2c_f32_bf16 v184, v16, v58
    v_dot2c_f32_bf16 v184, v17, v59
    v_dot2c_f32_bf16 v188, v58, v58
    v_dot2c_f32_bf16 v188, v59, v59
    v_dot2c_f32_bf16 v176, v16, v60
    v_dot2c_f32_bf16 v176, v17, v61
    v_dot2c_f32_bf16 v180, v60, v60
    v_dot2c_f32_bf16 v180, v61, v61
    v_dot2c_f32_bf16 v184, v16, v62
    v_dot2c_f32_bf16 v184, v17, v63
    v_dot2c_f32_bf16 v188, v62, v62
    v_dot2c_f32_bf16 v188, v63, v63
    ds_read_b128 v[64:67], v8 offset:32768
    ds_read_b128 v[68:71], v9 offset:32768
    s_waitcnt lgkmcnt(0)
    v_dot2c_f32_bf16 v176, v16, v64
    v_dot2c_f32_bf16 v176, v17, v65
    v_dot2c_f32_bf16 v180, v64, v64
    v_dot2c_f32_bf16 v180, v65, v65
    v_dot2c_f32_bf16 v184, v16, v66
    v_dot2c_f32_bf16 v184, v17, v67
    v_dot2c_f32_bf16 v188, v66, v66
    v_dot2c_f32_bf16 v188, v67, v67
    v_dot2c_f32_bf16 v176, v16, v68
    v_dot2c_f32_bf16 v176, v17, v69
    v_dot2c_f32_bf16 v180, v68, v68
    v_dot2c_f32_bf16 v180, v69, v69
    v_dot2c_f32_bf16 v184, v16, v70
    v_dot2c_f32_bf16 v184, v17, v71
    v_dot2c_f32_bf16 v188, v70, v70
    v_dot2c_f32_bf16 v188, v71, v71
    ds_read_b128 v[72:75], v10 offset:32768
    ds_read_b128 v[76:79], v11 offset:32768
    s_waitcnt lgkmcnt(0)
    s_barrier
    v_dot2c_f32_bf16 v176, v16, v72
    v_dot2c_f32_bf16 v176, v17, v73
    v_dot2c_f32_bf16 v180, v72, v72
    v_dot2c_f32_bf16 v180, v73, v73
    v_dot2c_f32_bf16 v184, v16, v74
    v_dot2c_f32_bf16 v184, v17, v75
    v_dot2c_f32_bf16 v188, v74, v74
    v_dot2c_f32_bf16 v188, v75, v75
    v_dot2c_f32_bf16 v176, v16, v76
    v_dot2c_f32_bf16 v176, v17, v77
    v_dot2c_f32_bf16 v180, v76, v76
    v_dot2c_f32_bf16 v180, v77, v77
    v_dot2c_f32_bf16 v184, v16, v78
    v_dot2c_f32_bf16 v184, v17, v79
    v_dot2c_f32_bf16 v188, v78, v78
    v_dot2c_f32_bf16 v188, v79, v79
    ds_read_b128 v[80:83], v8 offset:49152
    ds_read_b128 v[84:87], v9 offset:49152
    s_waitcnt lgkmcnt(0)
    v_dot2c_f32_bf16 v176, v16, v80
    v_dot2c_f32_bf16 v176, v17, v81
    v_dot2c_f32_bf16 v180, v80, v80
    v_dot2c_f32_bf16 v180, v81, v81
    v_dot2c_f32_bf16 v184, v16, v82
    v_dot2c_f32_bf16 v184, v17, v83
    v_dot2c_f32_bf16 v188, v82, v82
    v_dot2c_f32_bf16 v188, v83, v83
    v_dot2c_f32_bf16 v176, v16, v84
    v_dot2c_f32_bf16 v176, v17, v85
    v_dot2c_f32_bf16 v180, v84, v84
    v_dot2c_f32_bf16 v180, v85, v85
    v_dot2c_f32_bf16 v184, v16, v86
    v_dot2c_f32_bf16 v184, v17, v87
    v_dot2c_f32_bf16 v188, v86, v86
    v_dot2c_f32_bf16 v188, v87, v87
    ds_read_b128 v[88:91], v10 offset:49152
    ds_read_b128 v[92:95], v11 offset:49152
    s_waitcnt lgkmcnt(0)
    s_barrier
    v_dot2c_f32_bf16 v176, v16, v88
    v_dot2c_f32_bf16 v176, v17, v89
    v_dot2c_f32_bf16 v180, v88, v88
    v_dot2c_f32_bf16 v180, v89, v89
    v_dot2c_f32_bf16 v184, v16, v90
    v_dot2c_f32_bf16 v184, v17, v91
    v_dot2c_f32_bf16 v188, v90, v90
    v_dot2c_f32_bf16 v188, v91, v91
    v_dot2c_f32_bf16 v176, v16, v92
    v_dot2c_f32_bf16 v176, v17, v93
    v_dot2c_f32_bf16 v180, v92, v92
    v_dot2c_f32_bf16 v180, v93, v93
    v_dot2c_f32_bf16 v184, v16, v94
    v_dot2c_f32_bf16 v184, v17, v95
    v_dot2c_f32_bf16 v188, v94, v94
    v_dot2c_f32_bf16 v188, v95, v95
    ds_read_b128 v[96:99], v8 offset:0
    ds_read_b128 v[100:103], v9 offset:0
    s_waitcnt lgkmcnt(0)
    v_dot2c_f32_bf16 v176, v16, v96
    v_dot2c_f32_bf16 v176, v17, v97
    v_dot2c_f32_bf16 v180, v96, v96
    v_dot2c_f32_bf16 v180, v97, v97
    v_dot2c_f32_bf16 v184, v16, v98
    v_dot2c_f32_bf16 v184, v17, v99
    v_dot2c_f32_bf16 v188, v98, v98
    v_dot2c_f32_bf16 v188, v99, v99
    v_dot2c_f32_bf16 v176, v16, v100
    v_dot2c_f32_bf16 v176, v17, v101
    v_dot2c_f32_bf16 v180, v100, v100
    v_dot2c_f32_bf16 v180, v101, v101
    v_dot2c_f32_bf16 v184, v16, v102
    v_dot2c_f32_bf16 v184, v17, v103
    v_dot2c_f32_bf16 v188, v102, v102
    v_dot2c_f32_bf16 v188, v103, v103
    ds_read_b128 v[104:107], v10 offset:0
    ds_read_b128 v[108:111], v11 offset:0
    s_waitcnt lgkmcnt(0)
    s_barrier
    v_dot2c_f32_bf16 v176, v16, v104
    v_dot2c_f32_bf16 v176, v17, v105
    v_dot2c_f32_bf16 v180, v104, v104
    v_dot2c_f32_bf16 v180, v105, v105
    v_dot2c_f32_bf16 v184, v16, v106
    v_dot2c_f32_bf16 v184, v17, v107
    v_dot2c_f32_bf16 v188, v106, v106
    v_dot2c_f32_bf16 v188, v107, v107
    v_dot2c_f32_bf16 v176, v16, v108
    v_dot2c_f32_bf16 v176, v17, v109
    v_dot2c_f32_bf16 v180, v108, v108
    v_dot2c_f32_bf16 v180, v109, v109
    v_dot2c_f32_bf16 v184, v16, v110
    v_dot2c_f32_bf16 v184, v17, v111
    v_dot2c_f32_bf16 v188, v110, v110
    v_dot2c_f32_bf16 v188, v111, v111
    ds_read_b128 v[112:115], v8 offset:16384
    ds_read_b128 v[116:119], v9 offset:16384
    s_waitcnt lgkmcnt(0)
    v_dot2c_f32_bf16 v176, v16, v112
    v_dot2c_f32_bf16 v176, v17, v113
    v_dot2c_f32_bf16 v180, v112, v112
    v_dot2c_f32_bf16 v180, v113, v113
    v_dot2c_f32_bf16 v184, v16, v114
    v_dot2c_f32_bf16 v184, v17, v115
    v_dot2c_f32_bf16 v188, v114, v114
    v_dot2c_f32_bf16 v188, v115, v115
    v_dot2c_f32_bf16 v176, v16, v116
    v_dot2c_f32_bf16 v176, v17, v117
    v_dot2c_f32_bf16 v180, v116, v116
    v_dot2c_f32_bf16 v180, v117, v117
    v_dot2c_f32_bf16 v184, v16, v118
    v_dot2c_f32_bf16 v184, v17, v119
    v_dot2c_f32_bf16 v188, v118, v118
    v_dot2c_f32_bf16 v188, v119, v119
    s_mov_b64 exec, 3
    buffer_load_dword v15, v4, s[36:39], 0 offen sc1
    s_mov_b64 exec, -1
    ds_read_b128 v[120:123], v10 offset:16384
    ds_read_b128 v[124:127], v11 offset:16384
    s_waitcnt lgkmcnt(0)
    s_barrier
    v_dot2c_f32_bf16 v176, v16, v120
    v_dot2c_f32_bf16 v176, v17, v121
    v_dot2c_f32_bf16 v180, v120, v120
    v_dot2c_f32_bf16 v180, v121, v121
    v_dot2c_f32_bf16 v184, v16, v122
    v_dot2c_f32_bf16 v184, v17, v123
    v_dot2c_f32_bf16 v188, v122, v122
    v_dot2c_f32_bf16 v188, v123, v123
    v_dot2c_f32_bf16 v176, v16, v124
    v_dot2c_f32_bf16 v176, v17, v125
    v_dot2c_f32_bf16 v180, v124, v124
    v_dot2c_f32_bf16 v180, v125, v125
    v_dot2c_f32_bf16 v184, v16, v126
    v_dot2c_f32_bf16 v184, v17, v127
    v_dot2c_f32_bf16 v188, v126, v126
    v_dot2c_f32_bf16 v188, v127, v127
    ds_read_b128 v[128:131], v8 offset:32768
    ds_read_b128 v[132:135], v9 offset:32768
    ds_read_b128 v[136:139], v10 offset:32768
    ds_read_b128 v[140:143], v11 offset:32768
    s_waitcnt lgkmcnt(0)
    v_dot2c_f32_bf16 v176, v16, v128
    v_dot2c_f32_bf16 v176, v17, v129
    v_dot2c_f32_bf16 v180, v128, v128
    v_dot2c_f32_bf16 v180, v129, v129
    v_dot2c_f32_bf16 v184, v16, v130
    v_dot2c_f32_bf16 v184, v17, v131
    v_dot2c_f32_bf16 v188, v130, v130
    v_dot2c_f32_bf16 v188, v131, v131
    v_dot2c_f32_bf16 v176, v16, v132
    v_dot2c_f32_bf16 v176, v17, v133
    v_dot2c_f32_bf16 v180, v132, v132
    v_dot2c_f32_bf16 v180, v133, v133
    v_dot2c_f32_bf16 v184, v16, v134
    v_dot2c_f32_bf16 v184, v17, v135
    v_dot2c_f32_bf16 v188, v134, v134
    v_dot2c_f32_bf16 v188, v135, v135
    v_dot2c_f32_bf16 v176, v16, v136
    v_dot2c_f32_bf16 v176, v17, v137
    v_dot2c_f32_bf16 v180, v136, v136
    v_dot2c_f32_bf16 v180, v137, v137
    v_dot2c_f32_bf16 v184, v16, v138
    v_dot2c_f32_bf16 v184, v17, v139
    v_dot2c_f32_bf16 v188, v138, v138
    v_dot2c_f32_bf16 v188, v139, v139
    v_dot2c_f32_bf16 v176, v16, v140
    v_dot2c_f32_bf16 v176, v17, v141
    v_dot2c_f32_bf16 v180, v140, v140
    v_dot2c_f32_bf16 v180, v141, v141
    v_dot2c_f32_bf16 v184, v16, v142
    v_dot2c_f32_bf16 v184, v17, v143
    v_dot2c_f32_bf16 v188, v142, v142
    v_dot2c_f32_bf16 v188, v143, v143
    s_nop 0
    v_add_f32 v176, v176, v184
    s_nop 0
    v_add_f32 v180, v180, v188
    s_nop 1
    v_permlane32_swap_b32 v176, v180
    v_add_f32 v176, v176, v180
    v_mov_b32 v180, v176
    s_nop 1
    v_permlane32_swap_b32 v176, v180
    v_mul_f32 v20, 991054117, v176
    v_mul_f32 v180, 991054117, v180
    v_cvt_pk_bf16_f32 v22, -v20, -v20
    v_fma_f32 v180, -v20, v20, v180
    v_and_b32 v26, 0xffff0000, v22
    v_max_f32 v180, 0, v180
    v_add_f32 v26, v20, v26
    v_add_f32 v180, 925353388, v180
    v_cvt_pk_bf16_f32 v23, -v26, 0
    v_rsq_f32 v21, v180
L_kvjoin_39:
    s_lshl_b32 s57, s68, 4
    s_add_u32 s53, s57, s48
    s_lshl_b32 s53, s53, 7
    s_add_u32 s55, s53, 16777216
    v_mov_b32 v28, 0
    v_mov_b32_e64 v29, 1
    s_barrier
    ds_read_b64_tr_b16 v[240:241], v14 offset:0
    ds_read_b64_tr_b16 v[242:243], v14 offset:256
    ds_read_b64_tr_b16 v[244:245], v14 offset:1024
    ds_read_b64_tr_b16 v[246:247], v14 offset:1280
    ds_read_b64_tr_b16 v[248:249], v14 offset:2048
    ds_read_b64_tr_b16 v[250:251], v14 offset:2304
    ds_read_b64_tr_b16 v[252:253], v14 offset:3072
    ds_read_b64_tr_b16 v[254:255], v14 offset:3328
    ds_read_b64_tr_b16 v[208:209], v14 offset:4096
    ds_read_b64_tr_b16 v[210:211], v14 offset:4352
    s_mul_i32 s53, s48, 28
    s_add_u32 s54, s53, 27
    s_lshr_b32 s53, s53, 6
    s_lshr_b32 s54, s54, 6
    s_sub_u32 s54, s54, s53
    v_and_b32 v31, s54, v1
    v_bfe_u32 v27, v1, 1, 1
    v_mad_u32_u24 v31, v27, 7, v31
    v_lshrrev_b32 v27, 2, v1
    v_lshl_add_u32 v31, v27, 6, v31
    v_lshlrev_b32 v31, 7, v31
    s_add_u32 s53, s53, s57
    s_lshl_b32 s53, s53, 7
    s_add_u32 s59, s53, 16760832
    s_min_u32 s54, s49, 2
    s_lshl_b32 s54, s54, 2
    s_lshr_b32 s54, 0xfff00, s54
    s_and_b32 s78, s54, 0xfff
    s_mul_i32 s79, s68, 28672
    s_mul_i32 s54, s48, 1792
    s_add_u32 s79, s79, s54
    s_waitcnt lgkmcnt(6)
    v_mfma_f32_4x4x4_16b_bf16 v[232:235], v[16:17], v[240:241], 0
    v_mfma_f32_4x4x4_16b_bf16 v[236:239], v[16:17], v[242:243], 0
    v_add_u32_e64 v8, s58, v2
    v_mfma_f32_4x4x4_16b_bf16 v[232:235], v[16:17], v[244:245], v[232:235]
    v_mfma_f32_4x4x4_16b_bf16 v[236:239], v[16:17], v[246:247], v[236:239]
    v_mfma_f32_32x32x16_bf16 v[176:191], v[240:243], v[32:35], 0
    ds_read_b64_tr_b16 v[212:213], v14 offset:5120
    ds_read_b64_tr_b16 v[214:215], v14 offset:5376
    v_and_b32 v7, 15, v1
    v_lshlrev_b32 v7, 4, v7
    v_mfma_f32_32x32x16_bf16 v[176:191], v[244:247], v[36:39], v[176:191]
    ds_read_b64_tr_b16 v[216:217], v14 offset:6144
    ds_read_b64_tr_b16 v[218:219], v14 offset:6400
    v_bfe_u32 v9, v1, 4, 1
    v_lshl_add_u32 v7, v9, 3, v7
    v_lshrrev_b32 v9, 5, v1
    s_waitcnt lgkmcnt(6)
    v_mfma_f32_4x4x4_16b_bf16 v[232:235], v[16:17], v[248:249], v[232:235]
    v_mfma_f32_4x4x4_16b_bf16 v[236:239], v[16:17], v[250:251], v[236:239]
    v_lshl_add_u32 v7, v9, 8, v7
    v_mfma_f32_4x4x4_16b_bf16 v[232:235], v[16:17], v[252:253], v[232:235]
    v_mfma_f32_4x4x4_16b_bf16 v[236:239], v[16:17], v[254:255], v[236:239]
    v_mfma_f32_32x32x16_bf16 v[176:191], v[248:251], v[40:43], v[176:191]
    ds_read_b64_tr_b16 v[240:241], v14 offset:7168
    ds_read_b64_tr_b16 v[242:243], v14 offset:7424
    v_add_u32 v7, s58, v7
    v_lshrrev_b32 v11, 5, v1
    v_mfma_f32_32x32x16_bf16 v[176:191], v[252:255], v[44:47], v[176:191]
    ds_read_b64_tr_b16 v[244:245], v14 offset:8192
    ds_read_b64_tr_b16 v[246:247], v14 offset:8448
    v_lshlrev_b32 v11, 4, v11
    v_add_u32 v11, 94208, v11
    v_mov_b32_e64 v224, v16
    s_waitcnt lgkmcnt(6)
    v_mfma_f32_4x4x4_16b_bf16 v[232:235], v[16:17], v[208:209], v[232:235]
    v_mfma_f32_4x4x4_16b_bf16 v[236:239], v[16:17], v[210:211], v[236:239]
    v_mov_b32_e64 v228, 0
    v_mfma_f32_4x4x4_16b_bf16 v[232:235], v[16:17], v[212:213], v[232:235]
    v_mfma_f32_4x4x4_16b_bf16 v[236:239], v[16:17], v[214:215], v[236:239]
    v_mfma_f32_32x32x16_bf16 v[176:191], v[208:211], v[48:51], v[176:191]
    ds_read_b64_tr_b16 v[248:249], v14 offset:9216
    ds_read_b64_tr_b16 v[250:251], v14 offset:9472
    v_mov_b32 v225, v16
    v_mov_b32 v229, 0
    v_mfma_f32_32x32x16_bf16 v[176:191], v[212:215], v[52:55], v[176:191]
    ds_read_b64_tr_b16 v[252:253], v14 offset:10240
    ds_read_b64_tr_b16 v[254:255], v14 offset:10496
    v_mov_b32 v226, v16
    v_mov_b32 v230, 0
    v_mov_b32 v227, v16
    s_waitcnt lgkmcnt(6)
    v_mfma_f32_4x4x4_16b_bf16 v[232:235], v[16:17], v[216:217], v[232:235]
    v_mfma_f32_4x4x4_16b_bf16 v[236:239], v[16:17], v[218:219], v[236:239]
    v_mov_b32_e64 v231, 0
    v_mfma_f32_4x4x4_16b_bf16 v[232:235], v[16:17], v[240:241], v[232:235]
    v_mfma_f32_4x4x4_16b_bf16 v[236:239], v[16:17], v[242:243], v[236:239]
    v_mfma_f32_32x32x16_bf16 v[176:191], v[216:219], v[56:59], v[176:191]
    ds_read_b64_tr_b16 v[208:209], v14 offset:11264
    ds_read_b64_tr_b16 v[210:211], v14 offset:11520
    v_and_b32 v26, 31, v1
    v_lshrrev_b32 v27, 5, v1
    v_mfma_f32_32x32x16_bf16 v[176:191], v[240:243], v[60:63], v[176:191]
    ds_read_b64_tr_b16 v[212:213], v14 offset:12288
    ds_read_b64_tr_b16 v[214:215], v14 offset:12544
    v_lshlrev_b32 v27, 2, v27
    v_sub_u32 v26, v26, v27
    v_mov_b32 v27, 4048155338
    s_waitcnt vmcnt(0)
    s_mov_b64 exec, 3
    v_cmp_ne_u32 vcc, 1, v15
    s_cbranch_vccnz L_late_41
L_ok_42:
    s_mov_b64 exec, 1
    buffer_store_dword v29, v28, s[40:43], s55 offen sc1
    s_cmp_lg_u32 s46, 0
    s_cbranch_scc1 L_nof0_40
    v_mov_b32 v15, s50
    s_lshl_b32 s53, s45, 2
    s_add_u32 s53, s53, s77
    buffer_store_dword v15, v28, s[40:43], s53 offen offset:3584 sc1
L_nof0_40:
    s_mov_b64 exec, -1
    s_waitcnt lgkmcnt(6)
    v_mfma_f32_4x4x4_16b_bf16 v[232:235], v[16:17], v[244:245], v[232:235]
    v_mfma_f32_4x4x4_16b_bf16 v[236:239], v[16:17], v[246:247], v[236:239]
    v_cmp_le_i32 s[62:63], 0, v26
    v_mfma_f32_4x4x4_16b_bf16 v[232:235], v[16:17], v[248:249], v[232:235]
    v_mfma_f32_4x4x4_16b_bf16 v[236:239], v[16:17], v[250:251], v[236:239]
    v_mfma_f32_32x32x16_bf16 v[176:191], v[244:247], v[64:67], v[176:191]
    ds_read_b64_tr_b16 v[216:217], v14 offset:13312
    ds_read_b64_tr_b16 v[218:219], v14 offset:13568
    v_cmp_le_i32 s[64:65], 1, v26
    v_cndmask_b32 v160, v27, 0, s[62:63]
    v_mfma_f32_32x32x16_bf16 v[176:191], v[248:251], v[68:71], v[176:191]
    ds_read_b64_tr_b16 v[240:241], v14 offset:14336
    ds_read_b64_tr_b16 v[242:243], v14 offset:14592
    v_cndmask_b32 v144, 0, v27, s[62:63]
    v_cmp_le_i32 s[66:67], 2, v26
    v_cndmask_b32 v161, v27, 0, s[64:65]
    s_waitcnt lgkmcnt(6)
    v_mfma_f32_4x4x4_16b_bf16 v[232:235], v[16:17], v[252:253], v[232:235]
    v_mfma_f32_4x4x4_16b_bf16 v[236:239], v[16:17], v[254:255], v[236:239]
    v_cndmask_b32 v145, 0, v27, s[64:65]
    v_mfma_f32_4x4x4_16b_bf16 v[232:235], v[16:17], v[208:209], v[232:235]
    v_mfma_f32_4x4x4_16b_bf16 v[236:239], v[16:17], v[210:211], v[236:239]
    v_mfma_f32_32x32x16_bf16 v[176:191], v[252:255], v[72:75], v[176:191]
    ds_read_b64_tr_b16 v[244:245], v14 offset:15360
    ds_read_b64_tr_b16 v[246:247], v14 offset:15616
    v_cmp_le_i32 s[62:63], 3, v26
    v_cndmask_b32 v162, v27, 0, s[66:67]
    v_mfma_f32_32x32x16_bf16 v[176:191], v[208:211], v[76:79], v[176:191]
    ds_read_b64_tr_b16 v[248:249], v14 offset:16384
    ds_read_b64_tr_b16 v[250:251], v14 offset:16640
    v_cndmask_b32 v146, 0, v27, s[66:67]
    v_cmp_le_i32 s[64:65], 8, v26
    v_cndmask_b32 v163, v27, 0, s[62:63]
    s_waitcnt lgkmcnt(6)
    v_mfma_f32_4x4x4_16b_bf16 v[232:235], v[16:17], v[212:213], v[232:235]
    v_mfma_f32_4x4x4_16b_bf16 v[236:239], v[16:17], v[214:215], v[236:239]
    v_cndmask_b32 v147, 0, v27, s[62:63]
    v_mfma_f32_4x4x4_16b_bf16 v[232:235], v[16:17], v[216:217], v[232:235]
    v_mfma_f32_4x4x4_16b_bf16 v[236:239], v[16:17], v[218:219], v[236:239]
    v_mfma_f32_32x32x16_bf16 v[176:191], v[212:215], v[80:83], v[176:191]
    ds_read_b64_tr_b16 v[252:253], v14 offset:17408
    ds_read_b64_tr_b16 v[254:255], v14 offset:17664
    v_cmp_le_i32 s[66:67], 9, v26
    v_cndmask_b32 v164, v27, 0, s[64:65]
    v_mfma_f32_32x32x16_bf16 v[176:191], v[216:219], v[84:87], v[176:191]
    ds_read_b64_tr_b16 v[208:209], v14 offset:18432
    ds_read_b64_tr_b16 v[210:211], v14 offset:18688
    v_cndmask_b32 v148, 0, v27, s[64:65]
    v_cmp_le_i32 s[62:63], 10, v26
    v_cndmask_b32 v165, v27, 0, s[66:67]
    s_waitcnt lgkmcnt(6)
    v_mfma_f32_4x4x4_16b_bf16 v[232:235], v[16:17], v[240:241], v[232:235]
    v_mfma_f32_4x4x4_16b_bf16 v[236:239], v[16:17], v[242:243], v[236:239]
    v_cndmask_b32 v149, 0, v27, s[66:67]
    v_mfma_f32_4x4x4_16b_bf16 v[232:235], v[16:17], v[244:245], v[232:235]
    v_mfma_f32_4x4x4_16b_bf16 v[236:239], v[16:17], v[246:247], v[236:239]
    v_mfma_f32_32x32x16_bf16 v[176:191], v[240:243], v[88:91], v[176:191]
    ds_read_b64_tr_b16 v[212:213], v14 offset:19456
    ds_read_b64_tr_b16 v[214:215], v14 offset:19712
    v_cmp_le_i32 s[64:65], 11, v26
    v_cndmask_b32 v166, v27, 0, s[62:63]
    v_mfma_f32_32x32x16_bf16 v[176:191], v[244:247], v[92:95], v[176:191]
    ds_read_b64_tr_b16 v[216:217], v14 offset:20480
    ds_read_b64_tr_b16 v[218:219], v14 offset:20736
    v_cndmask_b32 v150, 0, v27, s[62:63]
    v_cmp_le_i32 s[66:67], 16, v26
    v_cndmask_b32 v167, v27, 0, s[64:65]
    s_waitcnt lgkmcnt(6)
    v_mfma_f32_4x4x4_16b_bf16 v[232:235], v[16:17], v[248:249], v[232:235]
    v_mfma_f32_4x4x4_16b_bf16 v[236:239], v[16:17], v[250:251], v[236:239]
    v_cndmask_b32 v151, 0, v27, s[64:65]
    v_mfma_f32_4x4x4_16b_bf16 v[232:235], v[16:17], v[252:253], v[232:235]
    v_mfma_f32_4x4x4_16b_bf16 v[236:239], v[16:17], v[254:255], v[236:239]
    v_mfma_f32_32x32x16_bf16 v[176:191], v[248:251], v[96:99], v[176:191]
    ds_read_b64_tr_b16 v[240:241], v14 offset:21504
    ds_read_b64_tr_b16 v[242:243], v14 offset:21760
    v_cmp_le_i32 s[62:63], 17, v26
    v_cndmask_b32 v168, v27, 0, s[66:67]
    v_mfma_f32_32x32x16_bf16 v[176:191], v[252:255], v[100:103], v[176:191]
    ds_read_b64_tr_b16 v[244:245], v14 offset:22528
    ds_read_b64_tr_b16 v[246:247], v14 offset:22784
    v_cndmask_b32 v152, 0, v27, s[66:67]
    v_cmp_le_i32 s[64:65], 18, v26
    v_cndmask_b32 v169, v27, 0, s[62:63]
    s_waitcnt lgkmcnt(6)
    v_mfma_f32_4x4x4_16b_bf16 v[232:235], v[16:17], v[208:209], v[232:235]
    v_mfma_f32_4x4x4_16b_bf16 v[236:239], v[16:17], v[210:211], v[236:239]
    v_cndmask_b32 v153, 0, v27, s[62:63]
    v_mfma_f32_4x4x4_16b_bf16 v[232:235], v[16:17], v[212:213], v[232:235]
    v_mfma_f32_4x4x4_16b_bf16 v[236:239], v[16:17], v[214:215], v[236:239]
    v_mfma_f32_32x32x16_bf16 v[176:191], v[208:211], v[104:107], v[176:191]
    ds_read_b64_tr_b16 v[248:249], v14 offset:23552
    ds_read_b64_tr_b16 v[250:251], v14 offset:23808
    v_cmp_le_i32 s[66:67], 19, v26
    v_cndmask_b32 v170, v27, 0, s[64:65]
    v_mfma_f32_32x32x16_bf16 v[176:191], v[212:215], v[108:111], v[176:191]
    ds_read_b64_tr_b16 v[252:253], v14 offset:24576
    ds_read_b64_tr_b16 v[254:255], v14 offset:24832
    v_cndmask_b32 v154, 0, v27, s[64:65]
    v_cmp_le_i32 s[62:63], 24, v26
    v_cndmask_b32 v171, v27, 0, s[66:67]
    s_waitcnt lgkmcnt(6)
    v_mfma_f32_4x4x4_16b_bf16 v[232:235], v[16:17], v[216:217], v[232:235]
    v_mfma_f32_4x4x4_16b_bf16 v[236:239], v[16:17], v[218:219], v[236:239]
    v_cndmask_b32 v155, 0, v27, s[66:67]
    v_mfma_f32_4x4x4_16b_bf16 v[232:235], v[16:17], v[240:241], v[232:235]
    v_mfma_f32_4x4x4_16b_bf16 v[236:239], v[16:17], v[242:243], v[236:239]
    v_mfma_f32_32x32x16_bf16 v[176:191], v[216:219], v[112:115], v[176:191]
    ds_read_b64_tr_b16 v[208:209], v14 offset:25600
    ds_read_b64_tr_b16 v[210:211], v14 offset:25856
    v_cmp_le_i32 s[64:65], 25, v26
    v_cndmask_b32 v172, v27, 0, s[62:63]
    v_mfma_f32_32x32x16_bf16 v[176:191], v[240:243], v[116:119], v[176:191]
    ds_read_b64_tr_b16 v[212:213], v14 offset:26624
    ds_read_b64_tr_b16 v[214:215], v14 offset:26880
    v_cndmask_b32 v156, 0, v27, s[62:63]
    v_cmp_le_i32 s[66:67], 26, v26
    v_cndmask_b32 v173, v27, 0, s[64:65]
    s_waitcnt lgkmcnt(6)
    v_mfma_f32_4x4x4_16b_bf16 v[232:235], v[16:17], v[244:245], v[232:235]
    v_mfma_f32_4x4x4_16b_bf16 v[236:239], v[16:17], v[246:247], v[236:239]
    v_cndmask_b32 v157, 0, v27, s[64:65]
    v_mfma_f32_4x4x4_16b_bf16 v[232:235], v[16:17], v[248:249], v[232:235]
    v_mfma_f32_4x4x4_16b_bf16 v[236:239], v[16:17], v[250:251], v[236:239]
    v_mfma_f32_32x32x16_bf16 v[176:191], v[244:247], v[120:123], v[176:191]
    ds_read_b64_tr_b16 v[216:217], v14 offset:27648
    ds_read_b64_tr_b16 v[218:219], v14 offset:27904
    v_cmp_le_i32 s[62:63], 27, v26
    v_cndmask_b32 v174, v27, 0, s[66:67]
    v_mfma_f32_32x32x16_bf16 v[176:191], v[248:251], v[124:127], v[176:191]
    v_cndmask_b32 v158, 0, v27, s[66:67]
    v_cndmask_b32 v175, v27, 0, s[62:63]
    v_cndmask_b32 v159, 0, v27, s[62:63]
    s_waitcnt lgkmcnt(4)
    v_mfma_f32_4x4x4_16b_bf16 v[232:235], v[16:17], v[252:253], v[232:235]
    v_mfma_f32_4x4x4_16b_bf16 v[236:239], v[16:17], v[254:255], v[236:239]
    s_nop 0
    v_mfma_f32_4x4x4_16b_bf16 v[232:235], v[16:17], v[208:209], v[232:235]
    v_mfma_f32_4x4x4_16b_bf16 v[236:239], v[16:17], v[210:211], v[236:239]
    v_mfma_f32_32x32x16_bf16 v[176:191], v[252:255], v[128:131], v[176:191]
    v_mfma_f32_32x32x16_bf16 v[176:191], v[208:211], v[132:135], v[176:191]
    s_waitcnt lgkmcnt(0)
    v_mfma_f32_4x4x4_16b_bf16 v[232:235], v[16:17], v[212:213], v[232:235]
    v_mfma_f32_4x4x4_16b_bf16 v[236:239], v[16:17], v[214:215], v[236:239]
    s_nop 0
    v_mfma_f32_4x4x4_16b_bf16 v[232:235], v[16:17], v[216:217], v[232:235]
    v_mfma_f32_4x4x4_16b_bf16 v[236:239], v[16:17], v[218:219], v[236:239]
    v_mfma_f32_32x32x16_bf16 v[176:191], v[212:215], v[136:139], v[176:191]
    v_mfma_f32_32x32x16_bf16 v[176:191], v[216:219], v[140:143], v[176:191]
    s_nop 2
    v_add_f32_e64 v232, v232, v236
    v_cvt_pk_bf16_f32 v235, v232, v232
    v_and_b32 v26, 0xffff0000, v235
    v_sub_f32 v26, v232, v26
    v_cvt_pk_bf16_f32 v234, v232, v26
    s_nop 1
    v_mfma_f32_32x32x8_bf16 v[176:191], v[234:235], v[22:23], v[176:191]
    s_mov_b32 exec_lo, 0xf0000000
    s_mov_b32 exec_hi, 0xf0000000
    ds_write_b128 v8, v[224:227] offset:2048
    ds_write_b128 v8, v[224:227] offset:3072
    ds_write_b128 v8, v[224:227] offset:18432
    ds_write_b128 v8, v[224:227] offset:19456
    ds_write_b128 v8, v[224:227] offset:34816
    ds_write_b128 v8, v[224:227] offset:35840
    s_mov_b32 exec_lo, 0
    s_mov_b32 exec_hi, 0xffff0000
    ds_write_b128 v8, v[228:231] offset:33792
    s_cmp_ge_u32 s49, 1
    s_cselect_b32 s53, 0, 61769
    v_mov_b32 v228, s53
    v_mov_b32 v230, s53
    ds_write_b128 v8, v[228:231] offset:17408
    s_cmp_ge_u32 s49, 2
    s_cselect_b32 s53, 0, 61769
    v_mov_b32 v228, s53
    v_mov_b32 v230, s53
    ds_write_b128 v8, v[228:231] offset:1024
    s_mov_b64 exec, -1
    v_mov_b32 v28, 0x3f80
    v_mul_f32 v21, 1049335798, v21
    v_mul_f32 v20, 1031798784, v20
    v_mul_f32 v176, v21, v176
    v_mul_f32 v177, v21, v177
    v_mul_f32 v178, v21, v178
    v_mul_f32 v179, v21, v179
    v_mul_f32 v180, v21, v180
    v_mul_f32 v181, v21, v181
    v_mul_f32 v182, v21, v182
    v_mul_f32 v183, v21, v183
    v_mul_f32 v184, v21, v184
    v_mul_f32 v185, v21, v185
    v_mul_f32 v186, v21, v186
    v_mul_f32 v187, v21, v187
    v_mul_f32 v188, v21, v188
    v_mul_f32 v189, v21, v189
    v_mul_f32 v190, v21, v190
    v_mul_f32_e64 v191, v21, v191
    s_waitcnt lgkmcnt(0)
    v_cvt_pk_bf16_f32 v220, v176, v177
    v_cvt_pk_bf16_f32 v221, v178, v179
    v_cvt_pk_bf16_f32 v222, v180, v181
    v_cvt_pk_bf16_f32 v223, v182, v183
    v_cvt_pk_bf16_f32 v224, v184, v185
    v_cvt_pk_bf16_f32 v225, v186, v187
    v_cvt_pk_bf16_f32 v226, v188, v189
    v_cvt_pk_bf16_f32 v227, v190, v191
    v_cndmask_b32 v226, v226, v28, s[60:61]
    v_cndmask_b32 v227, v227, 0, s[60:61]
L_qdone:
    s_mov_b32 exec_lo, s78
    s_mov_b32 exec_hi, 0
L_poll_45:
    buffer_load_dword v10, v31, s[40:43], s59 offen sc1
    s_add_u32 s52, s52, 1
    s_waitcnt vmcnt(0)
    v_cmp_ne_u32 vcc, 1, v10
    s_cmp_gt_u32 s52, 4194304
    s_cbranch_scc1 L_polled_46
    s_cbranch_vccnz L_poll_45
L_polled_46:
    s_sub_u32 s54, s79, 229376
    s_cmp_ge_u32 s49, 2
    s_cselect_b32 s54, s54, 0x7f000000
    s_add_u32 m0, s58, 0
    s_mov_b64 exec, -1
    buffer_load_dwordx4 v2, s[40:43], s54 offen sc1 lds
    s_mov_b32 exec_hi, 0xffff
    buffer_load_dwordx4 v2, s[40:43], s54 offen offset:1024 sc1 lds
    s_sub_u32 s54, s79, 114688
    s_cmp_ge_u32 s49, 1
    s_cselect_b32 s54, s54, 0x7f000000
    s_add_u32 m0, s58, 16384
    s_mov_b64 exec, -1
    buffer_load_dwordx4 v2, s[40:43], s54 offen sc1 lds
    s_mov_b32 exec_hi, 0xffff
    buffer_load_dwordx4 v2, s[40:43], s54 offen offset:1024 sc1 lds
    s_sub_u32 s54, s79, 0
    s_add_u32 m0, s58, 32768
    s_mov_b64 exec, -1
    buffer_load_dwordx4 v2, s[40:43], s54 offen sc1 lds
    s_mov_b32 exec_hi, 0xffff
    buffer_load_dwordx4 v2, s[40:43], s54 offen offset:1024 sc1 lds
    s_mov_b64 exec, -1
    v_lshlrev_b32 v3, 2, v1
    v_add_u32 v3, 3584, v3
    s_mov_b32 exec_hi, 0
    buffer_load_dword v15, v3, s[40:43], s77 offen sc1
    s_mov_b64 exec, -1
    s_barrier
    ds_read_b128 v[240:243], v11 offset:0
    ds_read_b128 v[244:247], v11 offset:32
    ds_read_b128 v[248:251], v11 offset:64
    ds_read_b128 v[252:255], v11 offset:96
    s_waitcnt vmcnt(5)
    ds_read_b64 v[192:193], v7 offset:0
    ds_read_b64 v[194:195], v7 offset:512
    ds_read_b64 v[196:197], v7 offset:1024
    ds_read_b64 v[198:199], v7 offset:1536
    s_waitcnt lgkmcnt(2)
    v_mfma_f32_32x32x16_bf16 v[32:47], v[192:195], v[220:223], v[144:159]
    s_waitcnt lgkmcnt(0)
    v_mfma_f32_32x32x16_bf16 v[32:47], v[196:199], v[224:227], v[32:47]
    s_waitcnt vmcnt(3)
    ds_read_b64 v[200:201], v7 offset:16384
    ds_read_b64 v[202:203], v7 offset:16896
    ds_read_b64 v[204:205], v7 offset:17408
    ds_read_b64 v[206:207], v7 offset:17920
    s_nop 6
    v_exp_f32 v32, v32
    v_exp_f32 v33, v33
    v_exp_f32 v34, v34
    v_exp_f32 v35, v35
    v_exp_f32 v36, v36
    v_exp_f32 v37, v37
    s_waitcnt lgkmcnt(2)
    v_mfma_f32_32x32x16_bf16 v[96:111], v[200:203], v[220:223], 0
    v_exp_f32 v38, v38
    v_exp_f32 v39, v39
    s_waitcnt lgkmcnt(0)
    v_mfma_f32_32x32x16_bf16 v[96:111], v[204:207], v[224:227], v[96:111]
    v_cvt_pk_bf16_f32 v32, v32, v33
    v_cvt_pk_bf16_f32 v33, v34, v35
    v_cvt_pk_bf16_f32 v34, v36, v37
    v_cvt_pk_bf16_f32 v35, v38, v39
    s_waitcnt vmcnt(1)
    ds_read_b64 v[208:209], v7 offset:32768
    s_branch L_pg3_skip
    .p2align 12
L_pg3:
    s_branch L_visit1_back
    s_nop 0
L_pg3_skip:
    ds_read_b64 v[210:211], v7 offset:33280
    ds_read_b64 v[212:213], v7 offset:33792
    ds_read_b64 v[214:215], v7 offset:34304
    v_exp_f32 v40, v40
    v_exp_f32 v41, v41
    v_exp_f32 v42, v42
    v_exp_f32 v43, v43
    v_exp_f32 v44, v44
    v_exp_f32 v45, v45
    s_waitcnt lgkmcnt(2)
    v_mfma_f32_32x32x16_bf16 v[160:175], v[208:211], v[220:223], v[160:175]
    v_exp_f32 v46, v46
    v_exp_f32 v47, v47
    s_waitcnt lgkmcnt(0)
    v_mfma_f32_32x32x16_bf16 v[160:175], v[212:215], v[224:227], v[160:175]
    v_cvt_pk_bf16_f32 v40, v40, v41
    v_cvt_pk_bf16_f32 v41, v42, v43
    v_cvt_pk_bf16_f32 v42, v44, v45
    v_cvt_pk_bf16_f32 v43, v46, v47
    v_exp_f32 v96, v96
    v_exp_f32 v97, v97
    v_exp_f32 v98, v98
    v_exp_f32 v99, v99
    v_exp_f32 v100, v100
    v_exp_f32 v101, v101
    v_exp_f32 v102, v102
    v_exp_f32 v103, v103
    v_cvt_pk_bf16_f32 v96, v96, v97
    v_cvt_pk_bf16_f32 v97, v98, v99
    v_cvt_pk_bf16_f32 v98, v100, v101
    v_cvt_pk_bf16_f32 v99, v102, v103
    s_barrier
    ds_read_b64 v[216:217], v7 offset:4096
    ds_read_b64 v[218:219], v7 offset:4608
    ds_read_b64 v[192:193], v7 offset:5120
    ds_read_b64 v[194:195], v7 offset:5632
    ds_read_b64 v[196:197], v7 offset:8192
    ds_read_b64 v[198:199], v7 offset:8704
    ds_read_b64 v[200:201], v7 offset:9216
    ds_read_b64 v[202:203], v7 offset:9728
    ds_read2st64_b64 v[204:207], v7 offset0:24 offset1:25
    ds_read2st64_b64 v[208:211], v7 offset0:26 offset1:27
    v_exp_f32 v104, v104
    v_exp_f32 v105, v105
    v_exp_f32 v106, v106
    v_exp_f32 v107, v107
    v_exp_f32 v108, v108
    v_exp_f32 v109, v109
    s_waitcnt lgkmcnt(8)
    v_mfma_f32_32x32x16_bf16 v[48:63], v[216:219], v[220:223], 0
    ds_read2st64_b64 v[212:215], v7 offset0:40 offset1:41
    v_exp_f32 v110, v110
    v_exp_f32_e64 v111, v111
    s_waitcnt lgkmcnt(7)
    v_mfma_f32_32x32x16_bf16 v[48:63], v[192:195], v[224:227], v[48:63]
    ds_read2st64_b64 v[216:219], v7 offset0:42 offset1:43
    v_cvt_pk_bf16_f32 v104, v104, v105
    v_cvt_pk_bf16_f32 v105, v106, v107
    v_cvt_pk_bf16_f32 v106, v108, v109
    v_cvt_pk_bf16_f32 v107, v110, v111
    v_exp_f32 v160, v160
    v_exp_f32_e64 v161, v161
    s_waitcnt lgkmcnt(6)
    v_mfma_f32_32x32x16_bf16 v[64:79], v[196:199], v[220:223], 0
    ds_read2st64_b64 v[192:195], v7 offset0:48 offset1:49
    v_exp_f32 v162, v162
    v_exp_f32 v163, v163
    v_exp_f32 v164, v164
    v_exp_f32_e64 v165, v165
    s_waitcnt lgkmcnt(5)
    v_mfma_f32_32x32x16_bf16 v[64:79], v[200:203], v[224:227], v[64:79]
    ds_read2st64_b64 v[196:199], v7 offset0:50 offset1:51
    v_exp_f32 v166, v166
    v_exp_f32 v167, v167
    v_cvt_pk_bf16_f32 v160, v160, v161
    v_cvt_pk_bf16_f32 v161, v162, v163
    v_cvt_pk_bf16_f32 v162, v164, v165
    v_cvt_pk_bf16_f32 v163, v166, v167
    v_exp_f32 v168, v168
    v_exp_f32_e64 v169, v169
    s_waitcnt lgkmcnt(5)
    v_mfma_f32_32x32x16_bf16 v[80:95], v[204:207], v[220:223], 0
    ds_read2st64_b64 v[200:203], v7 offset0:56 offset1:57
    v_exp_f32 v170, v170
    v_exp_f32 v171, v171
    v_exp_f32 v172, v172
    v_exp_f32_e64 v173, v173
    s_waitcnt lgkmcnt(5)
    v_mfma_f32_32x32x16_bf16 v[80:95], v[208:211], v[224:227], v[80:95]
    ds_read2st64_b64 v[204:207], v7 offset0:58 offset1:59
    v_exp_f32 v174, v174
    v_exp_f32 v175, v175
    v_cvt_pk_bf16_f32 v168, v168, v169
    v_cvt_pk_bf16_f32 v169, v170, v171
    v_cvt_pk_bf16_f32 v170, v172, v173
    v_cvt_pk_bf16_f32 v171, v174, v175
    v_exp_f32 v48, v48
    v_exp_f32 v49, v49
    s_waitcnt lgkmcnt(5)
    v_mfma_f32_32x32x16_bf16 v[112:127], v[212:215], v[220:223], 0
    v_exp_f32 v50, v50
    v_exp_f32 v51, v51
    v_exp_f32 v52, v52
    v_exp_f32 v53, v53
    s_waitcnt lgkmcnt(4)
    v_mfma_f32_32x32x16_bf16 v[112:127], v[216:219], v[224:227], v[112:127]
    v_exp_f32 v54, v54
    v_exp_f32 v55, v55
    v_cvt_pk_bf16_f32 v48, v48, v49
    v_cvt_pk_bf16_f32 v49, v50, v51
    v_cvt_pk_bf16_f32 v50, v52, v53
    v_cvt_pk_bf16_f32 v51, v54, v55
    v_exp_f32 v56, v56
    v_exp_f32 v57, v57
    s_waitcnt lgkmcnt(3)
    v_mfma_f32_32x32x16_bf16 v[128:143], v[192:195], v[220:223], 0
    v_exp_f32 v58, v58
    v_exp_f32 v59, v59
    v_exp_f32 v60, v60
    v_exp_f32 v61, v61
    s_waitcnt lgkmcnt(2)
    v_mfma_f32_32x32x16_bf16 v[128:143], v[196:199], v[224:227], v[128:143]
    v_exp_f32 v62, v62
    v_exp_f32 v63, v63
    v_cvt_pk_bf16_f32 v56, v56, v57
    v_cvt_pk_bf16_f32 v57, v58, v59
    v_cvt_pk_bf16_f32 v58, v60, v61
    v_cvt_pk_bf16_f32 v59, v62, v63
    v_exp_f32 v64, v64
    v_exp_f32 v65, v65
    s_waitcnt lgkmcnt(1)
    v_mfma_f32_32x32x16_bf16 v[144:159], v[200:203], v[220:223], 0
    v_exp_f32 v66, v66
    v_exp_f32 v67, v67
    v_exp_f32 v68, v68
    v_exp_f32 v69, v69
    s_waitcnt lgkmcnt(0)
    v_mfma_f32_32x32x16_bf16 v[144:159], v[204:207], v[224:227], v[144:159]
    v_exp_f32 v70, v70
    v_exp_f32 v71, v71
    v_cvt_pk_bf16_f32 v64, v64, v65
    v_cvt_pk_bf16_f32 v65, v66, v67
    v_cvt_pk_bf16_f32 v66, v68, v69
    v_cvt_pk_bf16_f32 v67, v70, v71
    v_exp_f32 v72, v72
    v_exp_f32 v73, v73
    v_exp_f32 v74, v74
    v_exp_f32 v75, v75
    v_exp_f32 v76, v76
    v_exp_f32 v77, v77
    v_exp_f32 v78, v78
    v_exp_f32 v79, v79
    v_cvt_pk_bf16_f32 v72, v72, v73
    v_cvt_pk_bf16_f32 v73, v74, v75
    v_cvt_pk_bf16_f32 v74, v76, v77
    v_cvt_pk_bf16_f32 v75, v78, v79
    v_exp_f32 v80, v80
    v_exp_f32 v81, v81
    v_exp_f32 v82, v82
    v_exp_f32 v83, v83
    v_exp_f32 v84, v84
    v_exp_f32 v85, v85
    v_exp_f32 v86, v86
    v_exp_f32 v87, v87
    v_cvt_pk_bf16_f32 v80, v80, v81
    v_cvt_pk_bf16_f32 v81, v82, v83
    v_cvt_pk_bf16_f32 v82, v84, v85
    v_cvt_pk_bf16_f32 v83, v86, v87
    s_barrier
    ds_read_b128 v[208:211], v8 offset:2048
    ds_read_b128 v[212:215], v8 offset:3072
    ds_read_b128 v[216:219], v8 offset:18432
    ds_read_b128 v[192:195], v8 offset:19456
    ds_read_b128 v[196:199], v8 offset:34816
    ds_read_b128 v[200:203], v8 offset:35840
    v_exp_f32 v88, v88
    v_exp_f32 v89, v89
    v_exp_f32 v90, v90
    v_exp_f32 v91, v91
    v_exp_f32_e64 v92, v92
    s_waitcnt lgkmcnt(5)
    v_mfma_f32_32x32x16_bf16 v[176:191], v[208:211], v[32:35], 0
    ds_read_b128 v[204:207], v8 offset:6144
    v_exp_f32 v93, v93
    v_exp_f32_e64 v94, v94
    s_waitcnt lgkmcnt(5)
    v_mfma_f32_32x32x16_bf16 v[176:191], v[212:215], v[40:43], v[176:191]
    ds_read_b128 v[208:211], v8 offset:7168
    v_exp_f32 v95, v95
    s_waitcnt lgkmcnt(5)
    v_mfma_f32_32x32x16_bf16 v[176:191], v[216:219], v[96:99], v[176:191]
    ds_read_b128 v[212:215], v8 offset:10240
    v_cvt_pk_bf16_f32 v88, v88, v89
    v_cvt_pk_bf16_f32 v89, v90, v91
    v_cvt_pk_bf16_f32 v90, v92, v93
    v_cvt_pk_bf16_f32 v91, v94, v95
    v_exp_f32 v112, v112
    s_waitcnt lgkmcnt(5)
    v_mfma_f32_32x32x16_bf16 v[176:191], v[192:195], v[104:107], v[176:191]
    ds_read_b128 v[216:219], v8 offset:11264
    v_exp_f32 v113, v113
    v_exp_f32 v114, v114
    v_exp_f32 v115, v115
    s_waitcnt lgkmcnt(5)
    v_mfma_f32_32x32x16_bf16 v[176:191], v[196:199], v[160:163], v[176:191]
    ds_read_b128 v[192:195], v8 offset:14336
    v_exp_f32 v116, v116
    v_exp_f32 v117, v117
    v_exp_f32 v118, v118
    s_waitcnt lgkmcnt(5)
    v_mfma_f32_32x32x16_bf16 v[176:191], v[200:203], v[168:171], v[176:191]
    ds_read_b128 v[196:199], v8 offset:15360
    v_exp_f32_e64 v119, v119
    v_cvt_pk_bf16_f32 v112, v112, v113
    v_cvt_pk_bf16_f32 v113, v114, v115
    v_cvt_pk_bf16_f32 v114, v116, v117
    v_cvt_pk_bf16_f32 v115, v118, v119
    v_exp_f32 v120, v120
    s_waitcnt lgkmcnt(5)
    v_mfma_f32_32x32x16_bf16 v[176:191], v[204:207], v[48:51], v[176:191]
    ds_read_b128 v[200:203], v8 offset:22528
    v_exp_f32 v121, v121
    v_exp_f32 v122, v122
    v_exp_f32 v123, v123
    s_waitcnt lgkmcnt(5)
    v_mfma_f32_32x32x16_bf16 v[176:191], v[208:211], v[56:59], v[176:191]
    ds_read_b128 v[204:207], v8 offset:23552
    v_exp_f32 v124, v124
    v_exp_f32 v125, v125
    v_exp_f32 v126, v126
    s_waitcnt lgkmcnt(5)
    v_mfma_f32_32x32x16_bf16 v[176:191], v[212:215], v[64:67], v[176:191]
    ds_read_b128 v[208:211], v8 offset:26624
    v_exp_f32_e64 v127, v127
    v_cvt_pk_bf16_f32 v120, v120, v121
    v_cvt_pk_bf16_f32 v121, v122, v123
    v_cvt_pk_bf16_f32 v122, v124, v125
    v_cvt_pk_bf16_f32 v123, v126, v127
    v_exp_f32 v128, v128
    v_exp_f32_e64 v129, v129
    s_waitcnt lgkmcnt(5)
    v_mfma_f32_32x32x16_bf16 v[176:191], v[216:219], v[72:75], v[176:191]
    ds_read_b128 v[212:215], v8 offset:27648
    v_exp_f32 v130, v130
    v_exp_f32 v131, v131
    v_exp_f32 v132, v132
    v_exp_f32_e64 v133, v133
    s_waitcnt lgkmcnt(5)
    v_mfma_f32_32x32x16_bf16 v[176:191], v[192:195], v[80:83], v[176:191]
    ds_read_b128 v[216:219], v8 offset:30720
    v_exp_f32 v134, v134
    v_exp_f32 v135, v135
    v_cvt_pk_bf16_f32 v128, v128, v129
    v_cvt_pk_bf16_f32 v129, v130, v131
    v_cvt_pk_bf16_f32 v130, v132, v133
    v_cvt_pk_bf16_f32 v131, v134, v135
    s_barrier
    v_exp_f32 v136, v136
    v_exp_f32 v137, v137
    s_waitcnt lgkmcnt(5)
    v_mfma_f32_32x32x16_bf16 v[176:191], v[196:199], v[88:91], v[176:191]
    ds_read_b128 v[192:195], v8 offset:31744
    v_exp_f32 v138, v138
    v_exp_f32 v139, v139
    v_exp_f32 v140, v140
    v_exp_f32 v141, v141
    s_waitcnt lgkmcnt(5)
    v_mfma_f32_32x32x16_bf16 v[176:191], v[200:203], v[112:115], v[176:191]
    v_exp_f32 v142, v142
    v_exp_f32_e64 v143, v143
    v_cvt_pk_bf16_f32 v136, v136, v137
    v_cvt_pk_bf16_f32 v137, v138, v139
    v_cvt_pk_bf16_f32 v138, v140, v141
    v_cvt_pk_bf16_f32 v139, v142, v143
    v_exp_f32 v144, v144
    v_exp_f32 v145, v145
    s_waitcnt lgkmcnt(4)
    v_mfma_f32_32x32x16_bf16 v[176:191], v[204:207], v[120:123], v[176:191]
    v_exp_f32 v146, v146
    v_exp_f32 v147, v147
    v_exp_f32 v148, v148
    v_exp_f32 v149, v149
    s_waitcnt lgkmcnt(3)
    v_mfma_f32_32x32x16_bf16 v[176:191], v[208:211], v[128:131], v[176:191]
    v_exp_f32 v150, v150
    v_exp_f32 v151, v151
    v_cvt_pk_bf16_f32 v144, v144, v145
    v_cvt_pk_bf16_f32 v145, v146, v147
    v_cvt_pk_bf16_f32 v146, v148, v149
    v_cvt_pk_bf16_f32 v147, v150, v151
    v_exp_f32 v152, v152
    v_exp_f32 v153, v153
    s_waitcnt lgkmcnt(2)
    v_mfma_f32_32x32x16_bf16 v[176:191], v[212:215], v[136:139], v[176:191]
    v_exp_f32 v154, v154
    v_exp_f32 v155, v155
    v_exp_f32 v156, v156
    v_exp_f32 v157, v157
    s_waitcnt lgkmcnt(1)
    v_mfma_f32_32x32x16_bf16 v[176:191], v[216:219], v[144:147], v[176:191]
    v_exp_f32 v158, v158
    v_exp_f32 v159, v159
    v_cvt_pk_bf16_f32 v152, v152, v153
    v_cvt_pk_bf16_f32 v153, v154, v155
    v_cvt_pk_bf16_f32 v154, v156, v157
    v_cvt_pk_bf16_f32 v155, v158, v159
    s_waitcnt lgkmcnt(0)
    s_nop 0
    v_mfma_f32_32x32x16_bf16 v[176:191], v[192:195], v[152:155], v[176:191]
    s_lshl_b32 s53, s68, 4
    s_add_u32 s53, s53, s48
    s_lshl_b32 s53, s53, 11
    s_add_u32 s53, s53, 4194304
    s_and_b32 s54, s68, 7
    s_lshl_b32 s54, s54, 5
    s_add_u32 s54, s54, s48
    s_lshl_b32 s54, s54, 2
    s_add_u32 s54, s54, s77
    s_waitcnt vmcnt(0)
    s_mov_b32 exec_hi, 0
    v_cmp_eq_u32 vcc, 0, v15
    s_cbranch_vccz L_ok_50
L_poll_51:
    buffer_load_dword v15, v3, s[40:43], s77 offen sc1
    s_add_u32 s52, s52, 1
    s_waitcnt vmcnt(0)
    v_cmp_eq_u32 vcc, 0, v15
    s_cmp_gt_u32 s52, 4194304
    s_cbranch_scc1 L_polled_52
    s_cbranch_vccnz L_poll_51
L_polled_52:
L_ok_50:
    v_cmp_ne_u32 vcc, s50, v15
    s_mov_b64 exec, -1
    s_cmp_eq_u64 vcc, 0
    s_cselect_b32 s51, 1, 0
    v_mov_b32 v26, v188
    v_mov_b32_e64 v27, v188
    s_nop 1
    v_permlane32_swap_b32 v26, v27
    v_subrev_u32 v26, 813694976, v27
    v_cmp_lt_u32 vcc, 754974720, v26
    s_cbranch_vccnz L_exact_47
L_checked_48:
    v_rcp_f32 v27, v27
    v_pk_mul_f32 v[28:29], v[176:177], v[240:241]
    v_pk_fma_f32 v[28:29], v[178:179], v[242:243], v[28:29]
    v_pk_fma_f32 v[28:29], v[180:181], v[244:245], v[28:29]
    v_pk_fma_f32 v[28:29], v[182:183], v[246:247], v[28:29]
    v_pk_fma_f32 v[28:29], v[184:185], v[248:249], v[28:29]
    v_pk_fma_f32 v[28:29], v[186:187], v[250:251], v[28:29]
    v_pk_fma_f32 v[28:29], v[188:189], v[252:253], v[28:29]
    v_pk_fma_f32 v[28:29], v[190:191], v[254:255], v[28:29]
    v_add_f32 v28, v28, v29
    v_mov_b32 v29, v28
    v_pk_mul_f32 v[184:185], v[184:185], v[26:27] op_sel:[0,1] op_sel_hi:[1,1]
    v_pk_mul_f32 v[186:187], v[186:187], v[26:27] op_sel:[0,1] op_sel_hi:[1,1]
    v_pk_mul_f32 v[188:189], v[188:189], v[26:27] op_sel:[0,1] op_sel_hi:[1,1]
    v_pk_mul_f32 v[190:191], v[190:191], v[26:27] op_sel:[0,1] op_sel_hi:[1,1]
    v_permlane32_swap_b32 v28, v29
    v_pk_mul_f32 v[176:177], v[176:177], v[26:27] op_sel:[0,1] op_sel_hi:[1,1]
    v_pk_mul_f32 v[178:179], v[178:179], v[26:27] op_sel:[0,1] op_sel_hi:[1,1]
    v_pk_mul_f32 v[180:181], v[180:181], v[26:27] op_sel:[0,1] op_sel_hi:[1,1]
    v_pk_mul_f32 v[182:183], v[182:183], v[26:27] op_sel:[0,1] op_sel_hi:[1,1]
    v_add_f32 v28, v28, v29
    v_cvt_pk_bf16_f32 v220, v176, v177
    v_cvt_pk_bf16_f32 v221, v178, v179
    v_cvt_pk_bf16_f32 v222, v180, v181
    v_cvt_pk_bf16_f32 v223, v182, v183
    v_fma_f32 v28, v28, v27, v20
    s_cmp_eq_u32 s51, 0
    s_cbranch_scc1 L_slow_53
    buffer_store_dwordx4 v[220:223], v2, s[40:43], s53 offen offset:0
L_pubd_54:
    v_cvt_pk_bf16_f32 v25, v28, v28
    v_and_b32 v26, 0xffff0000, v25
    v_sub_f32_e64 v26, v28, v26
    v_cvt_pk_bf16_f32 v24, v28, v26
    v_cvt_pk_bf16_f32 v224, v184, v185
    v_cvt_pk_bf16_f32 v225, v186, v187
    v_cvt_pk_bf16_f32 v226, v188, v189
    v_cvt_pk_bf16_f32 v227, v190, v191
    v_cndmask_b32 v226, v226, v24, s[60:61]
    v_cndmask_b32 v227, v227, 0, s[60:61]
    s_cmp_eq_u32 s51, 0
    s_cbranch_scc1 L_slow_55
    buffer_store_dwordx4 v[224:227], v2, s[40:43], s53 offen offset:1024
L_pubd_56:
    v_mov_b32 v26, 0
    v_mov_b32 v27, 1
    s_waitcnt vmcnt(0)
    s_mov_b64 exec, 1
    s_cmp_eq_u32 s51, 0
    s_cbranch_scc1 L_slow_57
    buffer_store_dword v27, v26, s[40:43], s54 offen offset:0
L_pubd_58:
    s_mov_b64 exec, -1
    s_cmp_ge_u32 s45, 28
    s_cbranch_scc1 L_Ldone
    v_lshrrev_b32 v4, 3, v1
    v_mul_u32_u24 v4, 896, v4
    v_lshrrev_b32 v26, 2, v1
    v_lshrrev_b32 v27, 4, v1
    v_xor_b32 v26, v26, v27
    v_and_b32 v26, 1, v26
    v_mul_u32_u24 v26, 64, v26
    v_add_u32 v4, v4, v26
    v_and_b32_e64 v26, 3, v1
    v_lshl_add_u32 v4, v26, 4, v4
    v_add_u32 v5, 113664, v4
    v_add_u32 v6, 227328, v4
    v_add_u32 v7, 340992, v4
    v_lshrrev_b32 v8, 5, v1
    v_mul_u32_u24 v8, 4, v8
    v_bfe_u32 v26, v1, 2, 2
    v_add_u32_e64 v8, v8, v26
    v_mul_u32_u24 v8, 128, v8
    v_bfe_u32 v26, v1, 4, 1
    v_mul_u32_u24 v26, 32, v26
    v_add_u32 v8, v8, v26
    v_and_b32_e64 v26, 3, v1
    v_lshl_add_u32 v8, v26, 3, v8
    v_bfe_u32 v26, v1, 3, 1
    v_lshlrev_b32 v26, 6, v26
    v_xor_b32 v27, 64, v26
    s_mov_b32 s53, 106496
    s_mov_b32 s54, 49152
    v_add3_u32 v9, v8, v27, s53
    v_add3_u32 v10, v8, v26, s54
    v_add3_u32 v11, v8, v27, s54
    v_add3_u32 v8, v8, v26, s53
    v_lshrrev_b32 v30, 3, v1
    v_mul_u32_u24 v30, 3584, v30
    v_lshrrev_b32 v26, 2, v1
    v_lshrrev_b32 v27, 4, v1
    v_xor_b32 v26, v26, v27
    v_and_b32 v26, 1, v26
    v_mul_u32_u24 v26, 64, v26
    v_add_u32 v30, v30, v26
    v_and_b32 v26, 3, v1
    v_lshl_add_u32 v30, v26, 4, v30
    v_add_u32 v31, 27648, v30
    v_lshrrev_b32 v12, 5, v1
    v_mul_u32_u24 v12, 4, v12
    v_bfe_u32 v26, v1, 2, 2
    v_add_u32_e64 v12, v12, v26
    v_mul_u32_u24 v12, 128, v12
    v_bfe_u32 v26, v1, 4, 1
    v_mul_u32_u24 v26, 32, v26
    v_add_u32 v12, v12, v26
    v_and_b32_e64 v26, 3, v1
    v_lshl_add_u32 v12, v26, 3, v12
    v_bfe_u32 v26, v1, 3, 1
    v_xor_b32 v26, s74, v26
    v_lshlrev_b32 v26, 6, v26
    v_xor_b32 v27, 64, v26
    v_add_u32 v13, v12, v27
    v_add_u32 v12, v12, v26
    s_mul_i32 s53, s74, 14336
    v_add_u32 v12, s53, v12
    v_add_u32_e64 v13, s53, v13
    s_xor_b32 s54, s72, 2
    s_lshl_b32 s54, s54, 1
    s_add_u32 s54, s54, s75
    s_lshl_b32 s59, s44, 3
    s_add_u32 s59, s59, s54
    s_lshl_b32 s54, s54, 5
    s_mul_i32 s53, s74, 14
    s_add_u32 s54, s54, s53
    s_sub_u32 s54, s54, s76
    s_add_u32 s54, s54, 1
    s_lshl_b32 s54, s54, 2
    s_add_u32 s54, s54, s77
    s_add_u32 s49, s54, 2048
    s_mul_i32 s79, s74, 802816
    s_mul_i32 s53, s75, 7168
    s_add_u32 s79, s79, s53
    s_lshl_b32 s53, s73, 7
    s_add_u32 s79, s79, s53
    s_xor_b32 s53, s76, 1
    s_mul_i32 s53, s53, 57344
    s_add_u32 s79, s79, s53
    s_mul_i32 s62, s46, 7168
    s_xor_b32 s71, s70, 0
    s_lshl_b32 s71, s71, 2
    s_add_u32 s71, s71, s46
    s_lshl_b32 s68, s44, 3
    s_add_u32 s68, s68, s71
    s_lshr_b32 s54, s45, 1
    s_lshl_b32 s54, s54, 10
    s_mul_i32 s53, s68, 32768
    s_add_u32 s53, s53, s54
    s_add_u32 s78, s53, 4194304
    s_mul_i32 s53, s68, 28672
    s_add_u32 s53, s53, s54
    s_add_u32 s69, s53, 6291456
    s_lshl_b32 s53, s71, 5
    s_add_u32 s53, s53, s45
    s_lshl_b32 s53, s53, 2
    s_add_u32 s53, s53, s77
    s_add_u32 s48, s53, 2048
    v_lshlrev_b32 v21, 2, v1
    v_lshlrev_b32 v22, 3, v1
    s_barrier
    s_add_u32 s55, s44, 0
    s_cmp_ge_u32 s55, 7
    s_cselect_b32 s56, 7, 0
    s_sub_u32 s55, s55, s56
    s_lshl_b32 s55, s55, 2
    s_add_u32 s55, s55, s46
    s_lshl_b32 s56, s55, 11
    s_add_u32 m0, s56, 49152
    s_mul_i32 s55, s55, 57344
    s_lshl_b32 s56, s45, 7
    s_add_u32 s55, s55, s56
    buffer_load_dwordx4 v30, s[24:27], s55 offen offset:0  lds
    buffer_load_dwordx4 v31, s[24:27], s55 offen offset:1024  lds
    s_add_u32 s55, s44, 1
    s_cmp_ge_u32 s55, 7
    s_cselect_b32 s56, 7, 0
    s_sub_u32 s55, s55, s56
    s_lshl_b32 s55, s55, 2
    s_add_u32 s55, s55, s46
    s_lshl_b32 s56, s55, 11
    s_add_u32 m0, s56, 49152
    s_mul_i32 s55, s55, 57344
    s_lshl_b32 s56, s45, 7
    s_add_u32 s55, s55, s56
    buffer_load_dwordx4 v30, s[24:27], s55 offen offset:0  lds
    buffer_load_dwordx4 v31, s[24:27], s55 offen offset:1024  lds
    s_barrier
    ds_read_b64_tr_b16 v[192:193], v8 offset:0
    ds_read_b64_tr_b16 v[194:195], v8 offset:1024
    ds_read_b64_tr_b16 v[196:197], v9 offset:0
    ds_read_b64_tr_b16 v[198:199], v9 offset:1024
    ds_read_b64_tr_b16 v[200:201], v8 offset:2048
    ds_read_b64_tr_b16 v[202:203], v8 offset:3072
    ds_read_b64_tr_b16 v[204:205], v9 offset:2048
    ds_read_b64_tr_b16 v[206:207], v9 offset:3072
    ds_read_b64_tr_b16 v[208:209], v8 offset:4096
    ds_read_b64_tr_b16 v[210:211], v8 offset:5120
    ds_read_b64_tr_b16 v[212:213], v9 offset:4096
    ds_read_b64_tr_b16 v[214:215], v9 offset:5120
    s_lshl_b32 s53, s71, 7
    s_add_u32 s53, s53, s77
    s_add_u32 s53, s53, 1024
    s_mul_i32 s57, s68, 28672
    s_add_u32 s57, s57, 6291456
    s_lshl_b32 s58, s68, 11
    s_add_u32 s58, s58, 8126464
    s_mov_b64 exec, 0x3fff
L_poll_59:
    buffer_load_dword v23, v21, s[40:43], s53 offen sc1
    s_add_u32 s52, s52, 1
    s_waitcnt vmcnt(0)
    v_cmp_ne_u32 vcc, 1, v23
    s_cmp_gt_u32 s52, 4194304
    s_cbranch_scc1 L_polled_60
    s_cbranch_vccnz L_poll_59
L_polled_60:
    s_mov_b64 exec, -1
    s_setprio 2
    buffer_load_dwordx4 v[32:35], v2, s[40:43], s57 offen offset:0 sc1
    buffer_load_dwordx4 v[36:39], v2, s[40:43], s57 offen offset:1024 sc1
    buffer_load_dwordx4 v[40:43], v2, s[40:43], s57 offen offset:2048 sc1
    buffer_load_dwordx4 v[44:47], v2, s[40:43], s57 offen offset:3072 sc1
    s_add_u32 s57, s57, 4096
    buffer_load_dwordx4 v[48:51], v2, s[40:43], s57 offen offset:0 sc1
    buffer_load_dwordx4 v[52:55], v2, s[40:43], s57 offen offset:1024 sc1
    buffer_load_dwordx4 v[56:59], v2, s[40:43], s57 offen offset:2048 sc1
    buffer_load_dwordx4 v[60:63], v2, s[40:43], s57 offen offset:3072 sc1
    s_add_u32 s57, s57, 4096
    buffer_load_dwordx4 v[64:67], v2, s[40:43], s57 offen offset:0 sc1
    buffer_load_dwordx4 v[68:71], v2, s[40:43], s57 offen offset:1024 sc1
    buffer_load_dwordx4 v[72:75], v2, s[40:43], s57 offen offset:2048 sc1
    buffer_load_dwordx4 v[76:79], v2, s[40:43], s57 offen offset:3072 sc1
    s_add_u32 s57, s57, 4096
    s_waitcnt vmcnt(11) lgkmcnt(10)
    v_mfma_f32_32x32x16_bf16 v[144:159], v[192:195], v[32:35], 0
    ds_read_b64_tr_b16 v[216:217], v8 offset:6144
    ds_read_b64_tr_b16 v[218:219], v8 offset:7168
    buffer_load_dwordx4 v[80:83], v2, s[40:43], s57 offen offset:0 sc1
    s_waitcnt lgkmcnt(10)
    v_mfma_f32_32x32x16_bf16 v[160:175], v[196:199], v[32:35], 0
    ds_read_b64_tr_b16 v[192:193], v9 offset:6144
    ds_read_b64_tr_b16 v[194:195], v9 offset:7168
    s_waitcnt vmcnt(11) lgkmcnt(10)
    v_mfma_f32_32x32x16_bf16 v[144:159], v[200:203], v[36:39], v[144:159]
    ds_read_b64_tr_b16 v[196:197], v8 offset:8192
    ds_read_b64_tr_b16 v[198:199], v8 offset:9216
    buffer_load_dwordx4 v[84:87], v2, s[40:43], s57 offen offset:1024 sc1
    s_waitcnt lgkmcnt(10)
    v_mfma_f32_32x32x16_bf16 v[160:175], v[204:207], v[36:39], v[160:175]
    ds_read_b64_tr_b16 v[200:201], v9 offset:8192
    ds_read_b64_tr_b16 v[202:203], v9 offset:9216
    s_waitcnt vmcnt(11) lgkmcnt(10)
    v_mfma_f32_32x32x16_bf16 v[144:159], v[208:211], v[40:43], v[144:159]
    ds_read_b64_tr_b16 v[204:205], v8 offset:10240
    ds_read_b64_tr_b16 v[206:207], v8 offset:11264
    buffer_load_dwordx4 v[88:91], v2, s[40:43], s57 offen offset:2048 sc1
    s_waitcnt lgkmcnt(10)
    v_mfma_f32_32x32x16_bf16 v[160:175], v[212:215], v[40:43], v[160:175]
    ds_read_b64_tr_b16 v[208:209], v9 offset:10240
    ds_read_b64_tr_b16 v[210:211], v9 offset:11264
    s_waitcnt vmcnt(11) lgkmcnt(10)
    v_mfma_f32_32x32x16_bf16 v[144:159], v[216:219], v[44:47], v[144:159]
    ds_read_b64_tr_b16 v[212:213], v8 offset:12288
    ds_read_b64_tr_b16 v[214:215], v8 offset:13312
    buffer_load_dwordx4 v[92:95], v2, s[40:43], s57 offen offset:3072 sc1
    s_add_u32 s57, s57, 4096
    s_waitcnt lgkmcnt(10)
    v_mfma_f32_32x32x16_bf16 v[160:175], v[192:195], v[44:47], v[160:175]
    ds_read_b64_tr_b16 v[216:217], v9 offset:12288
    ds_read_b64_tr_b16 v[218:219], v9 offset:13312
    s_waitcnt vmcnt(11) lgkmcnt(10)
    v_mfma_f32_32x32x16_bf16 v[144:159], v[196:199], v[48:51], v[144:159]
    ds_read_b64_tr_b16 v[192:193], v8 offset:14336
    ds_read_b64_tr_b16 v[194:195], v8 offset:15360
    buffer_load_dwordx4 v[96:99], v2, s[40:43], s57 offen offset:0 sc1
    s_waitcnt lgkmcnt(10)
    v_mfma_f32_32x32x16_bf16 v[160:175], v[200:203], v[48:51], v[160:175]
    ds_read_b64_tr_b16 v[196:197], v9 offset:14336
    ds_read_b64_tr_b16 v[198:199], v9 offset:15360
    s_waitcnt vmcnt(11) lgkmcnt(10)
    v_mfma_f32_32x32x16_bf16 v[144:159], v[204:207], v[52:55], v[144:159]
    ds_read_b64_tr_b16 v[200:201], v8 offset:16384
    ds_read_b64_tr_b16 v[202:203], v8 offset:17408
    buffer_load_dwordx4 v[100:103], v2, s[40:43], s57 offen offset:1024 sc1
    s_waitcnt lgkmcnt(10)
    v_mfma_f32_32x32x16_bf16 v[160:175], v[208:211], v[52:55], v[160:175]
    ds_read_b64_tr_b16 v[204:205], v9 offset:16384
    ds_read_b64_tr_b16 v[206:207], v9 offset:17408
    s_waitcnt vmcnt(11) lgkmcnt(10)
    v_mfma_f32_32x32x16_bf16 v[144:159], v[212:215], v[56:59], v[144:159]
    ds_read_b64_tr_b16 v[208:209], v8 offset:18432
    ds_read_b64_tr_b16 v[210:211], v8 offset:19456
    buffer_load_dwordx4 v[104:107], v2, s[40:43], s57 offen offset:2048 sc1
    s_waitcnt lgkmcnt(10)
    v_mfma_f32_32x32x16_bf16 v[160:175], v[216:219], v[56:59], v[160:175]
    ds_read_b64_tr_b16 v[212:213], v9 offset:18432
    ds_read_b64_tr_b16 v[214:215], v9 offset:19456
    s_waitcnt vmcnt(11) lgkmcnt(10)
    v_mfma_f32_32x32x16_bf16 v[144:159], v[192:195], v[60:63], v[144:159]
    ds_read_b64_tr_b16 v[216:217], v8 offset:20480
    ds_read_b64_tr_b16 v[218:219], v8 offset:21504
    buffer_load_dwordx4 v[108:111], v2, s[40:43], s57 offen offset:3072 sc1
    s_add_u32 s57, s57, 4096
    s_waitcnt lgkmcnt(10)
    v_mfma_f32_32x32x16_bf16 v[160:175], v[196:199], v[60:63], v[160:175]
    ds_read_b64_tr_b16 v[192:193], v9 offset:20480
    ds_read_b64_tr_b16 v[194:195], v9 offset:21504
    s_waitcnt vmcnt(11) lgkmcnt(10)
    v_mfma_f32_32x32x16_bf16 v[144:159], v[200:203], v[64:67], v[144:159]
    ds_read_b64_tr_b16 v[196:197], v8 offset:22528
    ds_read_b64_tr_b16 v[198:199], v8 offset:23552
    buffer_load_dwordx4 v[112:115], v2, s[40:43], s57 offen offset:0 sc1
    s_waitcnt lgkmcnt(10)
    v_mfma_f32_32x32x16_bf16 v[160:175], v[204:207], v[64:67], v[160:175]
    ds_read_b64_tr_b16 v[200:201], v9 offset:22528
    ds_read_b64_tr_b16 v[202:203], v9 offset:23552
    s_waitcnt vmcnt(11) lgkmcnt(10)
    v_mfma_f32_32x32x16_bf16 v[144:159], v[208:211], v[68:71], v[144:159]
    ds_read_b64_tr_b16 v[204:205], v8 offset:24576
    ds_read_b64_tr_b16 v[206:207], v8 offset:25600
    buffer_load_dwordx4 v[116:119], v2, s[40:43], s57 offen offset:1024 sc1
    s_waitcnt lgkmcnt(10)
    v_mfma_f32_32x32x16_bf16 v[160:175], v[212:215], v[68:71], v[160:175]
    ds_read_b64_tr_b16 v[208:209], v9 offset:24576
    ds_read_b64_tr_b16 v[210:211], v9 offset:25600
    s_waitcnt vmcnt(11) lgkmcnt(10)
    v_mfma_f32_32x32x16_bf16 v[144:159], v[216:219], v[72:75], v[144:159]
    ds_read_b64_tr_b16 v[212:213], v8 offset:26624
    ds_read_b64_tr_b16 v[214:215], v8 offset:27648
    buffer_load_dwordx4 v[120:123], v2, s[40:43], s57 offen offset:2048 sc1
    s_waitcnt lgkmcnt(10)
    v_mfma_f32_32x32x16_bf16 v[160:175], v[192:195], v[72:75], v[160:175]
    ds_read_b64_tr_b16 v[216:217], v9 offset:26624
    ds_read_b64_tr_b16 v[218:219], v9 offset:27648
    s_branch L_pg4_skip
    .p2align 12
L_pg4:
    s_branch L_visit1_back
    s_nop 0
L_pg4_skip:
    s_waitcnt vmcnt(11) lgkmcnt(10)
    v_mfma_f32_32x32x16_bf16 v[144:159], v[196:199], v[76:79], v[144:159]
    ds_read_b64_tr_b16 v[192:193], v8 offset:28672
    ds_read_b64_tr_b16 v[194:195], v8 offset:29696
    buffer_load_dwordx4 v[124:127], v2, s[40:43], s57 offen offset:3072 sc1
    s_add_u32 s57, s57, 4096
    s_waitcnt lgkmcnt(10)
    v_mfma_f32_32x32x16_bf16 v[160:175], v[200:203], v[76:79], v[160:175]
    ds_read_b64_tr_b16 v[196:197], v9 offset:28672
    ds_read_b64_tr_b16 v[198:199], v9 offset:29696
    s_waitcnt vmcnt(11) lgkmcnt(10)
    v_mfma_f32_32x32x16_bf16 v[144:159], v[204:207], v[80:83], v[144:159]
    ds_read_b64_tr_b16 v[200:201], v8 offset:30720
    ds_read_b64_tr_b16 v[202:203], v8 offset:31744
    buffer_load_dwordx4 v[128:131], v2, s[40:43], s57 offen offset:0 sc1
    s_waitcnt lgkmcnt(10)
    v_mfma_f32_32x32x16_bf16 v[160:175], v[208:211], v[80:83], v[160:175]
    ds_read_b64_tr_b16 v[204:205], v9 offset:30720
    ds_read_b64_tr_b16 v[206:207], v9 offset:31744
    s_waitcnt vmcnt(11) lgkmcnt(10)
    v_mfma_f32_32x32x16_bf16 v[144:159], v[212:215], v[84:87], v[144:159]
    ds_read_b64_tr_b16 v[208:209], v8 offset:32768
    ds_read_b64_tr_b16 v[210:211], v8 offset:33792
    buffer_load_dwordx4 v[132:135], v2, s[40:43], s57 offen offset:1024 sc1
    s_waitcnt lgkmcnt(10)
    v_mfma_f32_32x32x16_bf16 v[160:175], v[216:219], v[84:87], v[160:175]
    ds_read_b64_tr_b16 v[212:213], v9 offset:32768
    ds_read_b64_tr_b16 v[214:215], v9 offset:33792
    s_waitcnt vmcnt(11) lgkmcnt(10)
    v_mfma_f32_32x32x16_bf16 v[144:159], v[192:195], v[88:91], v[144:159]
    ds_read_b64_tr_b16 v[216:217], v8 offset:34816
    ds_read_b64_tr_b16 v[218:219], v8 offset:35840
    buffer_load_dwordx4 v[136:139], v2, s[40:43], s57 offen offset:2048 sc1
    s_waitcnt lgkmcnt(10)
    v_mfma_f32_32x32x16_bf16 v[160:175], v[196:199], v[88:91], v[160:175]
    ds_read_b64_tr_b16 v[192:193], v9 offset:34816
    ds_read_b64_tr_b16 v[194:195], v9 offset:35840
    s_waitcnt vmcnt(11) lgkmcnt(10)
    v_mfma_f32_32x32x16_bf16 v[144:159], v[200:203], v[92:95], v[144:159]
    ds_read_b64_tr_b16 v[196:197], v8 offset:36864
    ds_read_b64_tr_b16 v[198:199], v8 offset:37888
    buffer_load_dwordx4 v[140:143], v2, s[40:43], s57 offen offset:3072 sc1
    s_add_u32 s57, s57, 4096
    s_waitcnt lgkmcnt(10)
    v_mfma_f32_32x32x16_bf16 v[160:175], v[204:207], v[92:95], v[160:175]
    ds_read_b64_tr_b16 v[200:201], v9 offset:36864
    ds_read_b64_tr_b16 v[202:203], v9 offset:37888
    s_waitcnt vmcnt(11) lgkmcnt(10)
    v_mfma_f32_32x32x16_bf16 v[144:159], v[208:211], v[96:99], v[144:159]
    ds_read_b64_tr_b16 v[204:205], v8 offset:38912
    ds_read_b64_tr_b16 v[206:207], v8 offset:39936
    s_lshl_b32 s53, s46, 11
    s_add_u32 m0, s53, 20480
    v_add_u32_e64 v235, s53, v21
    buffer_load_dwordx4 v2, s[40:43], s58 offen offset:0 sc1 lds
    buffer_load_dwordx4 v2, s[40:43], s58 offen offset:1024 sc1 lds
    s_waitcnt lgkmcnt(10)
    v_mfma_f32_32x32x16_bf16 v[160:175], v[212:215], v[96:99], v[160:175]
    ds_read_b64_tr_b16 v[208:209], v9 offset:38912
    ds_read_b64_tr_b16 v[210:211], v9 offset:39936
    s_waitcnt vmcnt(12) lgkmcnt(10)
    v_mfma_f32_32x32x16_bf16 v[144:159], v[216:219], v[100:103], v[144:159]
    ds_read_b64_tr_b16 v[212:213], v8 offset:40960
    ds_read_b64_tr_b16 v[214:215], v8 offset:41984
    s_barrier
    s_waitcnt lgkmcnt(10)
    v_mfma_f32_32x32x16_bf16 v[160:175], v[192:195], v[100:103], v[160:175]
    ds_read_b64_tr_b16 v[216:217], v9 offset:40960
    ds_read_b64_tr_b16 v[218:219], v9 offset:41984
    s_waitcnt vmcnt(11) lgkmcnt(10)
    v_mfma_f32_32x32x16_bf16 v[144:159], v[196:199], v[104:107], v[144:159]
    ds_read_b64_tr_b16 v[192:193], v8 offset:43008
    ds_read_b64_tr_b16 v[194:195], v8 offset:44032
    s_waitcnt lgkmcnt(10)
    v_mfma_f32_32x32x16_bf16 v[160:175], v[200:203], v[104:107], v[160:175]
    ds_read_b64_tr_b16 v[196:197], v9 offset:43008
    ds_read_b64_tr_b16 v[198:199], v9 offset:44032
    s_waitcnt vmcnt(10) lgkmcnt(10)
    v_mfma_f32_32x32x16_bf16 v[144:159], v[204:207], v[108:111], v[144:159]
    ds_read_b64_tr_b16 v[200:201], v8 offset:45056
    ds_read_b64_tr_b16 v[202:203], v8 offset:46080
    s_waitcnt lgkmcnt(10)
    v_mfma_f32_32x32x16_bf16 v[160:175], v[208:211], v[108:111], v[160:175]
    ds_read_b64_tr_b16 v[204:205], v9 offset:45056
    ds_read_b64_tr_b16 v[206:207], v9 offset:46080
    s_waitcnt vmcnt(9) lgkmcnt(10)
    v_mfma_f32_32x32x16_bf16 v[144:159], v[212:215], v[112:115], v[144:159]
    ds_read_b64_tr_b16 v[208:209], v8 offset:47104
    ds_read_b64_tr_b16 v[210:211], v8 offset:48128
    s_waitcnt lgkmcnt(10)
    v_mfma_f32_32x32x16_bf16 v[160:175], v[216:219], v[112:115], v[160:175]
    ds_read_b64_tr_b16 v[212:213], v9 offset:47104
    ds_read_b64_tr_b16 v[214:215], v9 offset:48128
    s_waitcnt vmcnt(8) lgkmcnt(10)
    v_mfma_f32_32x32x16_bf16 v[144:159], v[192:195], v[116:119], v[144:159]
    ds_read_b64_tr_b16 v[216:217], v8 offset:49152
    ds_read_b64_tr_b16 v[218:219], v8 offset:50176
    s_waitcnt lgkmcnt(10)
    v_mfma_f32_32x32x16_bf16 v[160:175], v[196:199], v[116:119], v[160:175]
    ds_read_b64_tr_b16 v[192:193], v9 offset:49152
    ds_read_b64_tr_b16 v[194:195], v9 offset:50176
    s_waitcnt vmcnt(7) lgkmcnt(10)
    v_mfma_f32_32x32x16_bf16 v[144:159], v[200:203], v[120:123], v[144:159]
    ds_read_b64_tr_b16 v[196:197], v8 offset:51200
    ds_read_b64_tr_b16 v[198:199], v8 offset:52224
    s_waitcnt lgkmcnt(10)
    v_mfma_f32_32x32x16_bf16 v[160:175], v[204:207], v[120:123], v[160:175]
    ds_read_b64_tr_b16 v[200:201], v9 offset:51200
    ds_read_b64_tr_b16 v[202:203], v9 offset:52224
    s_waitcnt vmcnt(6) lgkmcnt(10)
    v_mfma_f32_32x32x16_bf16 v[144:159], v[208:211], v[124:127], v[144:159]
    ds_read_b64_tr_b16 v[204:205], v8 offset:53248
    ds_read_b64_tr_b16 v[206:207], v8 offset:54272
    s_waitcnt lgkmcnt(10)
    v_mfma_f32_32x32x16_bf16 v[160:175], v[212:215], v[124:127], v[160:175]
    ds_read_b64_tr_b16 v[208:209], v9 offset:53248
    ds_read_b64_tr_b16 v[210:211], v9 offset:54272
    s_waitcnt vmcnt(5) lgkmcnt(10)
    v_mfma_f32_32x32x16_bf16 v[144:159], v[216:219], v[128:131], v[144:159]
    ds_read_b64_tr_b16 v[212:213], v8 offset:55296
    ds_read_b64_tr_b16 v[214:215], v8 offset:56320
    s_waitcnt lgkmcnt(10)
    v_mfma_f32_32x32x16_bf16 v[160:175], v[192:195], v[128:131], v[160:175]
    ds_read_b64_tr_b16 v[216:217], v9 offset:55296
    ds_read_b64_tr_b16 v[218:219], v9 offset:56320
    s_waitcnt vmcnt(4) lgkmcnt(10)
    v_mfma_f32_32x32x16_bf16 v[144:159], v[196:199], v[132:135], v[144:159]
    s_waitcnt lgkmcnt(8)
    v_mfma_f32_32x32x16_bf16 v[160:175], v[200:203], v[132:135], v[160:175]
    s_waitcnt vmcnt(3) lgkmcnt(6)
    v_mfma_f32_32x32x16_bf16 v[144:159], v[204:207], v[136:139], v[144:159]
    s_waitcnt lgkmcnt(4)
    v_mfma_f32_32x32x16_bf16 v[160:175], v[208:211], v[136:139], v[160:175]
    s_waitcnt vmcnt(2) lgkmcnt(2)
    v_mfma_f32_32x32x16_bf16 v[144:159], v[212:215], v[140:143], v[144:159]
    s_waitcnt lgkmcnt(0)
    v_mfma_f32_32x32x16_bf16 v[160:175], v[216:219], v[140:143], v[160:175]
    s_waitcnt vmcnt(0)
    ds_read_b32 v228, v235 offset:20480
    ds_read_b32 v229, v235 offset:20736
    ds_read_b32 v230, v235 offset:20992
    ds_read_b32 v231, v235 offset:21248
    ds_read_b32 v232, v235 offset:21504
    ds_read_b32 v233, v235 offset:21760
    ds_read_b32 v234, v235 offset:22016
    v_mov_b32 v3, 1
    s_mov_b64 exec, 1
    s_cmp_eq_u32 s51, 0
    s_cbranch_scc1 L_slow_61
    buffer_store_dword v3, v21, s[40:43], s48 offen
L_pubd_62:
    s_mov_b64 exec, -1
    s_lshl_b32 s53, s46, 2
    s_add_u32 s53, s53, 17408
    v_mov_b32 v17, s53
    v_mov_b32_e64 v26, 0
    ds_write2_b32 v17, v26, v26 offset0:0 offset1:4
    ds_write2_b32 v17, v26, v26 offset0:8 offset1:12
    s_waitcnt lgkmcnt(2)
    v_add_f32 v228, v228, v231
    v_add_f32 v229, v229, v232
    v_add_f32 v230, v230, v233
    v_add_f32 v228, v228, v234
    v_add_f32 v229, v229, v230
    v_add_f32 v228, v228, v229
    v_mov_b32 v229, v228
    s_nop 1
    v_permlane32_swap_b32 v228, v229
    v_add_f32_e64 v228, v228, v229
    v_mul_f32 v228, 991054117, v228
    v_add_f32 v16, 925353388, v228
    v_rsq_f32 v228, v16
    s_nop 0
    v_mul_f32 v14, 3222493025, v228
    v_mul_f32 v228, v228, v228
    v_mul_f32 v228, 1027024659, v228
    v_mul_f32_e64 v15, v228, v14
    s_add_u32 s55, s44, 4
    s_cmp_ge_u32 s55, 7
    s_cselect_b32 s56, 7, 0
    s_sub_u32 s55, s55, s56
    s_lshl_b32 s55, s55, 2
    s_add_u32 s55, s55, s46
    s_lshl_b32 s56, s55, 11
    s_add_u32 m0, s56, 49152
    s_mul_i32 s55, s55, 57344
    s_lshl_b32 s56, s45, 7
    s_add_u32 s55, s55, s56
    buffer_load_dwordx4 v30, s[24:27], s55 offen offset:0  lds
    v_mul_f32 v220, v144, v144
    v_mul_f32 v221, v145, v145
    v_mul_f32 v222, v146, v146
    v_mul_f32 v223, v147, v147
    v_mul_f32 v224, v148, v148
    v_mul_f32 v225, v149, v149
    v_mul_f32 v226, v150, v150
    v_mul_f32 v227, v151, v151
    v_fma_f32 v220, v220, v15, v14
    v_fma_f32 v221, v221, v15, v14
    v_fma_f32 v222, v222, v15, v14
    v_fma_f32 v223, v223, v15, v14
    v_fma_f32 v224, v224, v15, v14
    v_fma_f32 v225, v225, v15, v14
    v_fma_f32 v226, v226, v15, v14
    v_fma_f32 v227, v227, v15, v14
    v_mul_f32 v220, v220, v144
    v_mul_f32 v221, v221, v145
    v_mul_f32 v222, v222, v146
    v_mul_f32 v223, v223, v147
    v_mul_f32 v224, v224, v148
    v_mul_f32 v225, v225, v149
    v_mul_f32 v226, v226, v150
    v_mul_f32 v227, v227, v151
    buffer_load_dwordx4 v31, s[24:27], s55 offen offset:1024  lds
    v_exp_f32 v220, v220
    v_exp_f32 v221, v221
    v_exp_f32 v222, v222
    v_exp_f32 v223, v223
    v_exp_f32 v224, v224
    v_exp_f32 v225, v225
    v_exp_f32 v226, v226
    v_exp_f32 v227, v227
    v_fma_f32 v220, v220, v16, v16
    v_fma_f32 v221, v221, v16, v16
    v_fma_f32 v222, v222, v16, v16
    v_fma_f32 v223, v223, v16, v16
    v_fma_f32 v224, v224, v16, v16
    v_fma_f32 v225, v225, v16, v16
    v_fma_f32 v226, v226, v16, v16
    v_fma_f32 v227, v227, v16, v16
    s_add_u32 s55, s44, 5
    s_cmp_ge_u32 s55, 7
    s_cselect_b32 s56, 7, 0
    s_sub_u32 s55, s55, s56
    s_lshl_b32 s55, s55, 2
    s_add_u32 s55, s55, s46
    s_lshl_b32 s56, s55, 11
    s_add_u32 m0, s56, 49152
    s_mul_i32 s55, s55, 57344
    s_lshl_b32 s56, s45, 7
    s_add_u32 s55, s55, s56
    buffer_load_dwordx4 v30, s[24:27], s55 offen offset:0  lds
    v_rcp_f32 v220, v220
    v_rcp_f32 v221, v221
    v_rcp_f32 v222, v222
    v_rcp_f32 v223, v223
    v_rcp_f32 v224, v224
    v_rcp_f32 v225, v225
    v_rcp_f32 v226, v226
    v_rcp_f32 v227, v227
    v_mul_f32 v144, v220, v144
    v_mul_f32 v145, v221, v145
    v_mul_f32 v146, v222, v146
    v_mul_f32 v147, v223, v147
    v_mul_f32 v148, v224, v148
    v_mul_f32 v149, v225, v149
    v_mul_f32 v150, v226, v150
    v_mul_f32 v151, v227, v151
    buffer_load_dwordx4 v31, s[24:27], s55 offen offset:1024  lds
    v_mul_f32 v220, v152, v152
    v_mul_f32 v221, v153, v153
    v_mul_f32 v222, v154, v154
    v_mul_f32 v223, v155, v155
    v_mul_f32 v224, v156, v156
    v_mul_f32 v225, v157, v157
    v_mul_f32 v226, v158, v158
    v_mul_f32_e64 v227, v159, v159
    v_fma_f32 v220, v220, v15, v14
    v_fma_f32 v221, v221, v15, v14
    v_fma_f32 v222, v222, v15, v14
    v_fma_f32 v223, v223, v15, v14
    v_fma_f32 v224, v224, v15, v14
    v_fma_f32 v225, v225, v15, v14
    v_fma_f32 v226, v226, v15, v14
    v_fma_f32 v227, v227, v15, v14
    v_mul_f32 v220, v220, v152
    v_mul_f32 v221, v221, v153
    v_mul_f32 v222, v222, v154
    v_mul_f32 v223, v223, v155
    v_mul_f32 v224, v224, v156
    v_mul_f32 v225, v225, v157
    v_mul_f32 v226, v226, v158
    v_mul_f32_e64 v227, v227, v159
    s_add_u32 s55, s44, 6
    s_cmp_ge_u32 s55, 7
    s_cselect_b32 s56, 7, 0
    s_sub_u32 s55, s55, s56
    s_lshl_b32 s55, s55, 2
    s_add_u32 s55, s55, s46
    s_lshl_b32 s56, s55, 11
    s_add_u32 m0, s56, 49152
    s_mul_i32 s55, s55, 57344
    s_lshl_b32 s56, s45, 7
    s_add_u32 s55, s55, s56
    buffer_load_dwordx4 v30, s[24:27], s55 offen offset:0  lds
    v_exp_f32 v220, v220
    v_exp_f32 v221, v221
    v_exp_f32 v222, v222
    v_exp_f32 v223, v223
    v_exp_f32 v224, v224
    v_exp_f32 v225, v225
    v_exp_f32 v226, v226
    v_exp_f32 v227, v227
    v_fma_f32 v220, v220, v16, v16
    v_fma_f32 v221, v221, v16, v16
    v_fma_f32 v222, v222, v16, v16
    v_fma_f32 v223, v223, v16, v16
    v_fma_f32 v224, v224, v16, v16
    v_fma_f32 v225, v225, v16, v16
    v_fma_f32 v226, v226, v16, v16
    v_fma_f32 v227, v227, v16, v16
    buffer_load_dwordx4 v31, s[24:27], s55 offen offset:1024  lds
    v_rcp_f32 v220, v220
    v_rcp_f32 v221, v221
    v_rcp_f32 v222, v222
    v_rcp_f32 v223, v223
    v_rcp_f32 v224, v224
    v_rcp_f32 v225, v225
    v_rcp_f32 v226, v226
    v_rcp_f32 v227, v227
    v_mul_f32 v152, v220, v152
    v_mul_f32 v153, v221, v153
    v_mul_f32 v154, v222, v154
    v_mul_f32 v155, v223, v155
    v_mul_f32 v156, v224, v156
    v_mul_f32 v157, v225, v157
    v_mul_f32 v158, v226, v158
    v_mul_f32 v159, v227, v159
    v_mul_f32 v220, v160, v160
    v_mul_f32 v221, v161, v161
    v_mul_f32 v222, v162, v162
    v_mul_f32 v223, v163, v163
    v_mul_f32 v224, v164, v164
    v_mul_f32 v225, v165, v165
    v_mul_f32 v226, v166, v166
    v_mul_f32 v227, v167, v167
    v_fma_f32 v220, v220, v15, v14
    v_fma_f32 v221, v221, v15, v14
    v_fma_f32 v222, v222, v15, v14
    v_fma_f32 v223, v223, v15, v14
    v_fma_f32 v224, v224, v15, v14
    v_fma_f32 v225, v225, v15, v14
    v_fma_f32 v226, v226, v15, v14
    v_fma_f32 v227, v227, v15, v14
    v_mul_f32 v220, v220, v160
    v_mul_f32 v221, v221, v161
    v_mul_f32 v222, v222, v162
    v_mul_f32 v223, v223, v163
    v_mul_f32 v224, v224, v164
    v_mul_f32 v225, v225, v165
    v_mul_f32 v226, v226, v166
    v_mul_f32 v227, v227, v167
    v_exp_f32 v220, v220
    v_exp_f32 v221, v221
    v_exp_f32 v222, v222
    v_exp_f32 v223, v223
    v_exp_f32 v224, v224
    v_exp_f32 v225, v225
    v_exp_f32 v226, v226
    v_exp_f32 v227, v227
    v_fma_f32 v220, v220, v16, v16
    v_fma_f32 v221, v221, v16, v16
    v_fma_f32 v222, v222, v16, v16
    v_fma_f32 v223, v223, v16, v16
    v_fma_f32 v224, v224, v16, v16
    v_fma_f32 v225, v225, v16, v16
    v_fma_f32 v226, v226, v16, v16
    v_fma_f32 v227, v227, v16, v16
    v_rcp_f32 v220, v220
    v_rcp_f32 v221, v221
    v_rcp_f32 v222, v222
    v_rcp_f32 v223, v223
    v_rcp_f32 v224, v224
    v_rcp_f32 v225, v225
    v_rcp_f32 v226, v226
    v_rcp_f32 v227, v227
    v_mul_f32 v160, v220, v160
    v_mul_f32 v161, v221, v161
    v_mul_f32 v162, v222, v162
    v_mul_f32 v163, v223, v163
    v_mul_f32 v164, v224, v164
    v_mul_f32 v165, v225, v165
    v_mul_f32 v166, v226, v166
    v_mul_f32 v167, v227, v167
    v_mul_f32 v220, v168, v168
    v_mul_f32 v221, v169, v169
    v_mul_f32 v222, v170, v170
    v_mul_f32 v223, v171, v171
    v_mul_f32 v224, v172, v172
    v_mul_f32 v225, v173, v173
    v_mul_f32 v226, v174, v174
    v_mul_f32 v227, v175, v175
    v_fma_f32 v220, v220, v15, v14
    v_fma_f32 v221, v221, v15, v14
    v_fma_f32 v222, v222, v15, v14
    v_fma_f32 v223, v223, v15, v14
    v_fma_f32 v224, v224, v15, v14
    v_fma_f32 v225, v225, v15, v14
    v_fma_f32 v226, v226, v15, v14
    v_fma_f32 v227, v227, v15, v14
    v_mul_f32 v220, v220, v168
    v_mul_f32 v221, v221, v169
    v_mul_f32 v222, v222, v170
    v_mul_f32 v223, v223, v171
    v_mul_f32 v224, v224, v172
    v_mul_f32 v225, v225, v173
    v_mul_f32 v226, v226, v174
    v_mul_f32 v227, v227, v175
    v_exp_f32 v220, v220
    v_exp_f32 v221, v221
    v_exp_f32 v222, v222
    v_exp_f32 v223, v223
    v_exp_f32 v224, v224
    v_exp_f32 v225, v225
    v_exp_f32 v226, v226
    v_exp_f32 v227, v227
    v_fma_f32 v220, v220, v16, v16
    v_fma_f32 v221, v221, v16, v16
    v_fma_f32 v222, v222, v16, v16
    v_fma_f32 v223, v223, v16, v16
    v_fma_f32 v224, v224, v16, v16
    v_fma_f32 v225, v225, v16, v16
    v_fma_f32 v226, v226, v16, v16
    v_fma_f32 v227, v227, v16, v16
    v_rcp_f32 v220, v220
    v_rcp_f32 v221, v221
    v_rcp_f32 v222, v222
    v_rcp_f32 v223, v223
    v_rcp_f32 v224, v224
    v_rcp_f32 v225, v225
    v_rcp_f32 v226, v226
    v_rcp_f32 v227, v227
    v_mul_f32 v168, v220, v168
    v_mul_f32 v169, v221, v169
    v_mul_f32 v170, v222, v170
    v_mul_f32 v171, v223, v171
    v_mul_f32 v172, v224, v172
    v_mul_f32 v173, v225, v173
    v_mul_f32 v174, v226, v174
    v_mul_f32 v175, v227, v175
    s_waitcnt vmcnt(0) lgkmcnt(0)
    s_barrier
    ds_read_b64_tr_b16 v[192:193], v10 offset:0
    ds_read_b64_tr_b16 v[194:195], v10 offset:1024
    ds_read_b64_tr_b16 v[196:197], v10 offset:2048
    ds_read_b64_tr_b16 v[198:199], v10 offset:3072
    ds_read_b64_tr_b16 v[200:201], v10 offset:4096
    ds_read_b64_tr_b16 v[202:203], v10 offset:5120
    ds_read_b64_tr_b16 v[204:205], v10 offset:6144
    ds_read_b64_tr_b16 v[206:207], v10 offset:7168
    ds_read_b64_tr_b16 v[208:209], v10 offset:8192
    ds_read_b64_tr_b16 v[210:211], v10 offset:9216
    ds_read_b64_tr_b16 v[212:213], v10 offset:10240
    ds_read_b64_tr_b16 v[214:215], v10 offset:11264
    s_lshl_b32 s57, s45, 2
    s_sub_u32 s57, s48, s57
    s_waitcnt lgkmcnt(10)
    v_mfma_f32_32x32x16_bf16 v[176:191], v[192:195], v[32:35], 0
    ds_read_b64_tr_b16 v[216:217], v10 offset:12288
    ds_read_b64_tr_b16 v[218:219], v10 offset:13312
    s_add_u32 m0, s62, 20480
    s_add_u32 s55, s79, 0
    buffer_load_dwordx4 v4, s[28:31], s55 offen offset:0  lds
    s_waitcnt lgkmcnt(10)
    v_mfma_f32_32x32x16_bf16 v[176:191], v[196:199], v[36:39], v[176:191]
    ds_read_b64_tr_b16 v[192:193], v10 offset:14336
    ds_read_b64_tr_b16 v[194:195], v10 offset:15360
    s_waitcnt lgkmcnt(10)
    v_mfma_f32_32x32x16_bf16 v[176:191], v[200:203], v[40:43], v[176:191]
    ds_read_b64_tr_b16 v[196:197], v10 offset:16384
    ds_read_b64_tr_b16 v[198:199], v10 offset:17408
    buffer_load_dwordx4 v5, s[28:31], s55 offen offset:1024  lds
    s_waitcnt lgkmcnt(10)
    v_mfma_f32_32x32x16_bf16 v[176:191], v[204:207], v[44:47], v[176:191]
    ds_read_b64_tr_b16 v[200:201], v10 offset:18432
    ds_read_b64_tr_b16 v[202:203], v10 offset:19456
    s_waitcnt lgkmcnt(10)
    v_mfma_f32_32x32x16_bf16 v[176:191], v[208:211], v[48:51], v[176:191]
    ds_read_b64_tr_b16 v[204:205], v10 offset:20480
    ds_read_b64_tr_b16 v[206:207], v10 offset:21504
    buffer_load_dwordx4 v6, s[28:31], s55 offen offset:2048  lds
    s_waitcnt lgkmcnt(10)
    v_mfma_f32_32x32x16_bf16 v[176:191], v[212:215], v[52:55], v[176:191]
    ds_read_b64_tr_b16 v[208:209], v10 offset:22528
    ds_read_b64_tr_b16 v[210:211], v10 offset:23552
    s_waitcnt lgkmcnt(10)
    v_mfma_f32_32x32x16_bf16 v[176:191], v[216:219], v[56:59], v[176:191]
    ds_read_b64_tr_b16 v[212:213], v10 offset:24576
    ds_read_b64_tr_b16 v[214:215], v10 offset:25600
    buffer_load_dwordx4 v7, s[28:31], s55 offen offset:3072  lds
    s_waitcnt lgkmcnt(10)
    v_mfma_f32_32x32x16_bf16 v[176:191], v[192:195], v[60:63], v[176:191]
    ds_read_b64_tr_b16 v[216:217], v10 offset:26624
    ds_read_b64_tr_b16 v[218:219], v10 offset:27648
    s_waitcnt lgkmcnt(10)
    v_mfma_f32_32x32x16_bf16 v[176:191], v[196:199], v[64:67], v[176:191]
    ds_read_b64_tr_b16 v[192:193], v10 offset:28672
    ds_read_b64_tr_b16 v[194:195], v10 offset:29696
    s_add_u32 m0, s62, 24576
    s_add_u32 s55, s79, 458752
    buffer_load_dwordx4 v4, s[28:31], s55 offen offset:0  lds
    s_waitcnt lgkmcnt(10)
    v_mfma_f32_32x32x16_bf16 v[176:191], v[200:203], v[68:71], v[176:191]
    ds_read_b64_tr_b16 v[196:197], v10 offset:30720
    ds_read_b64_tr_b16 v[198:199], v10 offset:31744
    s_waitcnt lgkmcnt(10)
    v_mfma_f32_32x32x16_bf16 v[176:191], v[204:207], v[72:75], v[176:191]
    ds_read_b64_tr_b16 v[200:201], v10 offset:32768
    ds_read_b64_tr_b16 v[202:203], v10 offset:33792
    buffer_load_dwordx4 v5, s[28:31], s55 offen offset:1024  lds
    s_waitcnt lgkmcnt(10)
    v_mfma_f32_32x32x16_bf16 v[176:191], v[208:211], v[76:79], v[176:191]
    ds_read_b64_tr_b16 v[204:205], v10 offset:34816
    ds_read_b64_tr_b16 v[206:207], v10 offset:35840
    s_waitcnt lgkmcnt(10)
    v_mfma_f32_32x32x16_bf16 v[176:191], v[212:215], v[80:83], v[176:191]
    ds_read_b64_tr_b16 v[208:209], v10 offset:36864
    ds_read_b64_tr_b16 v[210:211], v10 offset:37888
    buffer_load_dwordx4 v6, s[28:31], s55 offen offset:2048  lds
    s_waitcnt lgkmcnt(10)
    v_mfma_f32_32x32x16_bf16 v[176:191], v[216:219], v[84:87], v[176:191]
    ds_read_b64_tr_b16 v[212:213], v10 offset:38912
    ds_read_b64_tr_b16 v[214:215], v10 offset:39936
    s_waitcnt lgkmcnt(10)
    v_mfma_f32_32x32x16_bf16 v[176:191], v[192:195], v[88:91], v[176:191]
    ds_read_b64_tr_b16 v[216:217], v10 offset:40960
    ds_read_b64_tr_b16 v[218:219], v10 offset:41984
    s_add_u32 m0, s62, 106496
    s_add_u32 s55, s79, 14336
    buffer_load_dwordx4 v4, s[28:31], s55 offen offset:0  lds
    s_waitcnt lgkmcnt(10)
    v_mfma_f32_32x32x16_bf16 v[176:191], v[196:199], v[92:95], v[176:191]
    ds_read_b64_tr_b16 v[192:193], v10 offset:43008
    ds_read_b64_tr_b16 v[194:195], v10 offset:44032
    s_waitcnt lgkmcnt(10)
    v_mfma_f32_32x32x16_bf16 v[176:191], v[200:203], v[96:99], v[176:191]
    ds_read_b64_tr_b16 v[196:197], v10 offset:45056
    ds_read_b64_tr_b16 v[198:199], v10 offset:46080
    buffer_load_dwordx4 v5, s[28:31], s55 offen offset:1024  lds
    s_waitcnt lgkmcnt(10)
    v_mfma_f32_32x32x16_bf16 v[176:191], v[204:207], v[100:103], v[176:191]
    ds_read_b64_tr_b16 v[200:201], v10 offset:47104
    ds_read_b64_tr_b16 v[202:203], v10 offset:48128
    s_waitcnt lgkmcnt(10)
    v_mfma_f32_32x32x16_bf16 v[176:191], v[208:211], v[104:107], v[176:191]
    ds_read_b64_tr_b16 v[204:205], v10 offset:49152
    ds_read_b64_tr_b16 v[206:207], v10 offset:50176
    buffer_load_dwordx4 v6, s[28:31], s55 offen offset:2048  lds
    s_waitcnt lgkmcnt(10)
    v_mfma_f32_32x32x16_bf16 v[176:191], v[212:215], v[108:111], v[176:191]
    ds_read_b64_tr_b16 v[208:209], v10 offset:51200
    ds_read_b64_tr_b16 v[210:211], v10 offset:52224
    s_waitcnt lgkmcnt(10)
    v_mfma_f32_32x32x16_bf16 v[176:191], v[216:219], v[112:115], v[176:191]
    ds_read_b64_tr_b16 v[212:213], v10 offset:53248
    ds_read_b64_tr_b16 v[214:215], v10 offset:54272
    buffer_load_dwordx4 v7, s[28:31], s55 offen offset:3072  lds
    s_waitcnt lgkmcnt(10)
    v_mfma_f32_32x32x16_bf16 v[176:191], v[192:195], v[116:119], v[176:191]
    ds_read_b64_tr_b16 v[216:217], v10 offset:55296
    ds_read_b64_tr_b16 v[218:219], v10 offset:56320
    s_waitcnt lgkmcnt(10)
    v_mfma_f32_32x32x16_bf16 v[176:191], v[196:199], v[120:123], v[176:191]
    ds_read_b64_tr_b16 v[192:193], v11 offset:0
    ds_read_b64_tr_b16 v[194:195], v11 offset:1024
    s_add_u32 m0, s62, 110592
    s_add_u32 s55, s79, 473088
    buffer_load_dwordx4 v4, s[28:31], s55 offen offset:0  lds
    s_waitcnt lgkmcnt(10)
    v_mfma_f32_32x32x16_bf16 v[176:191], v[200:203], v[124:127], v[176:191]
    ds_read_b64_tr_b16 v[196:197], v11 offset:2048
    ds_read_b64_tr_b16 v[198:199], v11 offset:3072
    s_waitcnt lgkmcnt(10)
    v_mfma_f32_32x32x16_bf16 v[176:191], v[204:207], v[128:131], v[176:191]
    ds_read_b64_tr_b16 v[200:201], v11 offset:4096
    ds_read_b64_tr_b16 v[202:203], v11 offset:5120
    buffer_load_dwordx4 v5, s[28:31], s55 offen offset:1024  lds
    s_waitcnt lgkmcnt(10)
    v_mfma_f32_32x32x16_bf16 v[176:191], v[208:211], v[132:135], v[176:191]
    ds_read_b64_tr_b16 v[204:205], v11 offset:6144
    ds_read_b64_tr_b16 v[206:207], v11 offset:7168
    s_waitcnt lgkmcnt(10)
    v_mfma_f32_32x32x16_bf16 v[176:191], v[212:215], v[136:139], v[176:191]
    ds_read_b64_tr_b16 v[208:209], v11 offset:8192
    ds_read_b64_tr_b16 v[210:211], v11 offset:9216
    buffer_load_dwordx4 v6, s[28:31], s55 offen offset:2048  lds
    s_waitcnt lgkmcnt(10)
    v_mfma_f32_32x32x16_bf16 v[176:191], v[216:219], v[140:143], v[176:191]
    ds_read_b64_tr_b16 v[212:213], v11 offset:10240
    ds_read_b64_tr_b16 v[214:215], v11 offset:11264
    s_waitcnt lgkmcnt(10)
    v_mfma_f32_32x32x16_bf16 v[240:255], v[192:195], v[32:35], 0
    ds_read_b64_tr_b16 v[216:217], v11 offset:12288
    ds_read_b64_tr_b16 v[218:219], v11 offset:13312
    s_waitcnt lgkmcnt(10)
    v_mfma_f32_32x32x16_bf16 v[240:255], v[196:199], v[36:39], v[240:255]
    ds_read_b64_tr_b16 v[192:193], v11 offset:14336
    ds_read_b64_tr_b16 v[194:195], v11 offset:15360
    s_mov_b64 exec, 0xfffffff
    buffer_load_dword v23, v21, s[40:43], s57 offen sc1
    s_mov_b64 exec, -1
    s_waitcnt lgkmcnt(10)
    v_mfma_f32_32x32x16_bf16 v[240:255], v[200:203], v[40:43], v[240:255]
    ds_read_b64_tr_b16 v[196:197], v11 offset:16384
    ds_read_b64_tr_b16 v[198:199], v11 offset:17408
    v_mul_f32 v176, v144, v176
    v_mul_f32 v177, v145, v177
    s_waitcnt lgkmcnt(10)
    v_mfma_f32_32x32x16_bf16 v[240:255], v[204:207], v[44:47], v[240:255]
    ds_read_b64_tr_b16 v[200:201], v11 offset:18432
    ds_read_b64_tr_b16 v[202:203], v11 offset:19456
    v_mul_f32 v178, v146, v178
    v_mul_f32_e64 v179, v147, v179
    s_waitcnt lgkmcnt(10)
    v_mfma_f32_32x32x16_bf16 v[240:255], v[208:211], v[48:51], v[240:255]
    ds_read_b64_tr_b16 v[204:205], v11 offset:20480
    ds_read_b64_tr_b16 v[206:207], v11 offset:21504
    v_mul_f32 v180, v148, v180
    v_mul_f32_e64 v181, v149, v181
    s_waitcnt lgkmcnt(10)
    v_mfma_f32_32x32x16_bf16 v[240:255], v[212:215], v[52:55], v[240:255]
    ds_read_b64_tr_b16 v[208:209], v11 offset:22528
    ds_read_b64_tr_b16 v[210:211], v11 offset:23552
    v_mul_f32 v182, v150, v182
    v_mul_f32_e64 v183, v151, v183
    s_waitcnt lgkmcnt(10)
    v_mfma_f32_32x32x16_bf16 v[240:255], v[216:219], v[56:59], v[240:255]
    ds_read_b64_tr_b16 v[212:213], v11 offset:24576
    ds_read_b64_tr_b16 v[214:215], v11 offset:25600
    v_cvt_pk_bf16_f32 v176, v176, v177
    v_cvt_pk_bf16_f32 v177, v178, v179
    s_waitcnt lgkmcnt(10)
    v_mfma_f32_32x32x16_bf16 v[240:255], v[192:195], v[60:63], v[240:255]
    ds_read_b64_tr_b16 v[216:217], v11 offset:26624
    ds_read_b64_tr_b16 v[218:219], v11 offset:27648
    v_cvt_pk_bf16_f32 v178, v180, v181
    v_cvt_pk_bf16_f32 v179, v182, v183
    s_waitcnt lgkmcnt(10)
    v_mfma_f32_32x32x16_bf16 v[240:255], v[196:199], v[64:67], v[240:255]
    ds_read_b64_tr_b16 v[192:193], v11 offset:28672
    ds_read_b64_tr_b16 v[194:195], v11 offset:29696
    s_add_u32 s53, s78, 0
    s_cmp_eq_u32 s51, 0
    s_cbranch_scc1 L_slow_63
    buffer_store_dwordx4 v[176:179], v2, s[40:43], s53 offen
L_pubd_64:
    s_waitcnt lgkmcnt(10)
    v_mfma_f32_32x32x16_bf16 v[240:255], v[200:203], v[68:71], v[240:255]
    ds_read_b64_tr_b16 v[196:197], v11 offset:30720
    ds_read_b64_tr_b16 v[198:199], v11 offset:31744
    v_mul_f32 v184, v152, v184
    v_mul_f32_e64 v185, v153, v185
    s_waitcnt lgkmcnt(10)
    v_mfma_f32_32x32x16_bf16 v[240:255], v[204:207], v[72:75], v[240:255]
    ds_read_b64_tr_b16 v[200:201], v11 offset:32768
    ds_read_b64_tr_b16 v[202:203], v11 offset:33792
    v_mul_f32 v186, v154, v186
    v_mul_f32_e64 v187, v155, v187
    s_waitcnt lgkmcnt(10)
    v_mfma_f32_32x32x16_bf16 v[240:255], v[208:211], v[76:79], v[240:255]
    ds_read_b64_tr_b16 v[204:205], v11 offset:34816
    s_branch L_pg5_skip
    .p2align 12
L_pg5:
    s_branch L_visit1_back
    s_nop 0
L_pg5_skip:
    ds_read_b64_tr_b16 v[206:207], v11 offset:35840
    v_mul_f32 v188, v156, v188
    v_mul_f32_e64 v189, v157, v189
    s_waitcnt lgkmcnt(10)
    v_mfma_f32_32x32x16_bf16 v[240:255], v[212:215], v[80:83], v[240:255]
    ds_read_b64_tr_b16 v[208:209], v11 offset:36864
    ds_read_b64_tr_b16 v[210:211], v11 offset:37888
    v_mul_f32 v190, v158, v190
    v_mul_f32_e64 v191, v159, v191
    s_waitcnt lgkmcnt(10)
    v_mfma_f32_32x32x16_bf16 v[240:255], v[216:219], v[84:87], v[240:255]
    ds_read_b64_tr_b16 v[212:213], v11 offset:38912
    ds_read_b64_tr_b16 v[214:215], v11 offset:39936
    v_cvt_pk_bf16_f32 v184, v184, v185
    v_cvt_pk_bf16_f32 v185, v186, v187
    s_waitcnt lgkmcnt(10)
    v_mfma_f32_32x32x16_bf16 v[240:255], v[192:195], v[88:91], v[240:255]
    ds_read_b64_tr_b16 v[216:217], v11 offset:40960
    ds_read_b64_tr_b16 v[218:219], v11 offset:41984
    v_cvt_pk_bf16_f32 v186, v188, v189
    v_cvt_pk_bf16_f32 v187, v190, v191
    s_waitcnt lgkmcnt(10)
    v_mfma_f32_32x32x16_bf16 v[240:255], v[196:199], v[92:95], v[240:255]
    ds_read_b64_tr_b16 v[192:193], v11 offset:43008
    ds_read_b64_tr_b16 v[194:195], v11 offset:44032
    s_add_u32 s53, s78, 14336
    s_cmp_eq_u32 s51, 0
    s_cbranch_scc1 L_slow_65
    buffer_store_dwordx4 v[184:187], v2, s[40:43], s53 offen
L_pubd_66:
    s_waitcnt lgkmcnt(10)
    v_mfma_f32_32x32x16_bf16 v[240:255], v[200:203], v[96:99], v[240:255]
    ds_read_b64_tr_b16 v[196:197], v11 offset:45056
    ds_read_b64_tr_b16 v[198:199], v11 offset:46080
    s_waitcnt lgkmcnt(10)
    v_mfma_f32_32x32x16_bf16 v[240:255], v[204:207], v[100:103], v[240:255]
    ds_read_b64_tr_b16 v[200:201], v11 offset:47104
    ds_read_b64_tr_b16 v[202:203], v11 offset:48128
    s_waitcnt lgkmcnt(10)
    v_mfma_f32_32x32x16_bf16 v[240:255], v[208:211], v[104:107], v[240:255]
    ds_read_b64_tr_b16 v[204:205], v11 offset:49152
    ds_read_b64_tr_b16 v[206:207], v11 offset:50176
    s_waitcnt lgkmcnt(10)
    v_mfma_f32_32x32x16_bf16 v[240:255], v[212:215], v[108:111], v[240:255]
    ds_read_b64_tr_b16 v[208:209], v11 offset:51200
    ds_read_b64_tr_b16 v[210:211], v11 offset:52224
    s_waitcnt lgkmcnt(10)
    v_mfma_f32_32x32x16_bf16 v[240:255], v[216:219], v[112:115], v[240:255]
    ds_read_b64_tr_b16 v[212:213], v11 offset:53248
    ds_read_b64_tr_b16 v[214:215], v11 offset:54272
    s_waitcnt lgkmcnt(10)
    v_mfma_f32_32x32x16_bf16 v[240:255], v[192:195], v[116:119], v[240:255]
    ds_read_b64_tr_b16 v[216:217], v11 offset:55296
    ds_read_b64_tr_b16 v[218:219], v11 offset:56320
    s_waitcnt lgkmcnt(10)
    v_mfma_f32_32x32x16_bf16 v[240:255], v[196:199], v[120:123], v[240:255]
    s_waitcnt lgkmcnt(8)
    v_mfma_f32_32x32x16_bf16 v[240:255], v[200:203], v[124:127], v[240:255]
    s_waitcnt lgkmcnt(6)
    v_mfma_f32_32x32x16_bf16 v[240:255], v[204:207], v[128:131], v[240:255]
    s_waitcnt lgkmcnt(4)
    v_mfma_f32_32x32x16_bf16 v[240:255], v[208:211], v[132:135], v[240:255]
    v_mov_b32 v3, 2
    s_waitcnt vmcnt(0)
    s_mov_b64 exec, 1
    s_cmp_eq_u32 s51, 0
    s_cbranch_scc1 L_slow_67
    buffer_store_dword v3, v21, s[40:43], s48 offen
L_pubd_68:
    s_mov_b64 exec, -1
    s_waitcnt lgkmcnt(2)
    v_mfma_f32_32x32x16_bf16 v[240:255], v[212:215], v[136:139], v[240:255]
    s_waitcnt lgkmcnt(0)
    v_mfma_f32_32x32x16_bf16 v[240:255], v[216:219], v[140:143], v[240:255]
    s_setprio 0
    s_mov_b64 exec, 0xfffffff
    v_cmp_eq_u32 vcc, 0, v23
    s_cbranch_vccz L_ok_70
L_poll_71:
    buffer_load_dword v23, v21, s[40:43], s57 offen sc1
    s_add_u32 s52, s52, 1
    s_waitcnt vmcnt(0)
    v_cmp_eq_u32 vcc, 0, v23
    s_cmp_gt_u32 s52, 4194304
    s_cbranch_scc1 L_polled_72
    s_cbranch_vccnz L_poll_71
L_polled_72:
L_ok_70:
    s_mov_b64 exec, -1
    s_nop 6
    v_mul_f32 v240, v160, v240
    v_mul_f32 v241, v161, v241
    v_mul_f32 v242, v162, v242
    v_mul_f32 v243, v163, v243
    v_mul_f32 v244, v164, v244
    v_mul_f32 v245, v165, v245
    v_mul_f32 v246, v166, v246
    v_mul_f32 v247, v167, v247
    v_cvt_pk_bf16_f32 v240, v240, v241
    v_cvt_pk_bf16_f32 v241, v242, v243
    v_cvt_pk_bf16_f32 v242, v244, v245
    v_cvt_pk_bf16_f32 v243, v246, v247
    s_add_u32 s53, s69, 0
    s_cmp_eq_u32 s51, 0
    s_cbranch_scc1 L_slow_73
    buffer_store_dwordx4 v[240:243], v2, s[40:43], s53 offen
L_pubd_74:
    v_mul_f32 v248, v168, v248
    v_mul_f32 v249, v169, v249
    v_mul_f32 v250, v170, v250
    v_mul_f32 v251, v171, v251
    v_mul_f32 v252, v172, v252
    v_mul_f32 v253, v173, v253
    v_mul_f32 v254, v174, v254
    v_mul_f32_e64 v255, v175, v255
    v_cvt_pk_bf16_f32 v248, v248, v249
    v_cvt_pk_bf16_f32 v249, v250, v251
    v_cvt_pk_bf16_f32 v250, v252, v253
    v_cvt_pk_bf16_f32 v251, v254, v255
    s_add_u32 s53, s69, 14336
    s_cmp_eq_u32 s51, 0
    s_cbranch_scc1 L_slow_75
    buffer_store_dwordx4 v[248:251], v2, s[40:43], s53 offen
L_pubd_76:
    s_mov_b64 exec, 0x7f
    buffer_load_dword v23, v22, s[40:43], s49 offen sc1
    s_mov_b64 exec, -1
    v_mov_b32 v3, 3
    s_waitcnt vmcnt(1)
    s_mov_b64 exec, 1
    s_cmp_eq_u32 s51, 0
    s_cbranch_scc1 L_slow_77
    buffer_store_dword v3, v21, s[40:43], s48 offen
L_pubd_78:
    s_mov_b64 exec, -1
    s_waitcnt vmcnt(1)
    s_mov_b64 exec, 0x7f
    v_cmp_gt_u32 vcc, 2, v23
    s_cbranch_vccz L_ok_80
L_poll_81:
    buffer_load_dword v23, v22, s[40:43], s49 offen sc1
    s_add_u32 s52, s52, 1
    s_waitcnt vmcnt(0)
    v_cmp_gt_u32 vcc, 2, v23
    s_cmp_gt_u32 s52, 4194304
    s_cbranch_scc1 L_polled_82
    s_cbranch_vccnz L_poll_81
L_polled_82:
L_ok_80:
    s_mov_b64 exec, -1
    s_mul_i32 s54, s59, 32768
    s_mul_i32 s53, s74, 7168
    s_add_u32 s54, s54, s53
    s_add_u32 s54, s54, 4194304
    buffer_load_dwordx4 v[32:35], v2, s[40:43], s54 offen offset:0 sc1
    buffer_load_dwordx4 v[36:39], v2, s[40:43], s54 offen offset:1024 sc1
    buffer_load_dwordx4 v[40:43], v2, s[40:43], s54 offen offset:2048 sc1
    buffer_load_dwordx4 v[44:47], v2, s[40:43], s54 offen offset:3072 sc1
    s_add_u32 s54, s54, 4096
    buffer_load_dwordx4 v[48:51], v2, s[40:43], s54 offen offset:0 sc1
    buffer_load_dwordx4 v[52:55], v2, s[40:43], s54 offen offset:1024 sc1
    buffer_load_dwordx4 v[56:59], v2, s[40:43], s54 offen offset:2048 sc1
    s_mul_i32 s54, s59, 32768
    s_mul_i32 s53, s74, 7168
    s_add_u32 s54, s54, s53
    s_add_u32 s54, s54, 4208640
    buffer_load_dwordx4 v[60:63], v2, s[40:43], s54 offen offset:0 sc1
    buffer_load_dwordx4 v[64:67], v2, s[40:43], s54 offen offset:1024 sc1
    buffer_load_dwordx4 v[68:71], v2, s[40:43], s54 offen offset:2048 sc1
    buffer_load_dwordx4 v[72:75], v2, s[40:43], s54 offen offset:3072 sc1
    s_add_u32 s54, s54, 4096
    buffer_load_dwordx4 v[76:79], v2, s[40:43], s54 offen offset:0 sc1
    buffer_load_dwordx4 v[80:83], v2, s[40:43], s54 offen offset:1024 sc1
    buffer_load_dwordx4 v[84:87], v2, s[40:43], s54 offen offset:2048 sc1
    s_mov_b64 exec, 0x7f
    buffer_load_dword v23, v22, s[40:43], s49 offen sc1
    s_mov_b64 exec, -1
    s_lshl_b32 s53, s46, 12
    v_add_u32_e64 v26, s53, v2
    v_xor_b32 v27, 8192, v26
    v_add_u32 v26, 77824, v26
    v_add_u32 v27, 77824, v27
    v_add_u32 v29, 13312, v2
    v_mov_b32 v3, 1
    s_add_u32 s57, s45, 14
    s_cmp_ge_u32 s57, 28
    s_cselect_b32 s58, 28, 0
    s_sub_u32 s57, s57, s58
    s_mul_i32 s56, s72, 7
    s_lshl_b32 s53, s46, 2
    s_add_u32 s53, s53, s77
    s_add_u32 s53, s53, 3072
    s_lshl_b32 s58, s45, 4
    s_add_u32 s58, s58, s53
    s_lshl_b32 s57, s57, 4
    s_add_u32 s57, s57, s53
    s_lshl_b32 s56, s56, 4
    s_add_u32 s56, s56, s53
    s_barrier
    s_setprio 2
    s_lshl_b32 s53, s74, 3
    s_add_u32 s53, s53, 17424
    v_mov_b32 v222, s53
    v_add_u32 v18, 20480, v12
    v_add_u32 v19, 20480, v13
    ds_read_b64_tr_b16 v[192:193], v18 offset:0
    ds_read_b64_tr_b16 v[194:195], v18 offset:7168
    ds_read_b64_tr_b16 v[196:197], v19 offset:0
    ds_read_b64_tr_b16 v[198:199], v19 offset:7168
    ds_read_b64_tr_b16 v[200:201], v18 offset:1024
    ds_read_b64_tr_b16 v[202:203], v18 offset:8192
    ds_read_b64_tr_b16 v[204:205], v19 offset:1024
    ds_read_b64_tr_b16 v[206:207], v19 offset:8192
    ds_read_b64_tr_b16 v[208:209], v18 offset:2048
    ds_read_b64_tr_b16 v[210:211], v18 offset:9216
    ds_read_b64_tr_b16 v[212:213], v19 offset:2048
    ds_read_b64_tr_b16 v[214:215], v19 offset:9216
    s_waitcnt vmcnt(14) lgkmcnt(10)
    v_mfma_f32_32x32x16_bf16 v[144:159], v[192:195], v[32:35], 0
    ds_read_b64_tr_b16 v[216:217], v18 offset:3072
    ds_read_b64_tr_b16 v[218:219], v18 offset:10240
    s_waitcnt lgkmcnt(10)
    v_mfma_f32_32x32x16_bf16 v[160:175], v[196:199], v[32:35], 0
    ds_read_b64_tr_b16 v[192:193], v19 offset:3072
    ds_read_b64_tr_b16 v[194:195], v19 offset:10240
    s_waitcnt vmcnt(13) lgkmcnt(10)
    v_mfma_f32_32x32x16_bf16 v[144:159], v[200:203], v[36:39], v[144:159]
    ds_read_b64_tr_b16 v[196:197], v18 offset:4096
    ds_read_b64_tr_b16 v[198:199], v18 offset:11264
    s_waitcnt vmcnt(0)
    s_mov_b64 exec, 0x7f
    v_cmp_gt_u32 vcc, 3, v23
    s_cbranch_vccz L_ok_84
L_poll_85:
    buffer_load_dword v23, v22, s[40:43], s49 offen sc1
    s_add_u32 s52, s52, 1
    s_waitcnt vmcnt(0)
    v_cmp_gt_u32 vcc, 3, v23
    s_cmp_gt_u32 s52, 4194304
    s_cbranch_scc1 L_polled_86
    s_cbranch_vccnz L_poll_85
L_polled_86:
L_ok_84:
    s_mov_b64 exec, -1
    s_mul_i32 s54, s59, 28672
    s_mul_i32 s53, s74, 7168
    s_add_u32 s54, s54, s53
    s_add_u32 s54, s54, 6291456
    buffer_load_dwordx4 v[88:91], v2, s[40:43], s54 offen offset:0 sc1
    s_waitcnt lgkmcnt(10)
    v_mfma_f32_32x32x16_bf16 v[160:175], v[204:207], v[36:39], v[160:175]
    ds_read_b64_tr_b16 v[200:201], v19 offset:4096
    ds_read_b64_tr_b16 v[202:203], v19 offset:11264
    buffer_load_dwordx4 v[92:95], v2, s[40:43], s54 offen offset:1024 sc1
    s_waitcnt lgkmcnt(10)
    v_mfma_f32_32x32x16_bf16 v[144:159], v[208:211], v[40:43], v[144:159]
    ds_read_b64_tr_b16 v[204:205], v18 offset:5120
    ds_read_b64_tr_b16 v[206:207], v18 offset:12288
    buffer_load_dwordx4 v[96:99], v2, s[40:43], s54 offen offset:2048 sc1
    s_waitcnt lgkmcnt(10)
    v_mfma_f32_32x32x16_bf16 v[160:175], v[212:215], v[40:43], v[160:175]
    ds_read_b64_tr_b16 v[208:209], v19 offset:5120
    ds_read_b64_tr_b16 v[210:211], v19 offset:12288
    buffer_load_dwordx4 v[100:103], v2, s[40:43], s54 offen offset:3072 sc1
    s_add_u32 s54, s54, 4096
    s_waitcnt lgkmcnt(10)
    v_mfma_f32_32x32x16_bf16 v[144:159], v[216:219], v[44:47], v[144:159]
    ds_read_b64_tr_b16 v[212:213], v18 offset:6144
    ds_read_b64_tr_b16 v[214:215], v18 offset:13312
    buffer_load_dwordx4 v[104:107], v2, s[40:43], s54 offen offset:0 sc1
    s_waitcnt lgkmcnt(10)
    v_mfma_f32_32x32x16_bf16 v[160:175], v[192:195], v[44:47], v[160:175]
    ds_read_b64_tr_b16 v[216:217], v19 offset:6144
    ds_read_b64_tr_b16 v[218:219], v19 offset:13312
    buffer_load_dwordx4 v[108:111], v2, s[40:43], s54 offen offset:1024 sc1
    s_waitcnt lgkmcnt(10)
    v_mfma_f32_32x32x16_bf16 v[144:159], v[196:199], v[48:51], v[144:159]
    v_add_u32 v18, 106496, v12
    v_add_u32 v19, 106496, v13
    ds_read_b64_tr_b16 v[192:193], v18 offset:0
    ds_read_b64_tr_b16 v[194:195], v18 offset:7168
    buffer_load_dwordx4 v[112:115], v2, s[40:43], s54 offen offset:2048 sc1
    s_waitcnt lgkmcnt(10)
    v_mfma_f32_32x32x16_bf16 v[160:175], v[200:203], v[48:51], v[160:175]
    ds_read_b64_tr_b16 v[196:197], v19 offset:0
    ds_read_b64_tr_b16 v[198:199], v19 offset:7168
    s_add_u32 m0, s62, 49152
    s_add_u32 s55, s79, 43008
    buffer_load_dwordx4 v4, s[28:31], s55 offen offset:0  lds
    s_waitcnt lgkmcnt(10)
    v_mfma_f32_32x32x16_bf16 v[144:159], v[204:207], v[52:55], v[144:159]
    ds_read_b64_tr_b16 v[200:201], v18 offset:1024
    ds_read_b64_tr_b16 v[202:203], v18 offset:8192
    buffer_load_dwordx4 v5, s[28:31], s55 offen offset:1024  lds
    s_waitcnt lgkmcnt(10)
    v_mfma_f32_32x32x16_bf16 v[160:175], v[208:211], v[52:55], v[160:175]
    ds_read_b64_tr_b16 v[204:205], v19 offset:1024
    ds_read_b64_tr_b16 v[206:207], v19 offset:8192
    buffer_load_dwordx4 v6, s[28:31], s55 offen offset:2048  lds
    s_waitcnt lgkmcnt(10)
    v_mfma_f32_32x32x16_bf16 v[144:159], v[212:215], v[56:59], v[144:159]
    ds_read_b64_tr_b16 v[208:209], v18 offset:2048
    ds_read_b64_tr_b16 v[210:211], v18 offset:9216
    buffer_load_dwordx4 v7, s[28:31], s55 offen offset:3072  lds
    s_waitcnt lgkmcnt(10)
    v_mfma_f32_32x32x16_bf16 v[160:175], v[216:219], v[56:59], v[160:175]
    ds_read_b64_tr_b16 v[212:213], v19 offset:2048
    ds_read_b64_tr_b16 v[214:215], v19 offset:9216
    s_add_u32 m0, s62, 53248
    s_add_u32 s55, s79, 501760
    buffer_load_dwordx4 v4, s[28:31], s55 offen offset:0  lds
    s_waitcnt lgkmcnt(10)
    v_mfma_f32_32x32x16_bf16 v[144:159], v[192:195], v[60:63], v[144:159]
    ds_read_b64_tr_b16 v[216:217], v18 offset:3072
    ds_read_b64_tr_b16 v[218:219], v18 offset:10240
    buffer_load_dwordx4 v5, s[28:31], s55 offen offset:1024  lds
    s_waitcnt lgkmcnt(10)
    v_mfma_f32_32x32x16_bf16 v[160:175], v[196:199], v[60:63], v[160:175]
    ds_read_b64_tr_b16 v[192:193], v19 offset:3072
    ds_read_b64_tr_b16 v[194:195], v19 offset:10240
    buffer_load_dwordx4 v6, s[28:31], s55 offen offset:2048  lds
    s_waitcnt lgkmcnt(10)
    v_mfma_f32_32x32x16_bf16 v[144:159], v[200:203], v[64:67], v[144:159]
    ds_read_b64_tr_b16 v[196:197], v18 offset:4096
    ds_read_b64_tr_b16 v[198:199], v18 offset:11264
    s_mul_i32 s54, s59, 28672
    s_mul_i32 s53, s74, 7168
    s_add_u32 s54, s54, s53
    s_add_u32 s54, s54, 6305792
    buffer_load_dwordx4 v[116:119], v2, s[40:43], s54 offen offset:0 sc1
    s_waitcnt lgkmcnt(10)
    v_mfma_f32_32x32x16_bf16 v[160:175], v[204:207], v[64:67], v[160:175]
    ds_read_b64_tr_b16 v[200:201], v19 offset:4096
    ds_read_b64_tr_b16 v[202:203], v19 offset:11264
    buffer_load_dwordx4 v[120:123], v2, s[40:43], s54 offen offset:1024 sc1
    s_waitcnt lgkmcnt(10)
    v_mfma_f32_32x32x16_bf16 v[144:159], v[208:211], v[68:71], v[144:159]
    ds_read_b64_tr_b16 v[204:205], v18 offset:5120
    ds_read_b64_tr_b16 v[206:207], v18 offset:12288
    buffer_load_dwordx4 v[124:127], v2, s[40:43], s54 offen offset:2048 sc1
    s_waitcnt lgkmcnt(10)
    v_mfma_f32_32x32x16_bf16 v[160:175], v[212:215], v[68:71], v[160:175]
    ds_read_b64_tr_b16 v[208:209], v19 offset:5120
    ds_read_b64_tr_b16 v[210:211], v19 offset:12288
    buffer_load_dwordx4 v[128:131], v2, s[40:43], s54 offen offset:3072 sc1
    s_add_u32 s54, s54, 4096
    s_waitcnt lgkmcnt(10)
    v_mfma_f32_32x32x16_bf16 v[144:159], v[216:219], v[72:75], v[144:159]
    ds_read_b64_tr_b16 v[212:213], v18 offset:6144
    ds_read_b64_tr_b16 v[214:215], v18 offset:13312
    buffer_load_dwordx4 v[132:135], v2, s[40:43], s54 offen offset:0 sc1
    s_waitcnt lgkmcnt(10)
    v_mfma_f32_32x32x16_bf16 v[160:175], v[192:195], v[72:75], v[160:175]
    ds_read_b64_tr_b16 v[216:217], v19 offset:6144
    ds_read_b64_tr_b16 v[218:219], v19 offset:13312
    buffer_load_dwordx4 v[136:139], v2, s[40:43], s54 offen offset:1024 sc1
    s_waitcnt lgkmcnt(10)
    v_mfma_f32_32x32x16_bf16 v[144:159], v[196:199], v[76:79], v[144:159]
    v_add_u32 v18, 135168, v12
    v_add_u32 v19, 135168, v13
    ds_read_b64_tr_b16 v[192:193], v18 offset:0
    ds_read_b64_tr_b16 v[194:195], v18 offset:7168
    buffer_load_dwordx4 v[140:143], v2, s[40:43], s54 offen offset:2048 sc1
    s_waitcnt lgkmcnt(10)
    v_mfma_f32_32x32x16_bf16 v[160:175], v[200:203], v[76:79], v[160:175]
    ds_read_b64_tr_b16 v[196:197], v19 offset:0
    ds_read_b64_tr_b16 v[198:199], v19 offset:7168
    s_waitcnt lgkmcnt(10)
    v_mfma_f32_32x32x16_bf16 v[144:159], v[204:207], v[80:83], v[144:159]
    ds_read_b64_tr_b16 v[200:201], v18 offset:1024
    ds_read_b64_tr_b16 v[202:203], v18 offset:8192
    s_waitcnt lgkmcnt(10)
    v_mfma_f32_32x32x16_bf16 v[160:175], v[208:211], v[80:83], v[160:175]
    ds_read_b64_tr_b16 v[204:205], v19 offset:1024
    ds_read_b64_tr_b16 v[206:207], v19 offset:8192
    s_waitcnt lgkmcnt(10)
    v_mfma_f32_32x32x16_bf16 v[144:159], v[212:215], v[84:87], v[144:159]
    ds_read_b64_tr_b16 v[208:209], v18 offset:2048
    ds_read_b64_tr_b16 v[210:211], v18 offset:9216
    s_waitcnt lgkmcnt(10)
    v_mfma_f32_32x32x16_bf16 v[160:175], v[216:219], v[84:87], v[160:175]
    ds_read_b64_tr_b16 v[212:213], v19 offset:2048
    ds_read_b64_tr_b16 v[214:215], v19 offset:9216
    s_mov_b64 exec, 1
    s_cmp_eq_u32 s51, 0
    s_cbranch_scc1 L_slow_87
    buffer_store_dword v3, v21, s[40:43], s58 offen
L_pubd_88:
    s_mov_b64 exec, -1
    s_waitcnt vmcnt(21) lgkmcnt(10)
    v_mfma_f32_32x32x16_bf16 v[144:159], v[192:195], v[88:91], v[144:159]
    ds_read_b64_tr_b16 v[216:217], v18 offset:3072
    ds_read_b64_tr_b16 v[218:219], v18 offset:10240
    s_waitcnt vmcnt(8)
    ds_write_b32 v17, v3 offset:16
    s_waitcnt lgkmcnt(11)
    v_mfma_f32_32x32x16_bf16 v[160:175], v[196:199], v[88:91], v[160:175]
    ds_read_b64_tr_b16 v[192:193], v19 offset:3072
    ds_read_b64_tr_b16 v[194:195], v19 offset:10240
    s_waitcnt lgkmcnt(11)
    v_mfma_f32_32x32x16_bf16 v[144:159], v[200:203], v[92:95], v[144:159]
    ds_read_b64_tr_b16 v[196:197], v18 offset:4096
    ds_read_b64_tr_b16 v[198:199], v18 offset:11264
    s_waitcnt lgkmcnt(11)
    v_mfma_f32_32x32x16_bf16 v[160:175], v[204:207], v[92:95], v[160:175]
    ds_read_b64_tr_b16 v[200:201], v19 offset:4096
    ds_read_b64_tr_b16 v[202:203], v19 offset:11264
    s_waitcnt lgkmcnt(11)
    v_mfma_f32_32x32x16_bf16 v[144:159], v[208:211], v[96:99], v[144:159]
    ds_read_b64_tr_b16 v[204:205], v18 offset:5120
    ds_read_b64_tr_b16 v[206:207], v18 offset:12288
    s_waitcnt lgkmcnt(11)
    v_mfma_f32_32x32x16_bf16 v[160:175], v[212:215], v[96:99], v[160:175]
    ds_read_b64 v[220:221], v222
    ds_read_b64_tr_b16 v[208:209], v19 offset:5120
    ds_read_b64_tr_b16 v[210:211], v19 offset:12288
    s_waitcnt lgkmcnt(12)
    v_mfma_f32_32x32x16_bf16 v[144:159], v[216:219], v[100:103], v[144:159]
    ds_read_b64_tr_b16 v[212:213], v18 offset:6144
    ds_read_b64_tr_b16 v[214:215], v18 offset:13312
    s_waitcnt lgkmcnt(11)
    v_mfma_f32_32x32x16_bf16 v[160:175], v[192:195], v[100:103], v[160:175]
    ds_read_b64_tr_b16 v[216:217], v19 offset:6144
    ds_read_b64_tr_b16 v[218:219], v19 offset:13312
    s_waitcnt lgkmcnt(11)
    v_mfma_f32_32x32x16_bf16 v[144:159], v[196:199], v[104:107], v[144:159]
    s_waitcnt lgkmcnt(6)
    v_and_b32 v220, v220, v221
    v_cmp_ne_u32 vcc, 1, v220
    s_cbranch_vccz L_qok_89
L_qspin_90:
    ds_read_b64 v[220:221], v222
    s_add_u32 s52, s52, 1
    s_waitcnt lgkmcnt(0)
    v_and_b32 v220, v220, v221
    v_cmp_ne_u32 vcc, 1, v220
    s_cmp_gt_u32 s52, 4194304
    s_cbranch_scc1 L_qok_89
    s_cbranch_vccnz L_qspin_90
L_qok_89:
    v_add_u32 v18, 49152, v12
    v_add_u32 v19, 49152, v13
    ds_read_b64_tr_b16 v[192:193], v19 offset:0
    ds_read_b64_tr_b16 v[194:195], v19 offset:7168
    v_mfma_f32_32x32x16_bf16 v[160:175], v[200:203], v[104:107], v[160:175]
    ds_read_b64_tr_b16 v[196:197], v19 offset:1024
    ds_read_b64_tr_b16 v[198:199], v19 offset:8192
    v_mfma_f32_32x32x16_bf16 v[144:159], v[204:207], v[108:111], v[144:159]
    ds_read_b64_tr_b16 v[200:201], v19 offset:2048
    ds_read_b64_tr_b16 v[202:203], v19 offset:9216
    s_waitcnt lgkmcnt(10)
    v_mfma_f32_32x32x16_bf16 v[160:175], v[208:211], v[108:111], v[160:175]
    ds_read_b64_tr_b16 v[204:205], v19 offset:3072
    ds_read_b64_tr_b16 v[206:207], v19 offset:10240
    s_waitcnt lgkmcnt(10)
    v_mfma_f32_32x32x16_bf16 v[144:159], v[212:215], v[112:115], v[144:159]
    ds_read_b64_tr_b16 v[208:209], v19 offset:4096
    ds_read_b64_tr_b16 v[210:211], v19 offset:11264
    s_waitcnt lgkmcnt(10)
    v_mfma_f32_32x32x16_bf16 v[160:175], v[216:219], v[112:115], v[160:175]
    ds_read_b64_tr_b16 v[212:213], v19 offset:5120
    ds_read_b64_tr_b16 v[214:215], v19 offset:12288
    s_waitcnt vmcnt(7) lgkmcnt(10)
    v_mfma_f32_32x32x16_bf16 v[160:175], v[192:195], v[116:119], v[160:175]
    ds_read_b64_tr_b16 v[216:217], v19 offset:6144
    ds_read_b64_tr_b16 v[218:219], v19 offset:13312
    s_waitcnt vmcnt(6) lgkmcnt(10)
    v_mfma_f32_32x32x16_bf16 v[160:175], v[196:199], v[120:123], v[160:175]
    ds_read_b64_tr_b16 v[192:193], v18 offset:0
    ds_read_b64_tr_b16 v[194:195], v18 offset:7168
    s_waitcnt vmcnt(5) lgkmcnt(10)
    v_mfma_f32_32x32x16_bf16 v[160:175], v[200:203], v[124:127], v[160:175]
    ds_read_b64_tr_b16 v[196:197], v18 offset:1024
    ds_read_b64_tr_b16 v[198:199], v18 offset:8192
    s_waitcnt vmcnt(4) lgkmcnt(10)
    v_mfma_f32_32x32x16_bf16 v[160:175], v[204:207], v[128:131], v[160:175]
    ds_read_b64_tr_b16 v[200:201], v18 offset:2048
    ds_read_b64_tr_b16 v[202:203], v18 offset:9216
    s_waitcnt vmcnt(3) lgkmcnt(10)
    v_mfma_f32_32x32x16_bf16 v[160:175], v[208:211], v[132:135], v[160:175]
    ds_read_b64_tr_b16 v[204:205], v18 offset:3072
    ds_read_b64_tr_b16 v[206:207], v18 offset:10240
    s_mov_b64 exec, 0x7f
    buffer_load_dword v28, v2, s[40:43], s56 offen sc1
    s_mov_b64 exec, -1
    s_waitcnt vmcnt(3) lgkmcnt(10)
    v_mfma_f32_32x32x16_bf16 v[160:175], v[212:215], v[136:139], v[160:175]
    ds_read_b64_tr_b16 v[208:209], v18 offset:4096
    ds_read_b64_tr_b16 v[210:211], v18 offset:11264
    s_waitcnt vmcnt(2) lgkmcnt(10)
    v_mfma_f32_32x32x16_bf16 v[160:175], v[216:219], v[140:143], v[160:175]
    ds_read_b64_tr_b16 v[212:213], v18 offset:5120
    ds_read_b64_tr_b16 v[214:215], v18 offset:12288
    s_waitcnt lgkmcnt(10)
    v_mfma_f32_32x32x16_bf16 v[144:159], v[192:195], v[116:119], v[144:159]
    ds_read_b64_tr_b16 v[216:217], v18 offset:6144
    ds_read_b64_tr_b16 v[218:219], v18 offset:13312
    s_waitcnt lgkmcnt(10)
    v_mfma_f32_32x32x16_bf16 v[144:159], v[196:199], v[120:123], v[144:159]
    s_waitcnt lgkmcnt(8)
    v_mfma_f32_32x32x16_bf16 v[144:159], v[200:203], v[124:127], v[144:159]
    s_waitcnt lgkmcnt(6)
    v_mfma_f32_32x32x16_bf16 v[144:159], v[204:207], v[128:131], v[144:159]
    ds_write_b128 v26, v[160:163] offset:0
    s_waitcnt lgkmcnt(5)
    v_mfma_f32_32x32x16_bf16 v[144:159], v[208:211], v[132:135], v[144:159]
    ds_write_b128 v26, v[164:167] offset:1024
    s_waitcnt lgkmcnt(4)
    v_mfma_f32_32x32x16_bf16 v[144:159], v[212:215], v[136:139], v[144:159]
    ds_write_b128 v26, v[168:171] offset:2048
    s_waitcnt lgkmcnt(3)
    v_mfma_f32_32x32x16_bf16 v[144:159], v[216:219], v[140:143], v[144:159]
    ds_write_b128 v26, v[172:175] offset:3072
    ds_write_b32 v17, v3
    s_setprio 0
    s_mul_i32 s53, s74, 7
    s_add_u32 s53, s53, s73
    s_lshl_b32 s53, s53, 10
    s_add_u32 s53, s53, 4194304
    s_lshl_b32 s54, s59, 15
    s_add_u32 s54, s54, s53
    s_xor_b32 s55, s59, 4
    s_lshl_b32 s55, s55, 15
    s_add_u32 s55, s55, s53
    v_xor_b32 v17, 8, v17
    s_waitcnt vmcnt(0)
    s_mov_b64 exec, 0x7f
    v_cmp_eq_u32 vcc, 0, v28
    s_cbranch_vccz L_ok_92
L_poll_93:
    buffer_load_dword v28, v2, s[40:43], s56 offen sc1
    s_add_u32 s52, s52, 1
    s_waitcnt vmcnt(0)
    v_cmp_eq_u32 vcc, 0, v28
    s_cmp_gt_u32 s52, 4194304
    s_cbranch_scc1 L_polled_94
    s_cbranch_vccnz L_poll_93
L_polled_94:
L_ok_92:
    s_mov_b64 exec, -1
L_pair_95:
    ds_read_b32 v23, v17
    ds_read_b128 v[32:35], v27 offset:0
    ds_read_b128 v[36:39], v27 offset:1024
    ds_read_b128 v[40:43], v27 offset:2048
    ds_read_b128 v[44:47], v27 offset:3072
    s_add_u32 s52, s52, 1
    s_waitcnt lgkmcnt(0)
    v_cmp_ne_u32 vcc, 1, v23
    s_cmp_gt_u32 s52, 4194304
    s_cbranch_scc1 L_paired_96
    s_cbranch_vccnz L_pair_95
L_paired_96:
    v_add_f32 v144, v144, v32
    v_add_f32 v145, v145, v33
    v_add_f32 v146, v146, v34
    v_add_f32 v147, v147, v35
    v_add_f32 v148, v148, v36
    v_add_f32 v149, v149, v37
    v_add_f32 v150, v150, v38
    v_add_f32_e64 v151, v151, v39
    v_cvt_pk_bf16_f32 v160, v144, v145
    v_cvt_pk_bf16_f32 v161, v146, v147
    v_cvt_pk_bf16_f32 v162, v148, v149
    v_cvt_pk_bf16_f32 v163, v150, v151
    s_cmp_eq_u32 s51, 0
    s_cbranch_scc1 L_slow_97
    buffer_store_dwordx4 v[160:163], v2, s[40:43], s54 offen offset:0
L_pubd_98:
    v_add_f32 v152, v152, v40
    v_add_f32 v153, v153, v41
    v_add_f32 v154, v154, v42
    v_add_f32 v155, v155, v43
    v_add_f32 v156, v156, v44
    v_add_f32 v157, v157, v45
    v_add_f32 v158, v158, v46
    v_add_f32 v159, v159, v47
    v_cvt_pk_bf16_f32 v164, v152, v153
    v_cvt_pk_bf16_f32 v165, v154, v155
    v_cvt_pk_bf16_f32 v166, v156, v157
    v_cvt_pk_bf16_f32 v167, v158, v159
    s_cmp_eq_u32 s51, 0
    s_cbranch_scc1 L_slow_99
    buffer_store_dwordx4 v[164:167], v29, s[40:43], s54 offen offset:1024
L_pubd_100:
    s_lshl_b32 s53, s46, 11
    s_add_u32 m0, s53, 94208
    v_mov_b32 v3, 2
    s_waitcnt vmcnt(0)
    s_mov_b64 exec, 1
    s_cmp_eq_u32 s51, 0
    s_cbranch_scc1 L_slow_101
    buffer_store_dword v3, v21, s[40:43], s58 offen
L_pubd_102:
L_poll_103:
    buffer_load_dword v23, v21, s[40:43], s57 offen sc1
    s_add_u32 s52, s52, 1
    s_waitcnt vmcnt(0)
    v_cmp_ne_u32 vcc, 2, v23
    s_cmp_gt_u32 s52, 4194304
    s_cbranch_scc1 L_polled_104
    s_cbranch_vccnz L_poll_103
L_polled_104:
    s_mov_b64 exec, -1
    buffer_load_dwordx4 v2, s[40:43], s55 offen offset:0 sc1 lds
    buffer_load_dwordx4 v29, s[40:43], s55 offen offset:1024 sc1 lds
    s_waitcnt vmcnt(0)
    s_barrier
L_Ldone:
    s_endpgm
L_tail:
L_slow_10:
    buffer_store_dwordx4 v[32:35], v2, s[40:43], s57 offen offset:0 sc1
    s_branch L_pubd_11
L_slow_12:
    buffer_store_dwordx4 v[36:39], v2, s[40:43], s57 offen offset:1024 sc1
    s_branch L_pubd_13
L_slow_14:
    buffer_store_dword v28, v26, s[40:43], s58 offen sc1
    s_branch L_pubd_15
L_slow_16:
    buffer_store_dword v27, v26, s[40:43], s56 offen offset:1024 sc1
    s_branch L_pubd_17
L_slow_20:
    buffer_store_dword v3, v21, s[40:43], s48 offen sc1
    s_branch L_pubd_21
L_slow_22:
    buffer_store_dword v3, v21, s[40:43], s48 offen sc1
    s_branch L_pubd_23
L_slow_24:
    buffer_store_dword v3, v21, s[40:43], s48 offen sc1
    s_branch L_pubd_25
L_late_41:
L_poll_43:
    buffer_load_dword v15, v4, s[36:39], 0 offen sc1
    s_add_u32 s52, s52, 1
    s_waitcnt vmcnt(0)
    v_cmp_ne_u32 vcc, 1, v15
    s_cmp_gt_u32 s52, 4194304
    s_cbranch_scc1 L_polled_44
    s_cbranch_vccnz L_poll_43
L_polled_44:
    s_branch L_ok_42
L_exact_47:
    v_and_b32 v26, 31, v1
    v_lshrrev_b32 v27, 5, v1
    v_lshlrev_b32 v27, 2, v27
    v_sub_u32 v26, v26, v27
    v_mov_b32 v27, 4048155338
    v_cmp_le_i32 s[62:63], 0, v26
    v_cmp_le_i32 s[64:65], 1, v26
    s_nop 0
    v_cndmask_b32 v160, v27, 0, s[62:63]
    v_cndmask_b32 v144, 0, v27, s[62:63]
    v_cmp_le_i32 s[66:67], 2, v26
    v_cndmask_b32 v161, v27, 0, s[64:65]
    v_cndmask_b32 v145, 0, v27, s[64:65]
    v_cmp_le_i32 s[62:63], 3, v26
    v_cndmask_b32 v162, v27, 0, s[66:67]
    v_cndmask_b32 v146, 0, v27, s[66:67]
    v_cmp_le_i32 s[64:65], 8, v26
    v_cndmask_b32 v163, v27, 0, s[62:63]
    v_cndmask_b32 v147, 0, v27, s[62:63]
    v_cmp_le_i32 s[66:67], 9, v26
    v_cndmask_b32 v164, v27, 0, s[64:65]
    v_cndmask_b32 v148, 0, v27, s[64:65]
    v_cmp_le_i32 s[62:63], 10, v26
    v_cndmask_b32 v165, v27, 0, s[66:67]
    v_cndmask_b32 v149, 0, v27, s[66:67]
    v_cmp_le_i32 s[64:65], 11, v26
    v_cndmask_b32 v166, v27, 0, s[62:63]
    v_cndmask_b32 v150, 0, v27, s[62:63]
    v_cmp_le_i32 s[66:67], 16, v26
    v_cndmask_b32 v167, v27, 0, s[64:65]
    v_cndmask_b32 v151, 0, v27, s[64:65]
    v_cmp_le_i32 s[62:63], 17, v26
    v_cndmask_b32 v168, v27, 0, s[66:67]
    v_cndmask_b32 v152, 0, v27, s[66:67]
    v_cmp_le_i32 s[64:65], 18, v26
    v_cndmask_b32 v169, v27, 0, s[62:63]
    v_cndmask_b32 v153, 0, v27, s[62:63]
    v_cmp_le_i32 s[66:67], 19, v26
    v_cndmask_b32 v170, v27, 0, s[64:65]
    v_cndmask_b32 v154, 0, v27, s[64:65]
    v_cmp_le_i32 s[62:63], 24, v26
    v_cndmask_b32 v171, v27, 0, s[66:67]
    v_cndmask_b32 v155, 0, v27, s[66:67]
    v_cmp_le_i32 s[64:65], 25, v26
    v_cndmask_b32 v172, v27, 0, s[62:63]
    v_cndmask_b32 v156, 0, v27, s[62:63]
    v_cmp_le_i32 s[66:67], 26, v26
    v_cndmask_b32 v173, v27, 0, s[64:65]
    v_cndmask_b32 v157, 0, v27, s[64:65]
    v_cmp_le_i32 s[62:63], 27, v26
    v_cndmask_b32 v174, v27, 0, s[66:67]
    v_cndmask_b32 v158, 0, v27, s[66:67]
    v_cndmask_b32 v175, v27, 0, s[62:63]
    v_cndmask_b32 v159, 0, v27, s[62:63]
    ds_read_b64 v[192:193], v7 offset:0
    ds_read_b64 v[194:195], v7 offset:512
    ds_read_b64 v[196:197], v7 offset:1024
    ds_read_b64 v[198:199], v7 offset:1536
    ds_read_b64 v[200:201], v7 offset:16384
    ds_read_b64 v[202:203], v7 offset:16896
    ds_read_b64 v[204:205], v7 offset:17408
    ds_read_b64 v[206:207], v7 offset:17920
    ds_read_b64 v[208:209], v7 offset:32768
    ds_read_b64 v[210:211], v7 offset:33280
    ds_read_b64 v[212:213], v7 offset:33792
    ds_read_b64 v[214:215], v7 offset:34304
    s_waitcnt lgkmcnt(10)
    v_mfma_f32_32x32x16_bf16 v[32:47], v[192:195], v[220:223], v[144:159]
    ds_read_b64 v[216:217], v7 offset:4096
    ds_read_b64 v[218:219], v7 offset:4608
    s_waitcnt lgkmcnt(10)
    v_mfma_f32_32x32x16_bf16 v[32:47], v[196:199], v[224:227], v[32:47]
    ds_read_b64 v[192:193], v7 offset:5120
    ds_read_b64 v[194:195], v7 offset:5632
    s_waitcnt lgkmcnt(10)
    v_mfma_f32_32x32x16_bf16 v[96:111], v[200:203], v[220:223], 0
    ds_read_b64 v[196:197], v7 offset:8192
    ds_read_b64 v[198:199], v7 offset:8704
    s_waitcnt lgkmcnt(10)
    v_mfma_f32_32x32x16_bf16 v[96:111], v[204:207], v[224:227], v[96:111]
    ds_read_b64 v[200:201], v7 offset:9216
    ds_read_b64 v[202:203], v7 offset:9728
    s_waitcnt lgkmcnt(10)
    v_mfma_f32_32x32x16_bf16 v[160:175], v[208:211], v[220:223], v[160:175]
    ds_read2st64_b64 v[204:207], v7 offset0:24 offset1:25
    s_waitcnt lgkmcnt(9)
    v_mfma_f32_32x32x16_bf16 v[160:175], v[212:215], v[224:227], v[160:175]
    ds_read2st64_b64 v[208:211], v7 offset0:26 offset1:27
    s_waitcnt lgkmcnt(8)
    v_mfma_f32_32x32x16_bf16 v[48:63], v[216:219], v[220:223], 0
    ds_read2st64_b64 v[212:215], v7 offset0:40 offset1:41
    s_waitcnt lgkmcnt(7)
    v_mfma_f32_32x32x16_bf16 v[48:63], v[192:195], v[224:227], v[48:63]
    ds_read2st64_b64 v[216:219], v7 offset0:42 offset1:43
    s_waitcnt lgkmcnt(6)
    v_mfma_f32_32x32x16_bf16 v[64:79], v[196:199], v[220:223], 0
    ds_read2st64_b64 v[192:195], v7 offset0:48 offset1:49
    s_waitcnt lgkmcnt(5)
    v_mfma_f32_32x32x16_bf16 v[64:79], v[200:203], v[224:227], v[64:79]
    ds_read2st64_b64 v[196:199], v7 offset0:50 offset1:51
    s_waitcnt lgkmcnt(5)
    v_mfma_f32_32x32x16_bf16 v[80:95], v[204:207], v[220:223], 0
    ds_read2st64_b64 v[200:203], v7 offset0:56 offset1:57
    s_waitcnt lgkmcnt(5)
    v_mfma_f32_32x32x16_bf16 v[80:95], v[208:211], v[224:227], v[80:95]
    ds_read2st64_b64 v[204:207], v7 offset0:58 offset1:59
    s_waitcnt lgkmcnt(5)
    v_mfma_f32_32x32x16_bf16 v[112:127], v[212:215], v[220:223], 0
    ds_read_b128 v[208:211], v8 offset:2048
    s_waitcnt lgkmcnt(5)
    v_mfma_f32_32x32x16_bf16 v[112:127], v[216:219], v[224:227], v[112:127]
    ds_read_b128 v[212:215], v8 offset:3072
    s_waitcnt lgkmcnt(5)
    v_mfma_f32_32x32x16_bf16 v[128:143], v[192:195], v[220:223], 0
    ds_read_b128 v[216:219], v8 offset:18432
    s_waitcnt lgkmcnt(5)
    v_mfma_f32_32x32x16_bf16 v[128:143], v[196:199], v[224:227], v[128:143]
    ds_read_b128 v[192:195], v8 offset:19456
    s_waitcnt lgkmcnt(5)
    v_mfma_f32_32x32x16_bf16 v[144:159], v[200:203], v[220:223], 0
    ds_read_b128 v[196:199], v8 offset:34816
    s_waitcnt lgkmcnt(5)
    v_mfma_f32_32x32x16_bf16 v[144:159], v[204:207], v[224:227], v[144:159]
    ds_read_b128 v[200:203], v8 offset:35840
    v_max_f32 v5, v32, v33
    v_max3_f32 v5, v34, v35, v5
    v_max3_f32 v5, v36, v37, v5
    v_max3_f32 v5, v38, v39, v5
    v_max3_f32 v5, v40, v41, v5
    v_max3_f32 v5, v42, v43, v5
    v_max3_f32 v5, v44, v45, v5
    v_max3_f32 v5, v46, v47, v5
    v_max3_f32 v5, v48, v49, v5
    v_max3_f32 v5, v50, v51, v5
    v_max3_f32 v5, v52, v53, v5
    v_max3_f32 v5, v54, v55, v5
    v_max3_f32 v5, v56, v57, v5
    v_max3_f32 v5, v58, v59, v5
    v_max3_f32 v5, v60, v61, v5
    v_max3_f32 v5, v62, v63, v5
    v_max3_f32 v5, v64, v65, v5
    v_max3_f32 v5, v66, v67, v5
    v_max3_f32 v5, v68, v69, v5
    v_max3_f32 v5, v70, v71, v5
    v_max3_f32 v5, v72, v73, v5
    v_max3_f32 v5, v74, v75, v5
    v_max3_f32 v5, v76, v77, v5
    v_max3_f32 v5, v78, v79, v5
    v_max3_f32 v5, v80, v81, v5
    v_max3_f32 v5, v82, v83, v5
    v_max3_f32 v5, v84, v85, v5
    v_max3_f32 v5, v86, v87, v5
    v_max3_f32 v5, v88, v89, v5
    v_max3_f32 v5, v90, v91, v5
    v_max3_f32 v5, v92, v93, v5
    v_max3_f32 v5, v94, v95, v5
    v_max3_f32 v5, v96, v97, v5
    v_max3_f32 v5, v98, v99, v5
    v_max3_f32 v5, v100, v101, v5
    v_max3_f32 v5, v102, v103, v5
    v_max3_f32 v5, v104, v105, v5
    v_max3_f32 v5, v106, v107, v5
    v_max3_f32 v5, v108, v109, v5
    v_max3_f32 v5, v110, v111, v5
    v_max3_f32 v5, v112, v113, v5
    v_max3_f32 v5, v114, v115, v5
    v_max3_f32 v5, v116, v117, v5
    v_max3_f32 v5, v118, v119, v5
    v_max3_f32 v5, v120, v121, v5
    v_max3_f32 v5, v122, v123, v5
    v_max3_f32 v5, v124, v125, v5
    v_max3_f32 v5, v126, v127, v5
    v_max3_f32 v5, v128, v129, v5
    v_max3_f32 v5, v130, v131, v5
    v_max3_f32 v5, v132, v133, v5
    v_max3_f32 v5, v134, v135, v5
    v_max3_f32 v5, v136, v137, v5
    v_max3_f32 v5, v138, v139, v5
    v_max3_f32 v5, v140, v141, v5
    v_max3_f32 v5, v142, v143, v5
    v_max3_f32 v5, v144, v145, v5
    v_max3_f32 v5, v146, v147, v5
    v_max3_f32 v5, v148, v149, v5
    v_max3_f32 v5, v150, v151, v5
    v_max3_f32 v5, v152, v153, v5
    v_max3_f32 v5, v154, v155, v5
    v_max3_f32 v5, v156, v157, v5
    v_max3_f32 v5, v158, v159, v5
    v_max3_f32 v5, v160, v161, v5
    v_max3_f32 v5, v162, v163, v5
    v_max3_f32 v5, v164, v165, v5
    v_max3_f32 v5, v166, v167, v5
    v_max3_f32 v5, v168, v169, v5
    v_max3_f32 v5, v170, v171, v5
    v_max3_f32 v5, v172, v173, v5
    v_max3_f32 v5, v174, v175, v5
    v_mov_b32 v6, v5
    s_nop 1
    v_permlane32_swap_b32 v5, v6
    v_max_f32 v6, v5, v6
    v_pk_add_f32 v[32:33], v[32:33], v[6:7] op_sel_hi:[1,0] neg_lo:[0,1] neg_hi:[0,1]
    v_pk_add_f32 v[34:35], v[34:35], v[6:7] op_sel_hi:[1,0] neg_lo:[0,1] neg_hi:[0,1]
    v_pk_add_f32 v[36:37], v[36:37], v[6:7] op_sel_hi:[1,0] neg_lo:[0,1] neg_hi:[0,1]
    v_pk_add_f32 v[38:39], v[38:39], v[6:7] op_sel_hi:[1,0] neg_lo:[0,1] neg_hi:[0,1]
    v_pk_add_f32 v[40:41], v[40:41], v[6:7] op_sel_hi:[1,0] neg_lo:[0,1] neg_hi:[0,1]
    v_pk_add_f32 v[42:43], v[42:43], v[6:7] op_sel_hi:[1,0] neg_lo:[0,1] neg_hi:[0,1]
    v_pk_add_f32 v[44:45], v[44:45], v[6:7] op_sel_hi:[1,0] neg_lo:[0,1] neg_hi:[0,1]
    v_pk_add_f32 v[46:47], v[46:47], v[6:7] op_sel_hi:[1,0] neg_lo:[0,1] neg_hi:[0,1]
    v_pk_add_f32 v[48:49], v[48:49], v[6:7] op_sel_hi:[1,0] neg_lo:[0,1] neg_hi:[0,1]
    v_pk_add_f32 v[50:51], v[50:51], v[6:7] op_sel_hi:[1,0] neg_lo:[0,1] neg_hi:[0,1]
    v_pk_add_f32 v[52:53], v[52:53], v[6:7] op_sel_hi:[1,0] neg_lo:[0,1] neg_hi:[0,1]
    v_pk_add_f32 v[54:55], v[54:55], v[6:7] op_sel_hi:[1,0] neg_lo:[0,1] neg_hi:[0,1]
    v_pk_add_f32 v[56:57], v[56:57], v[6:7] op_sel_hi:[1,0] neg_lo:[0,1] neg_hi:[0,1]
    v_pk_add_f32 v[58:59], v[58:59], v[6:7] op_sel_hi:[1,0] neg_lo:[0,1] neg_hi:[0,1]
    v_pk_add_f32 v[60:61], v[60:61], v[6:7] op_sel_hi:[1,0] neg_lo:[0,1] neg_hi:[0,1]
    v_pk_add_f32 v[62:63], v[62:63], v[6:7] op_sel_hi:[1,0] neg_lo:[0,1] neg_hi:[0,1]
    v_pk_add_f32 v[64:65], v[64:65], v[6:7] op_sel_hi:[1,0] neg_lo:[0,1] neg_hi:[0,1]
    v_pk_add_f32 v[66:67], v[66:67], v[6:7] op_sel_hi:[1,0] neg_lo:[0,1] neg_hi:[0,1]
    v_pk_add_f32 v[68:69], v[68:69], v[6:7] op_sel_hi:[1,0] neg_lo:[0,1] neg_hi:[0,1]
    v_pk_add_f32 v[70:71], v[70:71], v[6:7] op_sel_hi:[1,0] neg_lo:[0,1] neg_hi:[0,1]
    v_pk_add_f32 v[72:73], v[72:73], v[6:7] op_sel_hi:[1,0] neg_lo:[0,1] neg_hi:[0,1]
    v_pk_add_f32 v[74:75], v[74:75], v[6:7] op_sel_hi:[1,0] neg_lo:[0,1] neg_hi:[0,1]
    v_pk_add_f32 v[76:77], v[76:77], v[6:7] op_sel_hi:[1,0] neg_lo:[0,1] neg_hi:[0,1]
    v_pk_add_f32 v[78:79], v[78:79], v[6:7] op_sel_hi:[1,0] neg_lo:[0,1] neg_hi:[0,1]
    v_pk_add_f32 v[80:81], v[80:81], v[6:7] op_sel_hi:[1,0] neg_lo:[0,1] neg_hi:[0,1]
    v_pk_add_f32 v[82:83], v[82:83], v[6:7] op_sel_hi:[1,0] neg_lo:[0,1] neg_hi:[0,1]
    v_pk_add_f32 v[84:85], v[84:85], v[6:7] op_sel_hi:[1,0] neg_lo:[0,1] neg_hi:[0,1]
    v_pk_add_f32 v[86:87], v[86:87], v[6:7] op_sel_hi:[1,0] neg_lo:[0,1] neg_hi:[0,1]
    v_pk_add_f32 v[88:89], v[88:89], v[6:7] op_sel_hi:[1,0] neg_lo:[0,1] neg_hi:[0,1]
    v_pk_add_f32 v[90:91], v[90:91], v[6:7] op_sel_hi:[1,0] neg_lo:[0,1] neg_hi:[0,1]
    v_pk_add_f32 v[92:93], v[92:93], v[6:7] op_sel_hi:[1,0] neg_lo:[0,1] neg_hi:[0,1]
    v_pk_add_f32 v[94:95], v[94:95], v[6:7] op_sel_hi:[1,0] neg_lo:[0,1] neg_hi:[0,1]
    v_pk_add_f32 v[96:97], v[96:97], v[6:7] op_sel_hi:[1,0] neg_lo:[0,1] neg_hi:[0,1]
    v_pk_add_f32 v[98:99], v[98:99], v[6:7] op_sel_hi:[1,0] neg_lo:[0,1] neg_hi:[0,1]
    v_pk_add_f32 v[100:101], v[100:101], v[6:7] op_sel_hi:[1,0] neg_lo:[0,1] neg_hi:[0,1]
    v_pk_add_f32 v[102:103], v[102:103], v[6:7] op_sel_hi:[1,0] neg_lo:[0,1] neg_hi:[0,1]
    v_pk_add_f32 v[104:105], v[104:105], v[6:7] op_sel_hi:[1,0] neg_lo:[0,1] neg_hi:[0,1]
    v_pk_add_f32 v[106:107], v[106:107], v[6:7] op_sel_hi:[1,0] neg_lo:[0,1] neg_hi:[0,1]
    v_pk_add_f32 v[108:109], v[108:109], v[6:7] op_sel_hi:[1,0] neg_lo:[0,1] neg_hi:[0,1]
    v_pk_add_f32 v[110:111], v[110:111], v[6:7] op_sel_hi:[1,0] neg_lo:[0,1] neg_hi:[0,1]
    v_pk_add_f32 v[112:113], v[112:113], v[6:7] op_sel_hi:[1,0] neg_lo:[0,1] neg_hi:[0,1]
    v_pk_add_f32 v[114:115], v[114:115], v[6:7] op_sel_hi:[1,0] neg_lo:[0,1] neg_hi:[0,1]
    v_pk_add_f32 v[116:117], v[116:117], v[6:7] op_sel_hi:[1,0] neg_lo:[0,1] neg_hi:[0,1]
    v_pk_add_f32 v[118:119], v[118:119], v[6:7] op_sel_hi:[1,0] neg_lo:[0,1] neg_hi:[0,1]
    v_pk_add_f32 v[120:121], v[120:121], v[6:7] op_sel_hi:[1,0] neg_lo:[0,1] neg_hi:[0,1]
    v_pk_add_f32 v[122:123], v[122:123], v[6:7] op_sel_hi:[1,0] neg_lo:[0,1] neg_hi:[0,1]
    v_pk_add_f32 v[124:125], v[124:125], v[6:7] op_sel_hi:[1,0] neg_lo:[0,1] neg_hi:[0,1]
    v_pk_add_f32 v[126:127], v[126:127], v[6:7] op_sel_hi:[1,0] neg_lo:[0,1] neg_hi:[0,1]
    v_pk_add_f32 v[128:129], v[128:129], v[6:7] op_sel_hi:[1,0] neg_lo:[0,1] neg_hi:[0,1]
    v_pk_add_f32 v[130:131], v[130:131], v[6:7] op_sel_hi:[1,0] neg_lo:[0,1] neg_hi:[0,1]
    v_pk_add_f32 v[132:133], v[132:133], v[6:7] op_sel_hi:[1,0] neg_lo:[0,1] neg_hi:[0,1]
    v_pk_add_f32 v[134:135], v[134:135], v[6:7] op_sel_hi:[1,0] neg_lo:[0,1] neg_hi:[0,1]
    v_pk_add_f32 v[136:137], v[136:137], v[6:7] op_sel_hi:[1,0] neg_lo:[0,1] neg_hi:[0,1]
    v_pk_add_f32 v[138:139], v[138:139], v[6:7] op_sel_hi:[1,0] neg_lo:[0,1] neg_hi:[0,1]
    v_pk_add_f32 v[140:141], v[140:141], v[6:7] op_sel_hi:[1,0] neg_lo:[0,1] neg_hi:[0,1]
    v_pk_add_f32 v[142:143], v[142:143], v[6:7] op_sel_hi:[1,0] neg_lo:[0,1] neg_hi:[0,1]
    v_pk_add_f32 v[144:145], v[144:145], v[6:7] op_sel_hi:[1,0] neg_lo:[0,1] neg_hi:[0,1]
    v_pk_add_f32 v[146:147], v[146:147], v[6:7] op_sel_hi:[1,0] neg_lo:[0,1] neg_hi:[0,1]
    v_pk_add_f32 v[148:149], v[148:149], v[6:7] op_sel_hi:[1,0] neg_lo:[0,1] neg_hi:[0,1]
    v_pk_add_f32 v[150:151], v[150:151], v[6:7] op_sel_hi:[1,0] neg_lo:[0,1] neg_hi:[0,1]
    v_pk_add_f32 v[152:153], v[152:153], v[6:7] op_sel_hi:[1,0] neg_lo:[0,1] neg_hi:[0,1]
    v_pk_add_f32 v[154:155], v[154:155], v[6:7] op_sel_hi:[1,0] neg_lo:[0,1] neg_hi:[0,1]
    v_pk_add_f32 v[156:157], v[156:157], v[6:7] op_sel_hi:[1,0] neg_lo:[0,1] neg_hi:[0,1]
    v_pk_add_f32 v[158:159], v[158:159], v[6:7] op_sel_hi:[1,0] neg_lo:[0,1] neg_hi:[0,1]
    v_pk_add_f32 v[160:161], v[160:161], v[6:7] op_sel_hi:[1,0] neg_lo:[0,1] neg_hi:[0,1]
    v_pk_add_f32 v[162:163], v[162:163], v[6:7] op_sel_hi:[1,0] neg_lo:[0,1] neg_hi:[0,1]
    v_pk_add_f32 v[164:165], v[164:165], v[6:7] op_sel_hi:[1,0] neg_lo:[0,1] neg_hi:[0,1]
    v_pk_add_f32 v[166:167], v[166:167], v[6:7] op_sel_hi:[1,0] neg_lo:[0,1] neg_hi:[0,1]
    v_pk_add_f32 v[168:169], v[168:169], v[6:7] op_sel_hi:[1,0] neg_lo:[0,1] neg_hi:[0,1]
    v_pk_add_f32 v[170:171], v[170:171], v[6:7] op_sel_hi:[1,0] neg_lo:[0,1] neg_hi:[0,1]
    v_pk_add_f32 v[172:173], v[172:173], v[6:7] op_sel_hi:[1,0] neg_lo:[0,1] neg_hi:[0,1]
    v_pk_add_f32 v[174:175], v[174:175], v[6:7] op_sel_hi:[1,0] neg_lo:[0,1] neg_hi:[0,1]
    v_exp_f32 v32, v32
    v_exp_f32 v33, v33
    v_exp_f32 v34, v34
    v_exp_f32 v35, v35
    v_exp_f32 v36, v36
    v_exp_f32 v37, v37
    v_exp_f32 v38, v38
    v_exp_f32 v39, v39
    v_cvt_pk_bf16_f32 v32, v32, v33
    v_cvt_pk_bf16_f32 v33, v34, v35
    v_cvt_pk_bf16_f32 v34, v36, v37
    v_cvt_pk_bf16_f32 v35, v38, v39
    s_waitcnt lgkmcnt(5)
    s_nop 0
    v_mfma_f32_32x32x16_bf16 v[176:191], v[208:211], v[32:35], 0
    ds_read_b128 v[204:207], v8 offset:6144
    v_exp_f32 v40, v40
    v_exp_f32 v41, v41
    v_exp_f32 v42, v42
    v_exp_f32 v43, v43
    v_exp_f32 v44, v44
    v_exp_f32 v45, v45
    v_exp_f32 v46, v46
    v_exp_f32 v47, v47
    v_cvt_pk_bf16_f32 v40, v40, v41
    v_cvt_pk_bf16_f32 v41, v42, v43
    v_cvt_pk_bf16_f32 v42, v44, v45
    v_cvt_pk_bf16_f32 v43, v46, v47
    s_waitcnt lgkmcnt(5)
    s_nop 0
    v_mfma_f32_32x32x16_bf16 v[176:191], v[212:215], v[40:43], v[176:191]
    ds_read_b128 v[208:211], v8 offset:7168
    v_exp_f32 v96, v96
    v_exp_f32 v97, v97
    v_exp_f32 v98, v98
    v_exp_f32 v99, v99
    v_exp_f32 v100, v100
    v_exp_f32 v101, v101
    v_exp_f32 v102, v102
    v_exp_f32 v103, v103
    v_cvt_pk_bf16_f32 v96, v96, v97
    v_cvt_pk_bf16_f32 v97, v98, v99
    v_cvt_pk_bf16_f32 v98, v100, v101
    v_cvt_pk_bf16_f32 v99, v102, v103
    s_waitcnt lgkmcnt(5)
    s_nop 0
    v_mfma_f32_32x32x16_bf16 v[176:191], v[216:219], v[96:99], v[176:191]
    ds_read_b128 v[212:215], v8 offset:10240
    v_exp_f32 v104, v104
    v_exp_f32 v105, v105
    v_exp_f32 v106, v106
    v_exp_f32 v107, v107
    v_exp_f32 v108, v108
    v_exp_f32 v109, v109
    v_exp_f32 v110, v110
    v_exp_f32 v111, v111
    v_cvt_pk_bf16_f32 v104, v104, v105
    v_cvt_pk_bf16_f32 v105, v106, v107
    v_cvt_pk_bf16_f32 v106, v108, v109
    v_cvt_pk_bf16_f32 v107, v110, v111
    s_waitcnt lgkmcnt(5)
    s_nop 0
    v_mfma_f32_32x32x16_bf16 v[176:191], v[192:195], v[104:107], v[176:191]
    ds_read_b128 v[216:219], v8 offset:11264
    v_exp_f32 v160, v160
    v_exp_f32 v161, v161
    v_exp_f32 v162, v162
    v_exp_f32 v163, v163
    v_exp_f32 v164, v164
    v_exp_f32 v165, v165
    v_exp_f32 v166, v166
    v_exp_f32 v167, v167
    v_cvt_pk_bf16_f32 v160, v160, v161
    v_cvt_pk_bf16_f32 v161, v162, v163
    v_cvt_pk_bf16_f32 v162, v164, v165
    v_cvt_pk_bf16_f32 v163, v166, v167
    s_waitcnt lgkmcnt(5)
    s_nop 0
    v_mfma_f32_32x32x16_bf16 v[176:191], v[196:199], v[160:163], v[176:191]
    ds_read_b128 v[192:195], v8 offset:14336
    v_exp_f32 v168, v168
    v_exp_f32 v169, v169
    v_exp_f32 v170, v170
    v_exp_f32 v171, v171
    v_exp_f32 v172, v172
    v_exp_f32 v173, v173
    v_exp_f32 v174, v174
    v_exp_f32 v175, v175
    v_cvt_pk_bf16_f32 v168, v168, v169
    v_cvt_pk_bf16_f32 v169, v170, v171
    v_cvt_pk_bf16_f32 v170, v172, v173
    v_cvt_pk_bf16_f32 v171, v174, v175
    s_waitcnt lgkmcnt(5)
    s_nop 0
    v_mfma_f32_32x32x16_bf16 v[176:191], v[200:203], v[168:171], v[176:191]
    ds_read_b128 v[196:199], v8 offset:15360
    v_exp_f32 v48, v48
    v_exp_f32 v49, v49
    v_exp_f32 v50, v50
    v_exp_f32 v51, v51
    v_exp_f32 v52, v52
    v_exp_f32 v53, v53
    v_exp_f32 v54, v54
    v_exp_f32 v55, v55
    v_cvt_pk_bf16_f32 v48, v48, v49
    v_cvt_pk_bf16_f32 v49, v50, v51
    v_cvt_pk_bf16_f32 v50, v52, v53
    v_cvt_pk_bf16_f32 v51, v54, v55
    s_waitcnt lgkmcnt(5)
    s_nop 0
    v_mfma_f32_32x32x16_bf16 v[176:191], v[204:207], v[48:51], v[176:191]
    ds_read_b128 v[200:203], v8 offset:22528
    v_exp_f32 v56, v56
    v_exp_f32 v57, v57
    v_exp_f32 v58, v58
    v_exp_f32 v59, v59
    v_exp_f32 v60, v60
    v_exp_f32 v61, v61
    v_exp_f32 v62, v62
    v_exp_f32 v63, v63
    v_cvt_pk_bf16_f32 v56, v56, v57
    v_cvt_pk_bf16_f32 v57, v58, v59
    v_cvt_pk_bf16_f32 v58, v60, v61
    v_cvt_pk_bf16_f32 v59, v62, v63
    s_waitcnt lgkmcnt(5)
    s_nop 0
    v_mfma_f32_32x32x16_bf16 v[176:191], v[208:211], v[56:59], v[176:191]
    ds_read_b128 v[204:207], v8 offset:23552
    v_exp_f32 v64, v64
    v_exp_f32 v65, v65
    v_exp_f32 v66, v66
    v_exp_f32 v67, v67
    v_exp_f32 v68, v68
    v_exp_f32 v69, v69
    v_exp_f32 v70, v70
    v_exp_f32 v71, v71
    v_cvt_pk_bf16_f32 v64, v64, v65
    v_cvt_pk_bf16_f32 v65, v66, v67
    v_cvt_pk_bf16_f32 v66, v68, v69
    v_cvt_pk_bf16_f32 v67, v70, v71
    s_waitcnt lgkmcnt(5)
    s_nop 0
    v_mfma_f32_32x32x16_bf16 v[176:191], v[212:215], v[64:67], v[176:191]
    ds_read_b128 v[208:211], v8 offset:26624
    v_exp_f32 v72, v72
    v_exp_f32 v73, v73
    v_exp_f32 v74, v74
    v_exp_f32 v75, v75
    v_exp_f32 v76, v76
    v_exp_f32 v77, v77
    v_exp_f32 v78, v78
    v_exp_f32 v79, v79
    v_cvt_pk_bf16_f32 v72, v72, v73
    v_cvt_pk_bf16_f32 v73, v74, v75
    v_cvt_pk_bf16_f32 v74, v76, v77
    v_cvt_pk_bf16_f32 v75, v78, v79
    s_waitcnt lgkmcnt(5)
    s_nop 0
    v_mfma_f32_32x32x16_bf16 v[176:191], v[216:219], v[72:75], v[176:191]
    ds_read_b128 v[212:215], v8 offset:27648
    v_exp_f32 v80, v80
    v_exp_f32 v81, v81
    v_exp_f32 v82, v82
    v_exp_f32 v83, v83
    v_exp_f32 v84, v84
    v_exp_f32 v85, v85
    v_exp_f32 v86, v86
    v_exp_f32 v87, v87
    v_cvt_pk_bf16_f32 v80, v80, v81
    v_cvt_pk_bf16_f32 v81, v82, v83
    v_cvt_pk_bf16_f32 v82, v84, v85
    v_cvt_pk_bf16_f32 v83, v86, v87
    s_waitcnt lgkmcnt(5)
    s_nop 0
    v_mfma_f32_32x32x16_bf16 v[176:191], v[192:195], v[80:83], v[176:191]
    ds_read_b128 v[216:219], v8 offset:30720
    v_exp_f32 v88, v88
    v_exp_f32 v89, v89
    v_exp_f32 v90, v90
    v_exp_f32 v91, v91
    v_exp_f32 v92, v92
    v_exp_f32 v93, v93
    v_exp_f32 v94, v94
    v_exp_f32 v95, v95
    v_cvt_pk_bf16_f32 v88, v88, v89
    v_cvt_pk_bf16_f32 v89, v90, v91
    v_cvt_pk_bf16_f32 v90, v92, v93
    v_cvt_pk_bf16_f32 v91, v94, v95
    s_waitcnt lgkmcnt(5)
    s_nop 0
    v_mfma_f32_32x32x16_bf16 v[176:191], v[196:199], v[88:91], v[176:191]
    ds_read_b128 v[192:195], v8 offset:31744
    v_exp_f32 v112, v112
    v_exp_f32 v113, v113
    v_exp_f32 v114, v114
    v_exp_f32 v115, v115
    v_exp_f32 v116, v116
    v_exp_f32 v117, v117
    v_exp_f32 v118, v118
    v_exp_f32 v119, v119
    v_cvt_pk_bf16_f32 v112, v112, v113
    v_cvt_pk_bf16_f32 v113, v114, v115
    v_cvt_pk_bf16_f32 v114, v116, v117
    v_cvt_pk_bf16_f32 v115, v118, v119
    s_waitcnt lgkmcnt(5)
    s_nop 0
    v_mfma_f32_32x32x16_bf16 v[176:191], v[200:203], v[112:115], v[176:191]
    v_exp_f32 v120, v120
    v_exp_f32 v121, v121
    v_exp_f32 v122, v122
    v_exp_f32 v123, v123
    v_exp_f32 v124, v124
    v_exp_f32 v125, v125
    v_exp_f32 v126, v126
    v_exp_f32 v127, v127
    v_cvt_pk_bf16_f32 v120, v120, v121
    v_cvt_pk_bf16_f32 v121, v122, v123
    v_cvt_pk_bf16_f32 v122, v124, v125
    v_cvt_pk_bf16_f32 v123, v126, v127
    s_waitcnt lgkmcnt(4)
    s_nop 0
    v_mfma_f32_32x32x16_bf16 v[176:191], v[204:207], v[120:123], v[176:191]
    v_exp_f32 v128, v128
    v_exp_f32 v129, v129
    v_exp_f32 v130, v130
    v_exp_f32 v131, v131
    v_exp_f32 v132, v132
    v_exp_f32 v133, v133
    v_exp_f32 v134, v134
    v_exp_f32 v135, v135
    v_cvt_pk_bf16_f32 v128, v128, v129
    v_cvt_pk_bf16_f32 v129, v130, v131
    v_cvt_pk_bf16_f32 v130, v132, v133
    v_cvt_pk_bf16_f32 v131, v134, v135
    s_waitcnt lgkmcnt(3)
    s_nop 0
    v_mfma_f32_32x32x16_bf16 v[176:191], v[208:211], v[128:131], v[176:191]
    v_exp_f32 v136, v136
    v_exp_f32 v137, v137
    v_exp_f32 v138, v138
    v_exp_f32 v139, v139
    v_exp_f32 v140, v140
    v_exp_f32 v141, v141
    v_exp_f32 v142, v142
    v_exp_f32 v143, v143
    v_cvt_pk_bf16_f32 v136, v136, v137
    v_cvt_pk_bf16_f32 v137, v138, v139
    v_cvt_pk_bf16_f32 v138, v140, v141
    v_cvt_pk_bf16_f32 v139, v142, v143
    s_waitcnt lgkmcnt(2)
    s_nop 0
    v_mfma_f32_32x32x16_bf16 v[176:191], v[212:215], v[136:139], v[176:191]
    v_exp_f32 v144, v144
    v_exp_f32 v145, v145
    v_exp_f32 v146, v146
    v_exp_f32 v147, v147
    v_exp_f32 v148, v148
    v_exp_f32 v149, v149
    v_exp_f32 v150, v150
    v_exp_f32 v151, v151
    v_cvt_pk_bf16_f32 v144, v144, v145
    v_cvt_pk_bf16_f32 v145, v146, v147
    v_cvt_pk_bf16_f32 v146, v148, v149
    v_cvt_pk_bf16_f32 v147, v150, v151
    s_waitcnt lgkmcnt(1)
    s_nop 0
    v_mfma_f32_32x32x16_bf16 v[176:191], v[216:219], v[144:147], v[176:191]
    v_exp_f32 v152, v152
    v_exp_f32 v153, v153
    v_exp_f32 v154, v154
    v_exp_f32 v155, v155
    v_exp_f32 v156, v156
    v_exp_f32 v157, v157
    v_exp_f32 v158, v158
    v_exp_f32 v159, v159
    v_cvt_pk_bf16_f32 v152, v152, v153
    v_cvt_pk_bf16_f32 v153, v154, v155
    v_cvt_pk_bf16_f32 v154, v156, v157
    v_cvt_pk_bf16_f32 v155, v158, v159
    s_waitcnt lgkmcnt(0)
    s_nop 0
    v_mfma_f32_32x32x16_bf16 v[176:191], v[192:195], v[152:155], v[176:191]
    s_nop 11
    v_mov_b32 v26, v188
    v_mov_b32 v27, v188
    s_nop 1
    v_permlane32_swap_b32 v26, v27
    s_nop 1
    s_branch L_checked_48
L_slow_53:
    buffer_store_dwordx4 v[220:223], v2, s[40:43], s53 offen offset:0 sc1
    s_branch L_pubd_54
L_slow_55:
    buffer_store_dwordx4 v[224:227], v2, s[40:43], s53 offen offset:1024 sc1
    s_branch L_pubd_56
L_slow_57:
    buffer_store_dword v27, v26, s[40:43], s54 offen offset:0 sc1
    s_branch L_pubd_58
L_slow_61:
    buffer_store_dword v3, v21, s[40:43], s48 offen sc1
    s_branch L_pubd_62
L_slow_63:
    buffer_store_dwordx4 v[176:179], v2, s[40:43], s53 offen sc1
    s_branch L_pubd_64
L_slow_65:
    buffer_store_dwordx4 v[184:187], v2, s[40:43], s53 offen sc1
    s_branch L_pubd_66
L_slow_67:
    buffer_store_dword v3, v21, s[40:43], s48 offen sc1
    s_branch L_pubd_68
L_slow_73:
    buffer_store_dwordx4 v[240:243], v2, s[40:43], s53 offen sc1
    s_branch L_pubd_74
L_slow_75:
    buffer_store_dwordx4 v[248:251], v2, s[40:43], s53 offen sc1
    s_branch L_pubd_76
L_slow_77:
    buffer_store_dword v3, v21, s[40:43], s48 offen sc1
    s_branch L_pubd_78
L_slow_87:
    buffer_store_dword v3, v21, s[40:43], s58 offen sc1
    s_branch L_pubd_88
L_slow_97:
    buffer_store_dwordx4 v[160:163], v2, s[40:43], s54 offen offset:0 sc1
    s_branch L_pubd_98
L_slow_99:
    buffer_store_dwordx4 v[164:167], v29, s[40:43], s54 offen offset:1024 sc1
    s_branch L_pubd_100
L_slow_101:
    buffer_store_dword v3, v21, s[40:43], s58 offen sc1
    s_branch L_pubd_102
L_exit:
    s_endpgm
L_end:
.section .rodata,"a"
.p2align 6
.amdhsa_kernel sequential_preLN__sliding_block__geglu_ffn__prompt_kernel
  .amdhsa_next_free_vgpr 256
  .amdhsa_next_free_sgpr 102
  .amdhsa_accum_offset 256
  .amdhsa_group_segment_fixed_size 0
  .amdhsa_kernarg_size 80
  .amdhsa_user_sgpr_count 2
  .amdhsa_user_sgpr_kernarg_segment_ptr 1
  .amdhsa_system_sgpr_workgroup_id_x 1
.end_amdhsa_kernel
```
